```python
import torch

def _softmax(x, axis=-1):
    return torch.softmax(x, dim=axis)
def _gelu(x):
    return torch.nn.functional.gelu(x, approximate="tanh")
def _silu(x):
    return torch.nn.functional.silu(x)
def _sigmoid(x):
    return torch.sigmoid(x)
def _layernorm(x, axis=-1, eps=1e-5):
    m = x.mean(dim=axis, keepdim=True)
    v = x.var(dim=axis, keepdim=True, unbiased=False)
    return (x - m) / torch.sqrt(v + eps)
def _scatter_add(tgt, idx, src, axis=0):
    return tgt.clone().index_add_(axis, idx, src)
def _segment_sum(src, seg, n):
    out = torch.zeros((n,) + src.shape[1:], dtype=src.dtype)
    return out.index_add_(0, seg, src)
def _pad(x, pw):
    flat = tuple(v for pair in reversed(pw) for v in pair)
    return torch.nn.functional.pad(x, flat)

kernel_name = 'concat_heads__gqa_block_cached__mha_block_cached__near_ridge'

def setup_inputs():

    _w = (lambda a: (lambda t: t.to(torch.bfloat16) if t.is_floating_point() else t)(torch.as_tensor(a)))
    def _A_setup():
        B, Sq, D = 8, 96, 448
        Hq, Hkv, Sk, Dh = 16, 8, 1024, 256
        assert Hq % Hkv == 0, (Hq, Hkv)
        return {
            "x": _w((lambda *s: torch.randn(*s, dtype=torch.bfloat16) * 0.8)(B, Sq, D)),
            "k_cache": _w((lambda *s: torch.randn(*s, dtype=torch.bfloat16) * 0.8)(B, Hkv, Sk, Dh)),
            "v_cache": _w((lambda *s: torch.randn(*s, dtype=torch.bfloat16) * 0.05)(B, Hkv, Sk, Dh)),
            "wq": _w((lambda *s: torch.randn(*s, dtype=torch.bfloat16) * 0.8)(D, Hq * Dh) * (D ** -0.5)),
            "wo": _w((lambda *s: torch.randn(*s, dtype=torch.bfloat16) * 0.05)(Hq * Dh, D) * ((Hq * Dh) ** -0.5)),
        }
    _A_in = _A_setup()

    def _B_setup():
        B, Sq, D = 8, 96, 448
        H, Sk, Dh = 16, 1024, 256
        return {
            "x": _w((lambda *s: torch.randn(*s, dtype=torch.bfloat16) * 0.8)(B, Sq, D)),
            "k_cache": _w((lambda *s: torch.randn(*s, dtype=torch.bfloat16) * 0.8)(B, H, Sk, Dh)),
            "v_cache": _w((lambda *s: torch.randn(*s, dtype=torch.bfloat16) * 0.05)(B, H, Sk, Dh)),
            "wq": _w((lambda *s: torch.randn(*s, dtype=torch.bfloat16) * 0.8)(D, H * Dh) * (D ** -0.5)),
            "wo": _w((lambda *s: torch.randn(*s, dtype=torch.bfloat16) * 0.05)(H * Dh, D) * ((H * Dh) ** -0.5)),
        }
    _B_in = _B_setup()

    return {
        "A_x": _A_in["x"],
        "A_k_cache": _A_in["k_cache"],
        "A_v_cache": _A_in["v_cache"],
        "A_wq": _A_in["wq"],
        "A_wo": _A_in["wo"],
        "B_x": _B_in["x"],
        "B_k_cache": _B_in["k_cache"],
        "B_v_cache": _B_in["v_cache"],
        "B_wq": _B_in["wq"],
        "B_wo": _B_in["wo"],
    }

def reference(A_x, A_k_cache, A_v_cache, A_wq, A_wo, B_x, B_k_cache, B_v_cache, B_wq, B_wo):
    def _A_ref(x, k_cache, v_cache, wq, wo):
        B, Sq, D = x.shape
        Hq, Dh = 16, 256
        Hkv = k_cache.shape[1]
        rep = Hq // Hkv
        q = (lambda x, *d: x.permute(*d))((x @ wq).reshape(B, Sq, Hq, Dh), 0, 2, 1, 3)
        k = (lambda x, n, axis: torch.repeat_interleave(x, n, dim=axis))(k_cache, rep, axis=1)
        v = (lambda x, n, axis: torch.repeat_interleave(x, n, dim=axis))(v_cache, rep, axis=1)
        scores = torch.einsum("bhqd,bhkd->bhqk", q, k) * (Dh ** -0.5)
        p = _softmax(scores, axis=-1)
        o = torch.einsum("bhqk,bhkd->bhqd", p, v)
        return (lambda x, *d: x.permute(*d))(o, 0, 2, 1, 3).reshape(B, Sq, Hq * Dh) @ wo

    def _B_ref(x, k_cache, v_cache, wq, wo):
        B, Sq, D = x.shape
        H, Dh = 16, 256
        q = (lambda x, *d: x.permute(*d))((x @ wq).reshape(B, Sq, H, Dh), 0, 2, 1, 3)
        scores = torch.einsum("bhqd,bhkd->bhqk", q, k_cache) * (Dh ** -0.5)
        p = _softmax(scores, axis=-1)
        o = torch.einsum("bhqk,bhkd->bhqd", p, v_cache)
        return (lambda x, *d: x.permute(*d))(o, 0, 2, 1, 3).reshape(B, Sq, H * Dh) @ wo

    a = _A_ref(A_x, A_k_cache, A_v_cache, A_wq, A_wo)
    b = _B_ref(B_x, B_k_cache, B_v_cache, B_wq, B_wo)
    return torch.concatenate([a, b], axis=-1)
```

```asm
; @launch grid=(256,1,1) block=(256,1,1) lds=163840
.amdgcn_target "amdgcn-amd-amdhsa--gfx950"
.text
.globl concat_heads__gqa_block_cached__mha_block_cached__near_ridge_kernel
.p2align 8
.type concat_heads__gqa_block_cached__mha_block_cached__near_ridge_kernel,@function
concat_heads__gqa_block_cached__mha_block_cached__near_ridge_kernel:
    s_cmp_ge_u32 s2, 256
    s_cbranch_scc1 L_end
    v_readfirstlane_b32 s33, v0
    s_lshr_b32 s30, s2, 7
    s_mul_i32 s3, s30, 40
    s_add_u32 s16, s0, s3
    s_addc_u32 s17, s1, 0
    s_load_dwordx8 s[4:11], s[16:17], 0
    s_load_dwordx2 s[12:13], s[16:17], 32
    s_load_dwordx4 s[76:79], s[0:1], 80
    s_load_dwordx2 s[80:81], s[0:1], 96
    s_getpc_b64 s[18:19]
L_pc:
    s_and_b32 s3, s2, 56
    s_lshl_b32 s3, s3, 4
    v_lshrrev_b32 v1, 2, v0
    v_lshl_add_u32 v1, v1, 10, s3
    v_min_u32 v1, L_codeend-L_pc-4, v1
    global_load_dword v126, v1, s[18:19]
    s_lshr_b32 s33, s33, 6
    s_cbranch_scc0 L_hop
    s_cmp_lg_u32 s33, 3
    s_cbranch_scc1 L_compute
    v_and_b32 v2, 63, v0
    s_and_b32 s26, s2, 7
    s_bfe_u32 s29, s2, 0x30004
    s_cmp_eq_u32 s26, 7
    s_cselect_b32 s3, 0, s26
    s_lshl_b32 s94, s3, 7
    v_lshrrev_b32 v5, 3, v2
    v_mul_u32_u24 v5, 896, v5
    v_lshrrev_b32 v3, 4, v2
    v_and_b32 v7, 7, v2
    v_xor_b32 v6, v3, v7
    v_lshl_add_u32 v36, v6, 4, v5
    v_xor_b32 v6, 64, v36
    v_add_u32 v37, 6144, v6
    v_add_u32 v38, 12288, v36
    v_add_u32 v39, 18432, v6
    s_mov_b32 s38, 86016
    s_mul_i32 s15, s29, s38
    s_mov_b32 s39, 0x20000
    s_branch L_first
.p2align 8
L_hop:
    s_branch L_compute
L_first:
    s_waitcnt lgkmcnt(0)
    s_add_u32 s36, s4, s15
    s_addc_u32 s37, s5, 0
L_loader:
    s_mov_b32 m0, 0
    s_add_u32 s23, s94, 0
    buffer_load_dwordx4 v36, s[36:39], s23 offen offset:0  lds
    buffer_load_dwordx4 v37, s[36:39], s23 offen offset:1024  lds
    buffer_load_dwordx4 v38, s[36:39], s23 offen offset:2048  lds
    buffer_load_dwordx4 v39, s[36:39], s23 offen offset:3072  lds
    s_mov_b32 m0, 32768
    s_add_u32 s23, s94, 28672
    buffer_load_dwordx4 v36, s[36:39], s23 offen offset:0  lds
    buffer_load_dwordx4 v37, s[36:39], s23 offen offset:1024  lds
    buffer_load_dwordx4 v38, s[36:39], s23 offen offset:2048  lds
    buffer_load_dwordx4 v39, s[36:39], s23 offen offset:3072  lds
    s_mov_b32 m0, 65536
    s_add_u32 s23, s94, 57344
    buffer_load_dwordx4 v36, s[36:39], s23 offen offset:0  lds
    buffer_load_dwordx4 v37, s[36:39], s23 offen offset:1024  lds
    buffer_load_dwordx4 v38, s[36:39], s23 offen offset:2048  lds
    buffer_load_dwordx4 v39, s[36:39], s23 offen offset:3072  lds
    s_bfe_u32 s28, s2, 0x10003
    s_lshl_b32 s31, s26, 1
    s_add_u32 s31, s31, s28
    s_lshl_b32 s32, s29, 3
    s_add_u32 s32, s32, s26
    s_lshl_b32 s35, s29, 4
    s_add_u32 s35, s35, s31
    s_cmp_eq_u32 s30, 0
    s_cselect_b32 s32, s32, s35
    s_lshr_b32 s28, s2, 4
    v_and_b32 v7, 15, v2
    v_lshlrev_b32 v6, 1, v3
    v_xor_b32 v6, v6, v7
    v_lshlrev_b32 v6, 4, v6
    v_lshl_add_u32 v40, v3, 13, v6
    v_add_u32 v41, 31744, v40
    v_xor_b32 v6, 128, v40
    v_add_u32 v42, 63488, v6
    v_add_u32 v43, 95232, v6
    s_lshl_b32 s14, s31, 9
    s_sub_u32 s3, 3670016, s14
    s_add_u32 s48, s10, s14
    s_addc_u32 s49, s11, 0
    s_mov_b32 s50, s3
    s_mov_b32 s51, 0x20000
    s_mov_b32 m0, 16384
    s_lshl_b32 s23, s94, 12
    s_add_u32 s23, s23, 0
    buffer_load_dwordx4 v40, s[48:51], s23 offen offset:0  lds
    buffer_load_dwordx4 v41, s[48:51], s23 offen offset:1024  lds
    buffer_load_dwordx4 v42, s[48:51], s23 offen offset:2048  lds
    buffer_load_dwordx4 v43, s[48:51], s23 offen offset:3072  lds
    s_mov_b32 m0, 20480
    s_lshl_b32 s23, s94, 12
    s_add_u32 s23, s23, 131072
    buffer_load_dwordx4 v40, s[48:51], s23 offen offset:0  lds
    buffer_load_dwordx4 v41, s[48:51], s23 offen offset:1024  lds
    buffer_load_dwordx4 v42, s[48:51], s23 offen offset:2048  lds
    buffer_load_dwordx4 v43, s[48:51], s23 offen offset:3072  lds
    s_mov_b32 m0, 24576
    s_lshl_b32 s23, s94, 12
    s_add_u32 s23, s23, 262144
    buffer_load_dwordx4 v40, s[48:51], s23 offen offset:0  lds
    buffer_load_dwordx4 v41, s[48:51], s23 offen offset:1024  lds
    buffer_load_dwordx4 v42, s[48:51], s23 offen offset:2048  lds
    buffer_load_dwordx4 v43, s[48:51], s23 offen offset:3072  lds
    s_mov_b32 m0, 28672
    s_lshl_b32 s23, s94, 12
    s_add_u32 s23, s23, 393216
    buffer_load_dwordx4 v40, s[48:51], s23 offen offset:0  lds
    buffer_load_dwordx4 v41, s[48:51], s23 offen offset:1024  lds
    buffer_load_dwordx4 v42, s[48:51], s23 offen offset:2048  lds
    buffer_load_dwordx4 v43, s[48:51], s23 offen offset:3072  lds
    s_add_u32 s95, s94, 128
    s_cmp_eq_u32 s95, 896
    s_cselect_b32 s95, 0, s95
    s_add_u32 s96, s95, 128
    s_cmp_eq_u32 s96, 896
    s_cselect_b32 s96, 0, s96
    s_add_u32 s97, s96, 128
    s_cmp_eq_u32 s97, 896
    s_cselect_b32 s97, 0, s97
    s_add_u32 s98, s97, 128
    s_cmp_eq_u32 s98, 896
    s_cselect_b32 s98, 0, s98
    s_add_u32 s99, s98, 128
    s_cmp_eq_u32 s99, 896
    s_cselect_b32 s99, 0, s99
    s_add_u32 s100, s99, 128
    s_cmp_eq_u32 s100, 896
    s_cselect_b32 s100, 0, s100
    v_bfe_u32 v5, v2, 1, 3
    v_and_b32 v6, 1, v2
    v_lshlrev_b32 v6, 7, v6
    v_lshl_add_u32 v45, v5, 13, v6
    v_lshrrev_b32 v5, 4, v2
    v_add_u32 v5, 1, v5
    v_min_u32 v5, 6, v5
    v_lshl_add_u32 v5, v5, 7, s94
    v_subrev_u32 v6, 896, v5
    v_min_u32 v5, v5, v6
    v_lshl_add_u32 v34, v5, 12, v45
    s_lshl_b32 s23, s29, 16
    buffer_load_dword v44, v34, s[48:51], s23 offen offset:0
    v_lshrrev_b32 v5, 4, v2
    v_add_u32 v5, 5, v5
    v_min_u32 v5, 6, v5
    v_lshl_add_u32 v5, v5, 7, s94
    v_subrev_u32 v6, 896, v5
    v_min_u32 v5, v5, v6
    v_lshl_add_u32 v34, v5, 12, v45
    s_lshl_b32 s23, s29, 16
    buffer_load_dword v44, v34, s[48:51], s23 offen offset:0
    s_mov_b32 m0, 4096
    s_add_u32 s23, s95, 0
    buffer_load_dwordx4 v36, s[36:39], s23 offen offset:0  lds
    buffer_load_dwordx4 v37, s[36:39], s23 offen offset:1024  lds
    buffer_load_dwordx4 v38, s[36:39], s23 offen offset:2048  lds
    buffer_load_dwordx4 v39, s[36:39], s23 offen offset:3072  lds
    s_mov_b32 m0, 36864
    s_add_u32 s23, s95, 28672
    buffer_load_dwordx4 v36, s[36:39], s23 offen offset:0  lds
    buffer_load_dwordx4 v37, s[36:39], s23 offen offset:1024  lds
    buffer_load_dwordx4 v38, s[36:39], s23 offen offset:2048  lds
    buffer_load_dwordx4 v39, s[36:39], s23 offen offset:3072  lds
    s_mov_b32 m0, 69632
    s_add_u32 s23, s95, 57344
    buffer_load_dwordx4 v36, s[36:39], s23 offen offset:0  lds
    buffer_load_dwordx4 v37, s[36:39], s23 offen offset:1024  lds
    buffer_load_dwordx4 v38, s[36:39], s23 offen offset:2048  lds
    buffer_load_dwordx4 v39, s[36:39], s23 offen offset:3072  lds
    s_mov_b32 m0, 49152
    s_lshl_b32 s23, s95, 12
    s_add_u32 s23, s23, 0
    buffer_load_dwordx4 v40, s[48:51], s23 offen offset:0  lds
    buffer_load_dwordx4 v41, s[48:51], s23 offen offset:1024  lds
    buffer_load_dwordx4 v42, s[48:51], s23 offen offset:2048  lds
    buffer_load_dwordx4 v43, s[48:51], s23 offen offset:3072  lds
    s_mov_b32 m0, 53248
    s_lshl_b32 s23, s95, 12
    s_add_u32 s23, s23, 131072
    buffer_load_dwordx4 v40, s[48:51], s23 offen offset:0  lds
    buffer_load_dwordx4 v41, s[48:51], s23 offen offset:1024  lds
    buffer_load_dwordx4 v42, s[48:51], s23 offen offset:2048  lds
    buffer_load_dwordx4 v43, s[48:51], s23 offen offset:3072  lds
    s_mov_b32 m0, 57344
    s_lshl_b32 s23, s95, 12
    s_add_u32 s23, s23, 262144
    buffer_load_dwordx4 v40, s[48:51], s23 offen offset:0  lds
    buffer_load_dwordx4 v41, s[48:51], s23 offen offset:1024  lds
    buffer_load_dwordx4 v42, s[48:51], s23 offen offset:2048  lds
    buffer_load_dwordx4 v43, s[48:51], s23 offen offset:3072  lds
    s_mov_b32 m0, 61440
    s_lshl_b32 s23, s95, 12
    s_add_u32 s23, s23, 393216
    buffer_load_dwordx4 v40, s[48:51], s23 offen offset:0  lds
    buffer_load_dwordx4 v41, s[48:51], s23 offen offset:1024  lds
    buffer_load_dwordx4 v42, s[48:51], s23 offen offset:2048  lds
    buffer_load_dwordx4 v43, s[48:51], s23 offen offset:3072  lds
    s_lshl_b32 s3, s32, 19
    s_add_u32 s40, s6, s3
    s_addc_u32 s41, s7, 0
    s_mov_b32 s42, 0x80000
    s_mov_b32 s43, 0x20000
    s_add_u32 s44, s8, s3
    s_addc_u32 s45, s9, 0
    s_mov_b32 s46, 0x80000
    s_mov_b32 s47, 0x20000
    s_mul_i32 s3, s31, 229376
    s_add_u32 s52, s12, s3
    s_addc_u32 s53, s13, 0
    s_mov_b32 s54, 229376
    s_mov_b32 s55, 0x20000
    s_mul_i32 s34, s32, 21
    s_and_b32 s34, s34, 31
    s_mul_i32 s34, s34, 0x4200
    s_and_b32 s34, s34, 0x60e00
    s_lshl_b32 s3, s28, 13
    s_add_u32 s3, s3, 33554432
    s_add_u32 s12, s80, s3
    s_addc_u32 s13, s81, 0
    s_mov_b32 s14, 6144
    s_mov_b32 s15, 0x20000
    s_lshl_b32 s3, s28, 4
    s_add_u32 s4, s78, s3
    s_addc_u32 s5, s79, 0
    s_mov_b32 s6, 16
    s_mov_b32 s7, 0x20000
    s_add_u32 s8, s80, 34603008
    s_addc_u32 s9, s81, 0
    s_mov_b32 s10, 4096
    s_mov_b32 s11, 0x20000
    s_and_b32 s82, s2, 7
    s_lshl_b32 s82, s82, 9
    v_lshrrev_b32 v3, 5, v2
    v_and_b32 v4, 31, v2
    v_lshlrev_b32 v7, 12, v3
    v_lshlrev_b32 v5, 1, v3
    v_xor_b32 v5, v5, v4
    v_lshl_add_u32 v5, v5, 4, v7
    v_xor_b32 v28, 0, v5
    v_xor_b32 v29, 64, v5
    v_xor_b32 v30, 128, v5
    v_xor_b32 v31, 192, v5
    v_xor_b32 v5, v4, v3
    v_lshl_add_u32 v5, v5, 4, v7
    v_xor_b32 v16, 0, v5
    v_xor_b32 v17, 32, v5
    v_xor_b32 v18, 64, v5
    v_xor_b32 v19, 96, v5
    v_xor_b32 v20, 128, v5
    v_xor_b32 v21, 160, v5
    v_xor_b32 v22, 192, v5
    v_xor_b32 v23, 224, v5
    v_add_u32 v29, 7168, v29
    v_add_u32 v30, 14336, v30
    v_add_u32 v31, 21504, v31
    v_add_u32 v17, 7168, v17
    v_add_u32 v18, 14336, v18
    v_add_u32 v19, 21504, v19
    v_add_u32 v21, 7168, v21
    v_add_u32 v22, 14336, v22
    v_add_u32 v23, 21504, v23
    v_lshrrev_b32 v5, 3, v2
    v_mul_u32_u24 v5, 896, v5
    v_lshrrev_b32 v6, 3, v2
    v_and_b32 v6, 6, v6
    v_and_b32 v7, 7, v2
    v_xor_b32 v6, v6, v7
    v_lshl_add_u32 v24, v6, 4, v5
    v_add_u32 v25, 6144, v24
    v_add_u32 v26, 12288, v24
    v_add_u32 v27, 18432, v24
    s_mov_b32 s19, 32768
    s_mov_b32 s20, 65536
    s_mov_b32 s21, s34
    s_mov_b32 s22, s34
    s_mov_b32 s25, 0
    s_waitcnt vmcnt(30)
    s_barrier
    s_mov_b32 m0, 8192
    s_add_u32 s23, s96, 0
    s_waitcnt vmcnt(56)
    buffer_load_dwordx4 v36, s[36:39], s23 offen offset:0  lds
    buffer_load_dwordx4 v37, s[36:39], s23 offen offset:1024  lds
    buffer_load_dwordx4 v38, s[36:39], s23 offen offset:2048  lds
    buffer_load_dwordx4 v39, s[36:39], s23 offen offset:3072  lds
    s_mov_b32 m0, 40960
    s_add_u32 s23, s96, 28672
    s_waitcnt vmcnt(56)
    buffer_load_dwordx4 v36, s[36:39], s23 offen offset:0  lds
    buffer_load_dwordx4 v37, s[36:39], s23 offen offset:1024  lds
    buffer_load_dwordx4 v38, s[36:39], s23 offen offset:2048  lds
    buffer_load_dwordx4 v39, s[36:39], s23 offen offset:3072  lds
    s_mov_b32 m0, 73728
    s_add_u32 s23, s96, 57344
    s_waitcnt vmcnt(56)
    buffer_load_dwordx4 v36, s[36:39], s23 offen offset:0  lds
    buffer_load_dwordx4 v37, s[36:39], s23 offen offset:1024  lds
    buffer_load_dwordx4 v38, s[36:39], s23 offen offset:2048  lds
    buffer_load_dwordx4 v39, s[36:39], s23 offen offset:3072  lds
    s_mov_b32 m0, 147456
    s_lshl_b32 s23, s96, 12
    s_add_u32 s23, s23, 0
    s_waitcnt vmcnt(56)
    buffer_load_dwordx4 v40, s[48:51], s23 offen offset:0  lds
    buffer_load_dwordx4 v41, s[48:51], s23 offen offset:1024  lds
    buffer_load_dwordx4 v42, s[48:51], s23 offen offset:2048  lds
    buffer_load_dwordx4 v43, s[48:51], s23 offen offset:3072  lds
    s_mov_b32 m0, 151552
    s_lshl_b32 s23, s96, 12
    s_add_u32 s23, s23, 131072
    s_waitcnt vmcnt(56)
    buffer_load_dwordx4 v40, s[48:51], s23 offen offset:0  lds
    buffer_load_dwordx4 v41, s[48:51], s23 offen offset:1024  lds
    buffer_load_dwordx4 v42, s[48:51], s23 offen offset:2048  lds
    buffer_load_dwordx4 v43, s[48:51], s23 offen offset:3072  lds
    s_mov_b32 m0, 155648
    s_lshl_b32 s23, s96, 12
    s_add_u32 s23, s23, 262144
    s_waitcnt vmcnt(56)
    buffer_load_dwordx4 v40, s[48:51], s23 offen offset:0  lds
    buffer_load_dwordx4 v41, s[48:51], s23 offen offset:1024  lds
    buffer_load_dwordx4 v42, s[48:51], s23 offen offset:2048  lds
    buffer_load_dwordx4 v43, s[48:51], s23 offen offset:3072  lds
    s_mov_b32 m0, 159744
    s_lshl_b32 s23, s96, 12
    s_add_u32 s23, s23, 393216
    s_waitcnt vmcnt(56)
    buffer_load_dwordx4 v40, s[48:51], s23 offen offset:0  lds
    buffer_load_dwordx4 v41, s[48:51], s23 offen offset:1024  lds
    buffer_load_dwordx4 v42, s[48:51], s23 offen offset:2048  lds
    buffer_load_dwordx4 v43, s[48:51], s23 offen offset:3072  lds
    s_mov_b32 m0, 12288
    s_add_u32 s23, s97, 0
    s_waitcnt vmcnt(56)
    buffer_load_dwordx4 v36, s[36:39], s23 offen offset:0  lds
    buffer_load_dwordx4 v37, s[36:39], s23 offen offset:1024  lds
    buffer_load_dwordx4 v38, s[36:39], s23 offen offset:2048  lds
    buffer_load_dwordx4 v39, s[36:39], s23 offen offset:3072  lds
    s_mov_b32 m0, 45056
    s_add_u32 s23, s97, 28672
    s_waitcnt vmcnt(56)
    buffer_load_dwordx4 v36, s[36:39], s23 offen offset:0  lds
    buffer_load_dwordx4 v37, s[36:39], s23 offen offset:1024  lds
    buffer_load_dwordx4 v38, s[36:39], s23 offen offset:2048  lds
    buffer_load_dwordx4 v39, s[36:39], s23 offen offset:3072  lds
    s_mov_b32 m0, 77824
    s_add_u32 s23, s97, 57344
    s_waitcnt vmcnt(56)
    buffer_load_dwordx4 v36, s[36:39], s23 offen offset:0  lds
    buffer_load_dwordx4 v37, s[36:39], s23 offen offset:1024  lds
    buffer_load_dwordx4 v38, s[36:39], s23 offen offset:2048  lds
    buffer_load_dwordx4 v39, s[36:39], s23 offen offset:3072  lds
    s_mov_b32 m0, 81920
    s_lshl_b32 s23, s97, 12
    s_add_u32 s23, s23, 0
    s_waitcnt vmcnt(56)
    buffer_load_dwordx4 v40, s[48:51], s23 offen offset:0  lds
    buffer_load_dwordx4 v41, s[48:51], s23 offen offset:1024  lds
    buffer_load_dwordx4 v42, s[48:51], s23 offen offset:2048  lds
    buffer_load_dwordx4 v43, s[48:51], s23 offen offset:3072  lds
    s_mov_b32 m0, 86016
    s_lshl_b32 s23, s97, 12
    s_add_u32 s23, s23, 131072
    s_waitcnt vmcnt(56)
    buffer_load_dwordx4 v40, s[48:51], s23 offen offset:0  lds
    buffer_load_dwordx4 v41, s[48:51], s23 offen offset:1024  lds
    buffer_load_dwordx4 v42, s[48:51], s23 offen offset:2048  lds
    buffer_load_dwordx4 v43, s[48:51], s23 offen offset:3072  lds
    s_mov_b32 m0, 90112
    s_lshl_b32 s23, s97, 12
    s_add_u32 s23, s23, 262144
    s_waitcnt vmcnt(56)
    buffer_load_dwordx4 v40, s[48:51], s23 offen offset:0  lds
    buffer_load_dwordx4 v41, s[48:51], s23 offen offset:1024  lds
    buffer_load_dwordx4 v42, s[48:51], s23 offen offset:2048  lds
    buffer_load_dwordx4 v43, s[48:51], s23 offen offset:3072  lds
    s_mov_b32 m0, 94208
    s_lshl_b32 s23, s97, 12
    s_add_u32 s23, s23, 393216
    s_waitcnt vmcnt(56)
    buffer_load_dwordx4 v40, s[48:51], s23 offen offset:0  lds
    buffer_load_dwordx4 v41, s[48:51], s23 offen offset:1024  lds
    buffer_load_dwordx4 v42, s[48:51], s23 offen offset:2048  lds
    buffer_load_dwordx4 v43, s[48:51], s23 offen offset:3072  lds
    s_waitcnt vmcnt(56)
    v_lshrrev_b32 v5, 4, v2
    v_add_u32 v5, 0, v5
    v_min_u32 v5, 6, v5
    v_lshl_add_u32 v5, v5, 7, s94
    v_subrev_u32 v6, 896, v5
    v_min_u32 v5, v5, v6
    v_lshl_add_u32 v34, v5, 12, v45
    s_lshl_b32 s23, s29, 16
    buffer_load_dword v44, v34, s[48:51], s23 offen offset:256
    s_waitcnt vmcnt(56)
    v_lshrrev_b32 v5, 4, v2
    v_add_u32 v5, 4, v5
    v_min_u32 v5, 6, v5
    v_lshl_add_u32 v5, v5, 7, s94
    v_subrev_u32 v6, 896, v5
    v_min_u32 v5, v5, v6
    v_lshl_add_u32 v34, v5, 12, v45
    s_lshl_b32 s23, s29, 16
    buffer_load_dword v44, v34, s[48:51], s23 offen offset:256
    s_waitcnt vmcnt(58)
    s_barrier
    s_mov_b32 m0, 98304
    s_add_u32 s23, s98, 0
    s_waitcnt vmcnt(56)
    buffer_load_dwordx4 v36, s[36:39], s23 offen offset:0  lds
    buffer_load_dwordx4 v37, s[36:39], s23 offen offset:1024  lds
    buffer_load_dwordx4 v38, s[36:39], s23 offen offset:2048  lds
    buffer_load_dwordx4 v39, s[36:39], s23 offen offset:3072  lds
    s_mov_b32 m0, 114688
    s_add_u32 s23, s98, 28672
    s_waitcnt vmcnt(56)
    buffer_load_dwordx4 v36, s[36:39], s23 offen offset:0  lds
    buffer_load_dwordx4 v37, s[36:39], s23 offen offset:1024  lds
    buffer_load_dwordx4 v38, s[36:39], s23 offen offset:2048  lds
    buffer_load_dwordx4 v39, s[36:39], s23 offen offset:3072  lds
    s_mov_b32 m0, 131072
    s_add_u32 s23, s98, 57344
    s_waitcnt vmcnt(56)
    buffer_load_dwordx4 v36, s[36:39], s23 offen offset:0  lds
    buffer_load_dwordx4 v37, s[36:39], s23 offen offset:1024  lds
    buffer_load_dwordx4 v38, s[36:39], s23 offen offset:2048  lds
    buffer_load_dwordx4 v39, s[36:39], s23 offen offset:3072  lds
    s_mov_b32 m0, 16384
    s_lshl_b32 s23, s98, 12
    s_add_u32 s23, s23, 0
    s_waitcnt vmcnt(56)
    buffer_load_dwordx4 v40, s[48:51], s23 offen offset:0  lds
    buffer_load_dwordx4 v41, s[48:51], s23 offen offset:1024  lds
    buffer_load_dwordx4 v42, s[48:51], s23 offen offset:2048  lds
    buffer_load_dwordx4 v43, s[48:51], s23 offen offset:3072  lds
    s_mov_b32 m0, 20480
    s_lshl_b32 s23, s98, 12
    s_add_u32 s23, s23, 131072
    s_waitcnt vmcnt(56)
    buffer_load_dwordx4 v40, s[48:51], s23 offen offset:0  lds
    buffer_load_dwordx4 v41, s[48:51], s23 offen offset:1024  lds
    buffer_load_dwordx4 v42, s[48:51], s23 offen offset:2048  lds
    buffer_load_dwordx4 v43, s[48:51], s23 offen offset:3072  lds
    s_mov_b32 m0, 24576
    s_lshl_b32 s23, s98, 12
    s_add_u32 s23, s23, 262144
    s_waitcnt vmcnt(56)
    buffer_load_dwordx4 v40, s[48:51], s23 offen offset:0  lds
    buffer_load_dwordx4 v41, s[48:51], s23 offen offset:1024  lds
    buffer_load_dwordx4 v42, s[48:51], s23 offen offset:2048  lds
    buffer_load_dwordx4 v43, s[48:51], s23 offen offset:3072  lds
    s_mov_b32 m0, 28672
    s_lshl_b32 s23, s98, 12
    s_add_u32 s23, s23, 393216
    s_waitcnt vmcnt(56)
    buffer_load_dwordx4 v40, s[48:51], s23 offen offset:0  lds
    buffer_load_dwordx4 v41, s[48:51], s23 offen offset:1024  lds
    buffer_load_dwordx4 v42, s[48:51], s23 offen offset:2048  lds
    buffer_load_dwordx4 v43, s[48:51], s23 offen offset:3072  lds
    s_waitcnt vmcnt(58)
    s_barrier
    s_mov_b32 m0, 102400
    s_add_u32 s23, s99, 0
    s_waitcnt vmcnt(56)
    buffer_load_dwordx4 v36, s[36:39], s23 offen offset:0  lds
    buffer_load_dwordx4 v37, s[36:39], s23 offen offset:1024  lds
    buffer_load_dwordx4 v38, s[36:39], s23 offen offset:2048  lds
    buffer_load_dwordx4 v39, s[36:39], s23 offen offset:3072  lds
    s_mov_b32 m0, 118784
    s_add_u32 s23, s99, 28672
    s_waitcnt vmcnt(56)
    buffer_load_dwordx4 v36, s[36:39], s23 offen offset:0  lds
    buffer_load_dwordx4 v37, s[36:39], s23 offen offset:1024  lds
    buffer_load_dwordx4 v38, s[36:39], s23 offen offset:2048  lds
    buffer_load_dwordx4 v39, s[36:39], s23 offen offset:3072  lds
    s_mov_b32 m0, 135168
    s_add_u32 s23, s99, 57344
    s_waitcnt vmcnt(56)
    buffer_load_dwordx4 v36, s[36:39], s23 offen offset:0  lds
    buffer_load_dwordx4 v37, s[36:39], s23 offen offset:1024  lds
    buffer_load_dwordx4 v38, s[36:39], s23 offen offset:2048  lds
    buffer_load_dwordx4 v39, s[36:39], s23 offen offset:3072  lds
    s_mov_b32 m0, 49152
    s_lshl_b32 s23, s99, 12
    s_add_u32 s23, s23, 0
    s_waitcnt vmcnt(56)
    buffer_load_dwordx4 v40, s[48:51], s23 offen offset:0  lds
    buffer_load_dwordx4 v41, s[48:51], s23 offen offset:1024  lds
    buffer_load_dwordx4 v42, s[48:51], s23 offen offset:2048  lds
    buffer_load_dwordx4 v43, s[48:51], s23 offen offset:3072  lds
    s_mov_b32 m0, 53248
    s_lshl_b32 s23, s99, 12
    s_add_u32 s23, s23, 131072
    s_waitcnt vmcnt(56)
    buffer_load_dwordx4 v40, s[48:51], s23 offen offset:0  lds
    buffer_load_dwordx4 v41, s[48:51], s23 offen offset:1024  lds
    buffer_load_dwordx4 v42, s[48:51], s23 offen offset:2048  lds
    buffer_load_dwordx4 v43, s[48:51], s23 offen offset:3072  lds
    s_mov_b32 m0, 57344
    s_lshl_b32 s23, s99, 12
    s_add_u32 s23, s23, 262144
    s_waitcnt vmcnt(56)
    buffer_load_dwordx4 v40, s[48:51], s23 offen offset:0  lds
    buffer_load_dwordx4 v41, s[48:51], s23 offen offset:1024  lds
    buffer_load_dwordx4 v42, s[48:51], s23 offen offset:2048  lds
    buffer_load_dwordx4 v43, s[48:51], s23 offen offset:3072  lds
    s_mov_b32 m0, 61440
    s_lshl_b32 s23, s99, 12
    s_add_u32 s23, s23, 393216
    s_waitcnt vmcnt(56)
    buffer_load_dwordx4 v40, s[48:51], s23 offen offset:0  lds
    buffer_load_dwordx4 v41, s[48:51], s23 offen offset:1024  lds
    buffer_load_dwordx4 v42, s[48:51], s23 offen offset:2048  lds
    buffer_load_dwordx4 v43, s[48:51], s23 offen offset:3072  lds
    s_waitcnt vmcnt(58)
    s_barrier
    s_mov_b32 m0, 106496
    s_add_u32 s23, s100, 0
    s_waitcnt vmcnt(56)
    buffer_load_dwordx4 v36, s[36:39], s23 offen offset:0  lds
    buffer_load_dwordx4 v37, s[36:39], s23 offen offset:1024  lds
    buffer_load_dwordx4 v38, s[36:39], s23 offen offset:2048  lds
    buffer_load_dwordx4 v39, s[36:39], s23 offen offset:3072  lds
    s_mov_b32 m0, 122880
    s_add_u32 s23, s100, 28672
    s_waitcnt vmcnt(56)
    buffer_load_dwordx4 v36, s[36:39], s23 offen offset:0  lds
    buffer_load_dwordx4 v37, s[36:39], s23 offen offset:1024  lds
    buffer_load_dwordx4 v38, s[36:39], s23 offen offset:2048  lds
    buffer_load_dwordx4 v39, s[36:39], s23 offen offset:3072  lds
    s_mov_b32 m0, 139264
    s_add_u32 s23, s100, 57344
    s_waitcnt vmcnt(56)
    buffer_load_dwordx4 v36, s[36:39], s23 offen offset:0  lds
    buffer_load_dwordx4 v37, s[36:39], s23 offen offset:1024  lds
    buffer_load_dwordx4 v38, s[36:39], s23 offen offset:2048  lds
    buffer_load_dwordx4 v39, s[36:39], s23 offen offset:3072  lds
    s_mov_b32 m0, 147456
    s_lshl_b32 s23, s100, 12
    s_add_u32 s23, s23, 0
    s_waitcnt vmcnt(56)
    buffer_load_dwordx4 v40, s[48:51], s23 offen offset:0  lds
    buffer_load_dwordx4 v41, s[48:51], s23 offen offset:1024  lds
    buffer_load_dwordx4 v42, s[48:51], s23 offen offset:2048  lds
    buffer_load_dwordx4 v43, s[48:51], s23 offen offset:3072  lds
    s_mov_b32 m0, 151552
    s_lshl_b32 s23, s100, 12
    s_add_u32 s23, s23, 131072
    s_waitcnt vmcnt(56)
    buffer_load_dwordx4 v40, s[48:51], s23 offen offset:0  lds
    buffer_load_dwordx4 v41, s[48:51], s23 offen offset:1024  lds
    buffer_load_dwordx4 v42, s[48:51], s23 offen offset:2048  lds
    buffer_load_dwordx4 v43, s[48:51], s23 offen offset:3072  lds
    s_mov_b32 m0, 155648
    s_lshl_b32 s23, s100, 12
    s_add_u32 s23, s23, 262144
    s_waitcnt vmcnt(56)
    buffer_load_dwordx4 v40, s[48:51], s23 offen offset:0  lds
    buffer_load_dwordx4 v41, s[48:51], s23 offen offset:1024  lds
    buffer_load_dwordx4 v42, s[48:51], s23 offen offset:2048  lds
    buffer_load_dwordx4 v43, s[48:51], s23 offen offset:3072  lds
    s_mov_b32 m0, 159744
    s_lshl_b32 s23, s100, 12
    s_add_u32 s23, s23, 393216
    s_waitcnt vmcnt(56)
    buffer_load_dwordx4 v40, s[48:51], s23 offen offset:0  lds
    buffer_load_dwordx4 v41, s[48:51], s23 offen offset:1024  lds
    buffer_load_dwordx4 v42, s[48:51], s23 offen offset:2048  lds
    buffer_load_dwordx4 v43, s[48:51], s23 offen offset:3072  lds
    s_waitcnt vmcnt(56)
    s_barrier
    s_mov_b32 m0, 32768
    s_lshl_b32 s23, s94, 12
    s_add_u32 s23, s23, 256
    s_waitcnt vmcnt(56)
    buffer_load_dwordx4 v40, s[48:51], s23 offen offset:0  lds
    buffer_load_dwordx4 v41, s[48:51], s23 offen offset:1024  lds
    buffer_load_dwordx4 v42, s[48:51], s23 offen offset:2048  lds
    buffer_load_dwordx4 v43, s[48:51], s23 offen offset:3072  lds
    s_mov_b32 m0, 36864
    s_lshl_b32 s23, s94, 12
    s_add_u32 s23, s23, 131328
    s_waitcnt vmcnt(56)
    buffer_load_dwordx4 v40, s[48:51], s23 offen offset:0  lds
    buffer_load_dwordx4 v41, s[48:51], s23 offen offset:1024  lds
    buffer_load_dwordx4 v42, s[48:51], s23 offen offset:2048  lds
    buffer_load_dwordx4 v43, s[48:51], s23 offen offset:3072  lds
    s_mov_b32 m0, 40960
    s_lshl_b32 s23, s94, 12
    s_add_u32 s23, s23, 262400
    s_waitcnt vmcnt(56)
    buffer_load_dwordx4 v40, s[48:51], s23 offen offset:0  lds
    buffer_load_dwordx4 v41, s[48:51], s23 offen offset:1024  lds
    buffer_load_dwordx4 v42, s[48:51], s23 offen offset:2048  lds
    buffer_load_dwordx4 v43, s[48:51], s23 offen offset:3072  lds
    s_mov_b32 m0, 45056
    s_lshl_b32 s23, s94, 12
    s_add_u32 s23, s23, 393472
    s_waitcnt vmcnt(56)
    buffer_load_dwordx4 v40, s[48:51], s23 offen offset:0  lds
    buffer_load_dwordx4 v41, s[48:51], s23 offen offset:1024  lds
    buffer_load_dwordx4 v42, s[48:51], s23 offen offset:2048  lds
    buffer_load_dwordx4 v43, s[48:51], s23 offen offset:3072  lds
    s_mov_b32 m0, 65536
    s_lshl_b32 s23, s95, 12
    s_add_u32 s23, s23, 256
    s_waitcnt vmcnt(56)
    buffer_load_dwordx4 v40, s[48:51], s23 offen offset:0  lds
    buffer_load_dwordx4 v41, s[48:51], s23 offen offset:1024  lds
    buffer_load_dwordx4 v42, s[48:51], s23 offen offset:2048  lds
    buffer_load_dwordx4 v43, s[48:51], s23 offen offset:3072  lds
    s_mov_b32 m0, 69632
    s_lshl_b32 s23, s95, 12
    s_add_u32 s23, s23, 131328
    s_waitcnt vmcnt(56)
    buffer_load_dwordx4 v40, s[48:51], s23 offen offset:0  lds
    buffer_load_dwordx4 v41, s[48:51], s23 offen offset:1024  lds
    buffer_load_dwordx4 v42, s[48:51], s23 offen offset:2048  lds
    buffer_load_dwordx4 v43, s[48:51], s23 offen offset:3072  lds
    s_mov_b32 m0, 73728
    s_lshl_b32 s23, s95, 12
    s_add_u32 s23, s23, 262400
    s_waitcnt vmcnt(56)
    buffer_load_dwordx4 v40, s[48:51], s23 offen offset:0  lds
    buffer_load_dwordx4 v41, s[48:51], s23 offen offset:1024  lds
    buffer_load_dwordx4 v42, s[48:51], s23 offen offset:2048  lds
    buffer_load_dwordx4 v43, s[48:51], s23 offen offset:3072  lds
    s_mov_b32 m0, 77824
    s_lshl_b32 s23, s95, 12
    s_add_u32 s23, s23, 393472
    s_waitcnt vmcnt(56)
    buffer_load_dwordx4 v40, s[48:51], s23 offen offset:0  lds
    buffer_load_dwordx4 v41, s[48:51], s23 offen offset:1024  lds
    buffer_load_dwordx4 v42, s[48:51], s23 offen offset:2048  lds
    buffer_load_dwordx4 v43, s[48:51], s23 offen offset:3072  lds
    s_waitcnt vmcnt(60)
    s_barrier
    s_mov_b32 m0, 0
    s_lshl_b32 s23, s96, 12
    s_add_u32 s23, s23, 256
    s_waitcnt vmcnt(56)
    buffer_load_dwordx4 v40, s[48:51], s23 offen offset:0  lds
    buffer_load_dwordx4 v41, s[48:51], s23 offen offset:1024  lds
    buffer_load_dwordx4 v42, s[48:51], s23 offen offset:2048  lds
    buffer_load_dwordx4 v43, s[48:51], s23 offen offset:3072  lds
    s_mov_b32 m0, 4096
    s_lshl_b32 s23, s96, 12
    s_add_u32 s23, s23, 131328
    s_waitcnt vmcnt(56)
    buffer_load_dwordx4 v40, s[48:51], s23 offen offset:0  lds
    buffer_load_dwordx4 v41, s[48:51], s23 offen offset:1024  lds
    buffer_load_dwordx4 v42, s[48:51], s23 offen offset:2048  lds
    buffer_load_dwordx4 v43, s[48:51], s23 offen offset:3072  lds
    s_mov_b32 m0, 8192
    s_lshl_b32 s23, s96, 12
    s_add_u32 s23, s23, 262400
    s_waitcnt vmcnt(56)
    buffer_load_dwordx4 v40, s[48:51], s23 offen offset:0  lds
    buffer_load_dwordx4 v41, s[48:51], s23 offen offset:1024  lds
    buffer_load_dwordx4 v42, s[48:51], s23 offen offset:2048  lds
    buffer_load_dwordx4 v43, s[48:51], s23 offen offset:3072  lds
    s_mov_b32 m0, 12288
    s_lshl_b32 s23, s96, 12
    s_add_u32 s23, s23, 393472
    s_waitcnt vmcnt(56)
    buffer_load_dwordx4 v40, s[48:51], s23 offen offset:0  lds
    buffer_load_dwordx4 v41, s[48:51], s23 offen offset:1024  lds
    buffer_load_dwordx4 v42, s[48:51], s23 offen offset:2048  lds
    buffer_load_dwordx4 v43, s[48:51], s23 offen offset:3072  lds
    s_mov_b32 m0, 81920
    s_lshl_b32 s23, s97, 12
    s_add_u32 s23, s23, 256
    s_waitcnt vmcnt(56)
    buffer_load_dwordx4 v40, s[48:51], s23 offen offset:0  lds
    buffer_load_dwordx4 v41, s[48:51], s23 offen offset:1024  lds
    buffer_load_dwordx4 v42, s[48:51], s23 offen offset:2048  lds
    buffer_load_dwordx4 v43, s[48:51], s23 offen offset:3072  lds
    s_mov_b32 m0, 86016
    s_lshl_b32 s23, s97, 12
    s_add_u32 s23, s23, 131328
    s_waitcnt vmcnt(56)
    buffer_load_dwordx4 v40, s[48:51], s23 offen offset:0  lds
    buffer_load_dwordx4 v41, s[48:51], s23 offen offset:1024  lds
    buffer_load_dwordx4 v42, s[48:51], s23 offen offset:2048  lds
    buffer_load_dwordx4 v43, s[48:51], s23 offen offset:3072  lds
    s_mov_b32 m0, 90112
    s_lshl_b32 s23, s97, 12
    s_add_u32 s23, s23, 262400
    s_waitcnt vmcnt(56)
    buffer_load_dwordx4 v40, s[48:51], s23 offen offset:0  lds
    buffer_load_dwordx4 v41, s[48:51], s23 offen offset:1024  lds
    buffer_load_dwordx4 v42, s[48:51], s23 offen offset:2048  lds
    buffer_load_dwordx4 v43, s[48:51], s23 offen offset:3072  lds
    s_mov_b32 m0, 94208
    s_lshl_b32 s23, s97, 12
    s_add_u32 s23, s23, 393472
    s_waitcnt vmcnt(56)
    buffer_load_dwordx4 v40, s[48:51], s23 offen offset:0  lds
    buffer_load_dwordx4 v41, s[48:51], s23 offen offset:1024  lds
    buffer_load_dwordx4 v42, s[48:51], s23 offen offset:2048  lds
    buffer_load_dwordx4 v43, s[48:51], s23 offen offset:3072  lds
    s_waitcnt vmcnt(63)
    s_barrier
    s_mov_b32 m0, 16384
    s_lshl_b32 s23, s98, 12
    s_add_u32 s23, s23, 256
    s_waitcnt vmcnt(56)
    buffer_load_dwordx4 v40, s[48:51], s23 offen offset:0  lds
    buffer_load_dwordx4 v41, s[48:51], s23 offen offset:1024  lds
    buffer_load_dwordx4 v42, s[48:51], s23 offen offset:2048  lds
    buffer_load_dwordx4 v43, s[48:51], s23 offen offset:3072  lds
    s_mov_b32 m0, 20480
    s_lshl_b32 s23, s98, 12
    s_add_u32 s23, s23, 131328
    s_waitcnt vmcnt(56)
    buffer_load_dwordx4 v40, s[48:51], s23 offen offset:0  lds
    buffer_load_dwordx4 v41, s[48:51], s23 offen offset:1024  lds
    buffer_load_dwordx4 v42, s[48:51], s23 offen offset:2048  lds
    buffer_load_dwordx4 v43, s[48:51], s23 offen offset:3072  lds
    s_mov_b32 m0, 24576
    s_lshl_b32 s23, s98, 12
    s_add_u32 s23, s23, 262400
    s_waitcnt vmcnt(56)
    buffer_load_dwordx4 v40, s[48:51], s23 offen offset:0  lds
    buffer_load_dwordx4 v41, s[48:51], s23 offen offset:1024  lds
    buffer_load_dwordx4 v42, s[48:51], s23 offen offset:2048  lds
    buffer_load_dwordx4 v43, s[48:51], s23 offen offset:3072  lds
    s_mov_b32 m0, 28672
    s_lshl_b32 s23, s98, 12
    s_add_u32 s23, s23, 393472
    s_waitcnt vmcnt(56)
    buffer_load_dwordx4 v40, s[48:51], s23 offen offset:0  lds
    buffer_load_dwordx4 v41, s[48:51], s23 offen offset:1024  lds
    buffer_load_dwordx4 v42, s[48:51], s23 offen offset:2048  lds
    buffer_load_dwordx4 v43, s[48:51], s23 offen offset:3072  lds
    s_mov_b32 m0, 49152
    s_lshl_b32 s23, s99, 12
    s_add_u32 s23, s23, 256
    s_waitcnt vmcnt(56)
    buffer_load_dwordx4 v40, s[48:51], s23 offen offset:0  lds
    buffer_load_dwordx4 v41, s[48:51], s23 offen offset:1024  lds
    buffer_load_dwordx4 v42, s[48:51], s23 offen offset:2048  lds
    buffer_load_dwordx4 v43, s[48:51], s23 offen offset:3072  lds
    s_mov_b32 m0, 53248
    s_lshl_b32 s23, s99, 12
    s_add_u32 s23, s23, 131328
    s_waitcnt vmcnt(56)
    buffer_load_dwordx4 v40, s[48:51], s23 offen offset:0  lds
    buffer_load_dwordx4 v41, s[48:51], s23 offen offset:1024  lds
    buffer_load_dwordx4 v42, s[48:51], s23 offen offset:2048  lds
    buffer_load_dwordx4 v43, s[48:51], s23 offen offset:3072  lds
    s_waitcnt vmcnt(63)
    s_barrier
    s_mov_b32 m0, 57344
    s_lshl_b32 s23, s99, 12
    s_add_u32 s23, s23, 262400
    s_waitcnt vmcnt(56)
    buffer_load_dwordx4 v40, s[48:51], s23 offen offset:0  lds
    buffer_load_dwordx4 v41, s[48:51], s23 offen offset:1024  lds
    buffer_load_dwordx4 v42, s[48:51], s23 offen offset:2048  lds
    buffer_load_dwordx4 v43, s[48:51], s23 offen offset:3072  lds
    s_mov_b32 m0, 61440
    s_lshl_b32 s23, s99, 12
    s_add_u32 s23, s23, 393472
    s_waitcnt vmcnt(56)
    buffer_load_dwordx4 v40, s[48:51], s23 offen offset:0  lds
    buffer_load_dwordx4 v41, s[48:51], s23 offen offset:1024  lds
    buffer_load_dwordx4 v42, s[48:51], s23 offen offset:2048  lds
    buffer_load_dwordx4 v43, s[48:51], s23 offen offset:3072  lds
    s_mov_b32 m0, 147456
    s_lshl_b32 s23, s100, 12
    s_add_u32 s23, s23, 256
    s_waitcnt vmcnt(56)
    buffer_load_dwordx4 v40, s[48:51], s23 offen offset:0  lds
    buffer_load_dwordx4 v41, s[48:51], s23 offen offset:1024  lds
    buffer_load_dwordx4 v42, s[48:51], s23 offen offset:2048  lds
    buffer_load_dwordx4 v43, s[48:51], s23 offen offset:3072  lds
    s_mov_b32 m0, 151552
    s_lshl_b32 s23, s100, 12
    s_add_u32 s23, s23, 131328
    s_waitcnt vmcnt(56)
    buffer_load_dwordx4 v40, s[48:51], s23 offen offset:0  lds
    buffer_load_dwordx4 v41, s[48:51], s23 offen offset:1024  lds
    buffer_load_dwordx4 v42, s[48:51], s23 offen offset:2048  lds
    buffer_load_dwordx4 v43, s[48:51], s23 offen offset:3072  lds
    s_mov_b32 m0, 155648
    s_lshl_b32 s23, s100, 12
    s_add_u32 s23, s23, 262400
    s_waitcnt vmcnt(56)
    buffer_load_dwordx4 v40, s[48:51], s23 offen offset:0  lds
    buffer_load_dwordx4 v41, s[48:51], s23 offen offset:1024  lds
    buffer_load_dwordx4 v42, s[48:51], s23 offen offset:2048  lds
    buffer_load_dwordx4 v43, s[48:51], s23 offen offset:3072  lds
    s_mov_b32 m0, 159744
    s_lshl_b32 s23, s100, 12
    s_add_u32 s23, s23, 393472
    s_waitcnt vmcnt(56)
    buffer_load_dwordx4 v40, s[48:51], s23 offen offset:0  lds
    buffer_load_dwordx4 v41, s[48:51], s23 offen offset:1024  lds
    buffer_load_dwordx4 v42, s[48:51], s23 offen offset:2048  lds
    buffer_load_dwordx4 v43, s[48:51], s23 offen offset:3072  lds
    s_mov_b32 m0, 114688
    s_add_u32 s23, s21, 0
    s_waitcnt vmcnt(56)
    buffer_load_dwordx4 v16, s[40:43], s23 offen offset:0 nt lds
    buffer_load_dwordx4 v17, s[40:43], s23 offen offset:1024 nt lds
    buffer_load_dwordx4 v18, s[40:43], s23 offen offset:2048 nt lds
    buffer_load_dwordx4 v19, s[40:43], s23 offen offset:3072 nt lds
    s_mov_b32 m0, 118784
    s_add_u32 s23, s21, 32768
    s_waitcnt vmcnt(56)
    buffer_load_dwordx4 v20, s[40:43], s23 offen offset:0 nt lds
    buffer_load_dwordx4 v21, s[40:43], s23 offen offset:1024 nt lds
    buffer_load_dwordx4 v22, s[40:43], s23 offen offset:2048 nt lds
    buffer_load_dwordx4 v23, s[40:43], s23 offen offset:3072 nt lds
    s_mov_b32 m0, 122880
    s_add_u32 s23, s21, 65536
    s_waitcnt vmcnt(56)
    buffer_load_dwordx4 v16, s[40:43], s23 offen offset:0 nt lds
    buffer_load_dwordx4 v17, s[40:43], s23 offen offset:1024 nt lds
    buffer_load_dwordx4 v18, s[40:43], s23 offen offset:2048 nt lds
    buffer_load_dwordx4 v19, s[40:43], s23 offen offset:3072 nt lds
    s_mov_b32 m0, 126976
    s_add_u32 s23, s21, 98304
    s_waitcnt vmcnt(56)
    buffer_load_dwordx4 v20, s[40:43], s23 offen offset:0 nt lds
    buffer_load_dwordx4 v21, s[40:43], s23 offen offset:1024 nt lds
    buffer_load_dwordx4 v22, s[40:43], s23 offen offset:2048 nt lds
    buffer_load_dwordx4 v23, s[40:43], s23 offen offset:3072 nt lds
    s_or_b32 s21, s21, 0x1f000
    s_add_u32 s21, s21, 512
    s_and_b32 s21, s21, 0x60e00
    s_waitcnt vmcnt(63)
    s_barrier
    s_mov_b32 m0, 131072
    s_add_u32 s23, s21, 0
    s_waitcnt vmcnt(56)
    buffer_load_dwordx4 v16, s[40:43], s23 offen offset:0 nt lds
    buffer_load_dwordx4 v17, s[40:43], s23 offen offset:1024 nt lds
    buffer_load_dwordx4 v18, s[40:43], s23 offen offset:2048 nt lds
    buffer_load_dwordx4 v19, s[40:43], s23 offen offset:3072 nt lds
    s_mov_b32 m0, 135168
    s_add_u32 s23, s21, 32768
    s_waitcnt vmcnt(56)
    buffer_load_dwordx4 v20, s[40:43], s23 offen offset:0 nt lds
    buffer_load_dwordx4 v21, s[40:43], s23 offen offset:1024 nt lds
    buffer_load_dwordx4 v22, s[40:43], s23 offen offset:2048 nt lds
    buffer_load_dwordx4 v23, s[40:43], s23 offen offset:3072 nt lds
    s_mov_b32 m0, 139264
    s_add_u32 s23, s21, 65536
    s_waitcnt vmcnt(56)
    buffer_load_dwordx4 v16, s[40:43], s23 offen offset:0 nt lds
    buffer_load_dwordx4 v17, s[40:43], s23 offen offset:1024 nt lds
    buffer_load_dwordx4 v18, s[40:43], s23 offen offset:2048 nt lds
    buffer_load_dwordx4 v19, s[40:43], s23 offen offset:3072 nt lds
    s_waitcnt vmcnt(63)
    s_barrier
    s_mov_b32 m0, 143360
    s_add_u32 s23, s21, 98304
    s_waitcnt vmcnt(56)
    buffer_load_dwordx4 v20, s[40:43], s23 offen offset:0 nt lds
    buffer_load_dwordx4 v21, s[40:43], s23 offen offset:1024 nt lds
    buffer_load_dwordx4 v22, s[40:43], s23 offen offset:2048 nt lds
    buffer_load_dwordx4 v23, s[40:43], s23 offen offset:3072 nt lds
    s_or_b32 s21, s21, 0x1f000
    s_add_u32 s21, s21, 512
    s_and_b32 s21, s21, 0x60e00
    s_mov_b32 m0, 98304
    s_add_u32 s23, s22, 0
    s_waitcnt vmcnt(56)
    buffer_load_dwordx4 v28, s[44:47], s23 offen offset:0 nt lds
    buffer_load_dwordx4 v29, s[44:47], s23 offen offset:1024 nt lds
    buffer_load_dwordx4 v30, s[44:47], s23 offen offset:2048 nt lds
    buffer_load_dwordx4 v31, s[44:47], s23 offen offset:3072 nt lds
    s_mov_b32 m0, 102400
    s_add_u32 s23, s22, 32768
    s_waitcnt vmcnt(56)
    buffer_load_dwordx4 v28, s[44:47], s23 offen offset:0 nt lds
    buffer_load_dwordx4 v29, s[44:47], s23 offen offset:1024 nt lds
    buffer_load_dwordx4 v30, s[44:47], s23 offen offset:2048 nt lds
    buffer_load_dwordx4 v31, s[44:47], s23 offen offset:3072 nt lds
    s_waitcnt vmcnt(63)
    s_barrier
    s_mov_b32 m0, 106496
    s_add_u32 s23, s22, 65536
    s_waitcnt vmcnt(56)
    buffer_load_dwordx4 v28, s[44:47], s23 offen offset:0 nt lds
    buffer_load_dwordx4 v29, s[44:47], s23 offen offset:1024 nt lds
    buffer_load_dwordx4 v30, s[44:47], s23 offen offset:2048 nt lds
    buffer_load_dwordx4 v31, s[44:47], s23 offen offset:3072 nt lds
    s_mov_b32 m0, 110592
    s_add_u32 s23, s22, 98304
    s_waitcnt vmcnt(56)
    buffer_load_dwordx4 v28, s[44:47], s23 offen offset:0 nt lds
    buffer_load_dwordx4 v29, s[44:47], s23 offen offset:1024 nt lds
    buffer_load_dwordx4 v30, s[44:47], s23 offen offset:2048 nt lds
    buffer_load_dwordx4 v31, s[44:47], s23 offen offset:3072 nt lds
    s_or_b32 s22, s22, 0x1f000
    s_add_u32 s22, s22, 512
    s_and_b32 s22, s22, 0x60e00
    s_add_u32 m0, s19, 0
    s_add_u32 s23, s21, 0
    s_waitcnt vmcnt(56)
    buffer_load_dwordx4 v16, s[40:43], s23 offen offset:0 nt lds
    buffer_load_dwordx4 v17, s[40:43], s23 offen offset:1024 nt lds
    buffer_load_dwordx4 v18, s[40:43], s23 offen offset:2048 nt lds
    buffer_load_dwordx4 v19, s[40:43], s23 offen offset:3072 nt lds
    s_waitcnt vmcnt(63)
    s_barrier
    s_add_u32 m0, s19, 4096
    s_add_u32 s23, s21, 32768
    s_waitcnt vmcnt(56)
    buffer_load_dwordx4 v20, s[40:43], s23 offen offset:0 nt lds
    buffer_load_dwordx4 v21, s[40:43], s23 offen offset:1024 nt lds
    buffer_load_dwordx4 v22, s[40:43], s23 offen offset:2048 nt lds
    buffer_load_dwordx4 v23, s[40:43], s23 offen offset:3072 nt lds
    s_add_u32 m0, s19, 8192
    s_add_u32 s23, s21, 65536
    s_waitcnt vmcnt(56)
    buffer_load_dwordx4 v16, s[40:43], s23 offen offset:0 nt lds
    buffer_load_dwordx4 v17, s[40:43], s23 offen offset:1024 nt lds
    buffer_load_dwordx4 v18, s[40:43], s23 offen offset:2048 nt lds
    buffer_load_dwordx4 v19, s[40:43], s23 offen offset:3072 nt lds
    s_add_u32 m0, s19, 12288
    s_add_u32 s23, s21, 98304
    s_waitcnt vmcnt(56)
    buffer_load_dwordx4 v20, s[40:43], s23 offen offset:0 nt lds
    buffer_load_dwordx4 v21, s[40:43], s23 offen offset:1024 nt lds
    buffer_load_dwordx4 v22, s[40:43], s23 offen offset:2048 nt lds
    buffer_load_dwordx4 v23, s[40:43], s23 offen offset:3072 nt lds
    s_or_b32 s21, s21, 0x1f000
    s_add_u32 s21, s21, 512
    s_and_b32 s21, s21, 0x60e00
    s_add_u32 s19, s19, 16384
    s_cmp_eq_u32 s19, 49152
    s_cselect_b32 s19, 0, s19
    s_waitcnt vmcnt(63)
    s_barrier
    s_waitcnt vmcnt(56)
    v_and_b32 v5, 31, v2
    v_mul_u32_u24 v5, 896, v5
    v_lshrrev_b32 v6, 5, v2
    v_lshl_add_u32 v47, v6, 7, v5
    v_min_u32 v35, v47, v5
    s_mul_i32 s23, s29, 28672
    buffer_load_dword v44, v47, s[52:55], s23 offen offset:0
    s_waitcnt vmcnt(56)
    s_mul_i32 s23, s29, 28672
    buffer_load_dword v44, v47, s[52:55], s23 offen offset:256
    s_add_u32 m0, s20, 0
    s_add_u32 s23, s22, 0
    s_waitcnt vmcnt(56)
    buffer_load_dwordx4 v28, s[44:47], s23 offen offset:0 nt lds
    buffer_load_dwordx4 v29, s[44:47], s23 offen offset:1024 nt lds
    buffer_load_dwordx4 v30, s[44:47], s23 offen offset:2048 nt lds
    buffer_load_dwordx4 v31, s[44:47], s23 offen offset:3072 nt lds
    s_waitcnt vmcnt(63)
    s_barrier
    s_add_u32 m0, s20, 4096
    s_add_u32 s23, s22, 32768
    s_waitcnt vmcnt(56)
    buffer_load_dwordx4 v28, s[44:47], s23 offen offset:0 nt lds
    buffer_load_dwordx4 v29, s[44:47], s23 offen offset:1024 nt lds
    buffer_load_dwordx4 v30, s[44:47], s23 offen offset:2048 nt lds
    buffer_load_dwordx4 v31, s[44:47], s23 offen offset:3072 nt lds
    s_add_u32 m0, s20, 8192
    s_add_u32 s23, s22, 65536
    s_waitcnt vmcnt(56)
    buffer_load_dwordx4 v28, s[44:47], s23 offen offset:0 nt lds
    buffer_load_dwordx4 v29, s[44:47], s23 offen offset:1024 nt lds
    buffer_load_dwordx4 v30, s[44:47], s23 offen offset:2048 nt lds
    buffer_load_dwordx4 v31, s[44:47], s23 offen offset:3072 nt lds
    s_add_u32 m0, s20, 12288
    s_add_u32 s23, s22, 98304
    s_waitcnt vmcnt(56)
    buffer_load_dwordx4 v28, s[44:47], s23 offen offset:0 nt lds
    buffer_load_dwordx4 v29, s[44:47], s23 offen offset:1024 nt lds
    buffer_load_dwordx4 v30, s[44:47], s23 offen offset:2048 nt lds
    buffer_load_dwordx4 v31, s[44:47], s23 offen offset:3072 nt lds
    s_or_b32 s22, s22, 0x1f000
    s_add_u32 s22, s22, 512
    s_and_b32 s22, s22, 0x60e00
    s_add_u32 s20, s20, 16384
    s_cmp_eq_u32 s20, 98304
    s_cselect_b32 s20, 49152, s20
    s_add_u32 m0, s19, 0
    s_add_u32 s23, s21, 0
    s_waitcnt vmcnt(56)
    buffer_load_dwordx4 v16, s[40:43], s23 offen offset:0 nt lds
    buffer_load_dwordx4 v17, s[40:43], s23 offen offset:1024 nt lds
    buffer_load_dwordx4 v18, s[40:43], s23 offen offset:2048 nt lds
    buffer_load_dwordx4 v19, s[40:43], s23 offen offset:3072 nt lds
    s_waitcnt vmcnt(63)
    s_barrier
    s_add_u32 m0, s19, 4096
    s_add_u32 s23, s21, 32768
    s_waitcnt vmcnt(56)
    buffer_load_dwordx4 v20, s[40:43], s23 offen offset:0 nt lds
    buffer_load_dwordx4 v21, s[40:43], s23 offen offset:1024 nt lds
    buffer_load_dwordx4 v22, s[40:43], s23 offen offset:2048 nt lds
    buffer_load_dwordx4 v23, s[40:43], s23 offen offset:3072 nt lds
    s_add_u32 m0, s19, 8192
    s_add_u32 s23, s21, 65536
    s_waitcnt vmcnt(56)
    buffer_load_dwordx4 v16, s[40:43], s23 offen offset:0 nt lds
    buffer_load_dwordx4 v17, s[40:43], s23 offen offset:1024 nt lds
    buffer_load_dwordx4 v18, s[40:43], s23 offen offset:2048 nt lds
    buffer_load_dwordx4 v19, s[40:43], s23 offen offset:3072 nt lds
    s_add_u32 m0, s19, 12288
    s_add_u32 s23, s21, 98304
    s_waitcnt vmcnt(56)
    buffer_load_dwordx4 v20, s[40:43], s23 offen offset:0 nt lds
    buffer_load_dwordx4 v21, s[40:43], s23 offen offset:1024 nt lds
    buffer_load_dwordx4 v22, s[40:43], s23 offen offset:2048 nt lds
    buffer_load_dwordx4 v23, s[40:43], s23 offen offset:3072 nt lds
    s_or_b32 s21, s21, 0x1f000
    s_add_u32 s21, s21, 512
    s_and_b32 s21, s21, 0x60e00
    s_add_u32 s19, s19, 16384
    s_cmp_eq_u32 s19, 49152
    s_cselect_b32 s19, 0, s19
    s_waitcnt vmcnt(56)
    s_mul_i32 s23, s29, 28672
    buffer_load_dword v44, v47, s[52:55], s23 offen offset:512
    s_waitcnt vmcnt(56)
    s_mul_i32 s23, s29, 28672
    buffer_load_dword v44, v35, s[52:55], s23 offen offset:768
    s_waitcnt vmcnt(52)
    s_barrier
    s_add_u32 m0, s20, 0
    s_add_u32 s23, s22, 0
    s_waitcnt vmcnt(56)
    buffer_load_dwordx4 v28, s[44:47], s23 offen offset:0 nt lds
    buffer_load_dwordx4 v29, s[44:47], s23 offen offset:1024 nt lds
    buffer_load_dwordx4 v30, s[44:47], s23 offen offset:2048 nt lds
    buffer_load_dwordx4 v31, s[44:47], s23 offen offset:3072 nt lds
    s_add_u32 m0, s20, 4096
    s_add_u32 s23, s22, 32768
    s_waitcnt vmcnt(56)
    buffer_load_dwordx4 v28, s[44:47], s23 offen offset:0 nt lds
    buffer_load_dwordx4 v29, s[44:47], s23 offen offset:1024 nt lds
    buffer_load_dwordx4 v30, s[44:47], s23 offen offset:2048 nt lds
    buffer_load_dwordx4 v31, s[44:47], s23 offen offset:3072 nt lds
    s_add_u32 m0, s20, 8192
    s_add_u32 s23, s22, 65536
    s_waitcnt vmcnt(56)
    buffer_load_dwordx4 v28, s[44:47], s23 offen offset:0 nt lds
    buffer_load_dwordx4 v29, s[44:47], s23 offen offset:1024 nt lds
    buffer_load_dwordx4 v30, s[44:47], s23 offen offset:2048 nt lds
    buffer_load_dwordx4 v31, s[44:47], s23 offen offset:3072 nt lds
    s_add_u32 m0, s20, 12288
    s_add_u32 s23, s22, 98304
    s_waitcnt vmcnt(56)
    buffer_load_dwordx4 v28, s[44:47], s23 offen offset:0 nt lds
    buffer_load_dwordx4 v29, s[44:47], s23 offen offset:1024 nt lds
    buffer_load_dwordx4 v30, s[44:47], s23 offen offset:2048 nt lds
    buffer_load_dwordx4 v31, s[44:47], s23 offen offset:3072 nt lds
    s_or_b32 s22, s22, 0x1f000
    s_add_u32 s22, s22, 512
    s_and_b32 s22, s22, 0x60e00
    s_add_u32 s20, s20, 16384
    s_cmp_eq_u32 s20, 98304
    s_cselect_b32 s20, 49152, s20
    s_add_u32 m0, s19, 0
    s_add_u32 s23, s21, 0
    s_waitcnt vmcnt(56)
    buffer_load_dwordx4 v16, s[40:43], s23 offen offset:0 nt lds
    buffer_load_dwordx4 v17, s[40:43], s23 offen offset:1024 nt lds
    buffer_load_dwordx4 v18, s[40:43], s23 offen offset:2048 nt lds
    buffer_load_dwordx4 v19, s[40:43], s23 offen offset:3072 nt lds
    s_add_u32 m0, s19, 4096
    s_add_u32 s23, s21, 32768
    s_waitcnt vmcnt(56)
    buffer_load_dwordx4 v20, s[40:43], s23 offen offset:0 nt lds
    buffer_load_dwordx4 v21, s[40:43], s23 offen offset:1024 nt lds
    buffer_load_dwordx4 v22, s[40:43], s23 offen offset:2048 nt lds
    buffer_load_dwordx4 v23, s[40:43], s23 offen offset:3072 nt lds
    s_waitcnt vmcnt(42)
    s_barrier
    s_add_u32 m0, s19, 8192
    s_add_u32 s23, s21, 65536
    s_waitcnt vmcnt(56)
    buffer_load_dwordx4 v16, s[40:43], s23 offen offset:0 nt lds
    buffer_load_dwordx4 v17, s[40:43], s23 offen offset:1024 nt lds
    buffer_load_dwordx4 v18, s[40:43], s23 offen offset:2048 nt lds
    buffer_load_dwordx4 v19, s[40:43], s23 offen offset:3072 nt lds
    s_add_u32 m0, s19, 12288
    s_add_u32 s23, s21, 98304
    s_waitcnt vmcnt(56)
    buffer_load_dwordx4 v20, s[40:43], s23 offen offset:0 nt lds
    buffer_load_dwordx4 v21, s[40:43], s23 offen offset:1024 nt lds
    buffer_load_dwordx4 v22, s[40:43], s23 offen offset:2048 nt lds
    buffer_load_dwordx4 v23, s[40:43], s23 offen offset:3072 nt lds
    s_or_b32 s21, s21, 0x1f000
    s_add_u32 s21, s21, 512
    s_and_b32 s21, s21, 0x60e00
    s_add_u32 s19, s19, 16384
    s_cmp_eq_u32 s19, 49152
    s_cselect_b32 s19, 0, s19
    s_add_u32 m0, s20, 0
    s_add_u32 s23, s22, 0
    s_waitcnt vmcnt(56)
    buffer_load_dwordx4 v28, s[44:47], s23 offen offset:0 nt lds
    buffer_load_dwordx4 v29, s[44:47], s23 offen offset:1024 nt lds
    buffer_load_dwordx4 v30, s[44:47], s23 offen offset:2048 nt lds
    buffer_load_dwordx4 v31, s[44:47], s23 offen offset:3072 nt lds
    s_add_u32 m0, s20, 4096
    s_add_u32 s23, s22, 32768
    s_waitcnt vmcnt(56)
    buffer_load_dwordx4 v28, s[44:47], s23 offen offset:0 nt lds
    buffer_load_dwordx4 v29, s[44:47], s23 offen offset:1024 nt lds
    buffer_load_dwordx4 v30, s[44:47], s23 offen offset:2048 nt lds
    buffer_load_dwordx4 v31, s[44:47], s23 offen offset:3072 nt lds
    s_add_u32 m0, s20, 8192
    s_add_u32 s23, s22, 65536
    s_waitcnt vmcnt(56)
    buffer_load_dwordx4 v28, s[44:47], s23 offen offset:0 nt lds
    buffer_load_dwordx4 v29, s[44:47], s23 offen offset:1024 nt lds
    buffer_load_dwordx4 v30, s[44:47], s23 offen offset:2048 nt lds
    buffer_load_dwordx4 v31, s[44:47], s23 offen offset:3072 nt lds
    s_add_u32 m0, s20, 12288
    s_add_u32 s23, s22, 98304
    s_waitcnt vmcnt(56)
    buffer_load_dwordx4 v28, s[44:47], s23 offen offset:0 nt lds
    buffer_load_dwordx4 v29, s[44:47], s23 offen offset:1024 nt lds
    buffer_load_dwordx4 v30, s[44:47], s23 offen offset:2048 nt lds
    buffer_load_dwordx4 v31, s[44:47], s23 offen offset:3072 nt lds
    s_or_b32 s22, s22, 0x1f000
    s_add_u32 s22, s22, 512
    s_and_b32 s22, s22, 0x60e00
    s_add_u32 s20, s20, 16384
    s_cmp_eq_u32 s20, 98304
    s_cselect_b32 s20, 49152, s20
    s_waitcnt vmcnt(32)
    s_barrier
    s_lshr_b32 s23, s2, 3
    s_lshl_b32 s23, s23, 2
    v_lshl_add_u32 v13, v2, 12, s23
    v_and_b32 v14, 31, v2
    v_lshlrev_b32 v14, 2, v14
    v_mov_b32 v15, 1
    buffer_store_dword v15, v13, s[8:11], s82 offen
    s_add_u32 m0, s19, 0
    s_add_u32 s23, s21, 0
    s_waitcnt vmcnt(56)
    buffer_load_dwordx4 v16, s[40:43], s23 offen offset:0 nt lds
    buffer_load_dwordx4 v17, s[40:43], s23 offen offset:1024 nt lds
    buffer_load_dwordx4 v18, s[40:43], s23 offen offset:2048 nt lds
    buffer_load_dwordx4 v19, s[40:43], s23 offen offset:3072 nt lds
    s_add_u32 m0, s19, 4096
    s_add_u32 s23, s21, 32768
    s_waitcnt vmcnt(56)
    buffer_load_dwordx4 v20, s[40:43], s23 offen offset:0 nt lds
    buffer_load_dwordx4 v21, s[40:43], s23 offen offset:1024 nt lds
    buffer_load_dwordx4 v22, s[40:43], s23 offen offset:2048 nt lds
    buffer_load_dwordx4 v23, s[40:43], s23 offen offset:3072 nt lds
    s_add_u32 m0, s19, 8192
    s_add_u32 s23, s21, 65536
    s_waitcnt vmcnt(56)
    buffer_load_dwordx4 v16, s[40:43], s23 offen offset:0 nt lds
    buffer_load_dwordx4 v17, s[40:43], s23 offen offset:1024 nt lds
    buffer_load_dwordx4 v18, s[40:43], s23 offen offset:2048 nt lds
    buffer_load_dwordx4 v19, s[40:43], s23 offen offset:3072 nt lds
    s_add_u32 m0, s19, 12288
    s_add_u32 s23, s21, 98304
    s_waitcnt vmcnt(56)
    buffer_load_dwordx4 v20, s[40:43], s23 offen offset:0 nt lds
    buffer_load_dwordx4 v21, s[40:43], s23 offen offset:1024 nt lds
    buffer_load_dwordx4 v22, s[40:43], s23 offen offset:2048 nt lds
    buffer_load_dwordx4 v23, s[40:43], s23 offen offset:3072 nt lds
    s_or_b32 s21, s21, 0x1f000
    s_add_u32 s21, s21, 512
    s_and_b32 s21, s21, 0x60e00
    s_add_u32 s19, s19, 16384
    s_cmp_eq_u32 s19, 49152
    s_cselect_b32 s19, 0, s19
    s_add_u32 m0, s20, 0
    s_add_u32 s23, s22, 0
    s_waitcnt vmcnt(56)
    buffer_load_dwordx4 v28, s[44:47], s23 offen offset:0 nt lds
    buffer_load_dwordx4 v29, s[44:47], s23 offen offset:1024 nt lds
    buffer_load_dwordx4 v30, s[44:47], s23 offen offset:2048 nt lds
    buffer_load_dwordx4 v31, s[44:47], s23 offen offset:3072 nt lds
    s_add_u32 m0, s20, 4096
    s_add_u32 s23, s22, 32768
    s_waitcnt vmcnt(56)
    buffer_load_dwordx4 v28, s[44:47], s23 offen offset:0 nt lds
    buffer_load_dwordx4 v29, s[44:47], s23 offen offset:1024 nt lds
    buffer_load_dwordx4 v30, s[44:47], s23 offen offset:2048 nt lds
    buffer_load_dwordx4 v31, s[44:47], s23 offen offset:3072 nt lds
    s_add_u32 m0, s20, 8192
    s_add_u32 s23, s22, 65536
    s_waitcnt vmcnt(56)
    buffer_load_dwordx4 v28, s[44:47], s23 offen offset:0 nt lds
    buffer_load_dwordx4 v29, s[44:47], s23 offen offset:1024 nt lds
    buffer_load_dwordx4 v30, s[44:47], s23 offen offset:2048 nt lds
    buffer_load_dwordx4 v31, s[44:47], s23 offen offset:3072 nt lds
    s_add_u32 m0, s20, 12288
    s_add_u32 s23, s22, 98304
    s_waitcnt vmcnt(56)
    buffer_load_dwordx4 v28, s[44:47], s23 offen offset:0 nt lds
    buffer_load_dwordx4 v29, s[44:47], s23 offen offset:1024 nt lds
    buffer_load_dwordx4 v30, s[44:47], s23 offen offset:2048 nt lds
    buffer_load_dwordx4 v31, s[44:47], s23 offen offset:3072 nt lds
    s_or_b32 s22, s22, 0x1f000
    s_add_u32 s22, s22, 512
    s_and_b32 s22, s22, 0x60e00
    s_add_u32 s20, s20, 16384
    s_cmp_eq_u32 s20, 98304
    s_cselect_b32 s20, 49152, s20
    s_waitcnt vmcnt(33)
    s_barrier
    s_add_u32 m0, s19, 0
    s_add_u32 s23, s21, 0
    s_waitcnt vmcnt(56)
    buffer_load_dwordx4 v16, s[40:43], s23 offen offset:0 nt lds
    buffer_load_dwordx4 v17, s[40:43], s23 offen offset:1024 nt lds
    buffer_load_dwordx4 v18, s[40:43], s23 offen offset:2048 nt lds
    buffer_load_dwordx4 v19, s[40:43], s23 offen offset:3072 nt lds
    s_add_u32 m0, s19, 4096
    s_add_u32 s23, s21, 32768
    s_waitcnt vmcnt(56)
    buffer_load_dwordx4 v20, s[40:43], s23 offen offset:0 nt lds
    buffer_load_dwordx4 v21, s[40:43], s23 offen offset:1024 nt lds
    buffer_load_dwordx4 v22, s[40:43], s23 offen offset:2048 nt lds
    buffer_load_dwordx4 v23, s[40:43], s23 offen offset:3072 nt lds
    s_add_u32 m0, s19, 8192
    s_add_u32 s23, s21, 65536
    s_waitcnt vmcnt(56)
    buffer_load_dwordx4 v16, s[40:43], s23 offen offset:0 nt lds
    buffer_load_dwordx4 v17, s[40:43], s23 offen offset:1024 nt lds
    buffer_load_dwordx4 v18, s[40:43], s23 offen offset:2048 nt lds
    buffer_load_dwordx4 v19, s[40:43], s23 offen offset:3072 nt lds
    s_add_u32 m0, s19, 12288
    s_add_u32 s23, s21, 98304
    s_waitcnt vmcnt(56)
    buffer_load_dwordx4 v20, s[40:43], s23 offen offset:0 nt lds
    buffer_load_dwordx4 v21, s[40:43], s23 offen offset:1024 nt lds
    buffer_load_dwordx4 v22, s[40:43], s23 offen offset:2048 nt lds
    buffer_load_dwordx4 v23, s[40:43], s23 offen offset:3072 nt lds
    s_or_b32 s21, s21, 0x1f000
    s_add_u32 s21, s21, 512
    s_and_b32 s21, s21, 0x60e00
    s_add_u32 s19, s19, 16384
    s_cmp_eq_u32 s19, 49152
    s_cselect_b32 s19, 0, s19
    s_add_u32 m0, s20, 0
    s_add_u32 s23, s22, 0
    s_waitcnt vmcnt(56)
    buffer_load_dwordx4 v28, s[44:47], s23 offen offset:0 nt lds
    buffer_load_dwordx4 v29, s[44:47], s23 offen offset:1024 nt lds
    buffer_load_dwordx4 v30, s[44:47], s23 offen offset:2048 nt lds
    buffer_load_dwordx4 v31, s[44:47], s23 offen offset:3072 nt lds
    s_add_u32 m0, s20, 4096
    s_add_u32 s23, s22, 32768
    s_waitcnt vmcnt(56)
    buffer_load_dwordx4 v28, s[44:47], s23 offen offset:0 nt lds
    buffer_load_dwordx4 v29, s[44:47], s23 offen offset:1024 nt lds
    buffer_load_dwordx4 v30, s[44:47], s23 offen offset:2048 nt lds
    buffer_load_dwordx4 v31, s[44:47], s23 offen offset:3072 nt lds
    s_add_u32 m0, s20, 8192
    s_add_u32 s23, s22, 65536
    s_waitcnt vmcnt(56)
    buffer_load_dwordx4 v28, s[44:47], s23 offen offset:0 nt lds
    buffer_load_dwordx4 v29, s[44:47], s23 offen offset:1024 nt lds
    buffer_load_dwordx4 v30, s[44:47], s23 offen offset:2048 nt lds
    buffer_load_dwordx4 v31, s[44:47], s23 offen offset:3072 nt lds
    s_add_u32 m0, s20, 12288
    s_add_u32 s23, s22, 98304
    s_waitcnt vmcnt(56)
    buffer_load_dwordx4 v28, s[44:47], s23 offen offset:0 nt lds
    buffer_load_dwordx4 v29, s[44:47], s23 offen offset:1024 nt lds
    buffer_load_dwordx4 v30, s[44:47], s23 offen offset:2048 nt lds
    buffer_load_dwordx4 v31, s[44:47], s23 offen offset:3072 nt lds
    s_or_b32 s22, s22, 0x1f000
    s_add_u32 s22, s22, 512
    s_and_b32 s22, s22, 0x60e00
    s_add_u32 s20, s20, 16384
    s_cmp_eq_u32 s20, 98304
    s_cselect_b32 s20, 49152, s20
    s_mov_b32 s60, 98304
    s_mov_b32 s61, 0
    s_mov_b32 m0, s60
    s_mov_b32 s23, s61
    s_waitcnt vmcnt(56)
    buffer_load_dwordx4 v24, s[52:55], s23 offen offset:0  lds
    buffer_load_dwordx4 v25, s[52:55], s23 offen offset:1024  lds
    buffer_load_dwordx4 v26, s[52:55], s23 offen offset:2048  lds
    buffer_load_dwordx4 v27, s[52:55], s23 offen offset:3072  lds
    s_add_u32 s60, s60, 4096
    s_add_u32 s61, s61, 28672
    s_cmp_eq_u32 s61, 229376
    s_cselect_b32 s61, 128, s61
    s_waitcnt vmcnt(36)
    s_barrier
    s_add_u32 m0, s19, 0
    s_add_u32 s23, s21, 0
    s_waitcnt vmcnt(56)
    buffer_load_dwordx4 v16, s[40:43], s23 offen offset:0 nt lds
    buffer_load_dwordx4 v17, s[40:43], s23 offen offset:1024 nt lds
    buffer_load_dwordx4 v18, s[40:43], s23 offen offset:2048 nt lds
    buffer_load_dwordx4 v19, s[40:43], s23 offen offset:3072 nt lds
    s_add_u32 m0, s19, 4096
    s_add_u32 s23, s21, 32768
    s_waitcnt vmcnt(56)
    buffer_load_dwordx4 v20, s[40:43], s23 offen offset:0 nt lds
    buffer_load_dwordx4 v21, s[40:43], s23 offen offset:1024 nt lds
    buffer_load_dwordx4 v22, s[40:43], s23 offen offset:2048 nt lds
    buffer_load_dwordx4 v23, s[40:43], s23 offen offset:3072 nt lds
    s_add_u32 m0, s19, 8192
    s_add_u32 s23, s21, 65536
    s_waitcnt vmcnt(56)
    buffer_load_dwordx4 v16, s[40:43], s23 offen offset:0 nt lds
    buffer_load_dwordx4 v17, s[40:43], s23 offen offset:1024 nt lds
    buffer_load_dwordx4 v18, s[40:43], s23 offen offset:2048 nt lds
    buffer_load_dwordx4 v19, s[40:43], s23 offen offset:3072 nt lds
    s_add_u32 m0, s19, 12288
    s_add_u32 s23, s21, 98304
    s_waitcnt vmcnt(56)
    buffer_load_dwordx4 v20, s[40:43], s23 offen offset:0 nt lds
    buffer_load_dwordx4 v21, s[40:43], s23 offen offset:1024 nt lds
    buffer_load_dwordx4 v22, s[40:43], s23 offen offset:2048 nt lds
    buffer_load_dwordx4 v23, s[40:43], s23 offen offset:3072 nt lds
    s_or_b32 s21, s21, 0x1f000
    s_add_u32 s21, s21, 512
    s_and_b32 s21, s21, 0x60e00
    s_add_u32 s19, s19, 16384
    s_cmp_eq_u32 s19, 49152
    s_cselect_b32 s19, 0, s19
    s_add_u32 m0, s20, 0
    s_add_u32 s23, s22, 0
    s_waitcnt vmcnt(56)
    buffer_load_dwordx4 v28, s[44:47], s23 offen offset:0 nt lds
    buffer_load_dwordx4 v29, s[44:47], s23 offen offset:1024 nt lds
    buffer_load_dwordx4 v30, s[44:47], s23 offen offset:2048 nt lds
    buffer_load_dwordx4 v31, s[44:47], s23 offen offset:3072 nt lds
    s_add_u32 m0, s20, 4096
    s_add_u32 s23, s22, 32768
    s_waitcnt vmcnt(56)
    buffer_load_dwordx4 v28, s[44:47], s23 offen offset:0 nt lds
    buffer_load_dwordx4 v29, s[44:47], s23 offen offset:1024 nt lds
    buffer_load_dwordx4 v30, s[44:47], s23 offen offset:2048 nt lds
    buffer_load_dwordx4 v31, s[44:47], s23 offen offset:3072 nt lds
    s_add_u32 m0, s20, 8192
    s_add_u32 s23, s22, 65536
    s_waitcnt vmcnt(56)
    buffer_load_dwordx4 v28, s[44:47], s23 offen offset:0 nt lds
    buffer_load_dwordx4 v29, s[44:47], s23 offen offset:1024 nt lds
    buffer_load_dwordx4 v30, s[44:47], s23 offen offset:2048 nt lds
    buffer_load_dwordx4 v31, s[44:47], s23 offen offset:3072 nt lds
    s_add_u32 m0, s20, 12288
    s_add_u32 s23, s22, 98304
    s_waitcnt vmcnt(56)
    buffer_load_dwordx4 v28, s[44:47], s23 offen offset:0 nt lds
    buffer_load_dwordx4 v29, s[44:47], s23 offen offset:1024 nt lds
    buffer_load_dwordx4 v30, s[44:47], s23 offen offset:2048 nt lds
    buffer_load_dwordx4 v31, s[44:47], s23 offen offset:3072 nt lds
    s_or_b32 s22, s22, 0x1f000
    s_add_u32 s22, s22, 512
    s_and_b32 s22, s22, 0x60e00
    s_add_u32 s20, s20, 16384
    s_cmp_eq_u32 s20, 98304
    s_cselect_b32 s20, 49152, s20
    s_mov_b32 m0, s60
    s_mov_b32 s23, s61
    s_waitcnt vmcnt(56)
    buffer_load_dwordx4 v24, s[52:55], s23 offen offset:0  lds
    buffer_load_dwordx4 v25, s[52:55], s23 offen offset:1024  lds
    buffer_load_dwordx4 v26, s[52:55], s23 offen offset:2048  lds
    buffer_load_dwordx4 v27, s[52:55], s23 offen offset:3072  lds
    s_add_u32 s60, s60, 4096
    s_add_u32 s61, s61, 28672
    s_cmp_eq_u32 s61, 229376
    s_cselect_b32 s61, 128, s61
    s_mov_b32 s24, 14
L_ld_loop0:
    s_waitcnt vmcnt(40)
    s_barrier
    s_add_u32 m0, s19, 0
    s_add_u32 s23, s21, 0
    s_waitcnt vmcnt(56)
    buffer_load_dwordx4 v16, s[40:43], s23 offen offset:0 nt lds
    buffer_load_dwordx4 v17, s[40:43], s23 offen offset:1024 nt lds
    buffer_load_dwordx4 v18, s[40:43], s23 offen offset:2048 nt lds
    buffer_load_dwordx4 v19, s[40:43], s23 offen offset:3072 nt lds
    s_add_u32 m0, s19, 4096
    s_add_u32 s23, s21, 32768
    s_waitcnt vmcnt(56)
    buffer_load_dwordx4 v20, s[40:43], s23 offen offset:0 nt lds
    buffer_load_dwordx4 v21, s[40:43], s23 offen offset:1024 nt lds
    buffer_load_dwordx4 v22, s[40:43], s23 offen offset:2048 nt lds
    buffer_load_dwordx4 v23, s[40:43], s23 offen offset:3072 nt lds
    s_add_u32 m0, s19, 8192
    s_add_u32 s23, s21, 65536
    s_waitcnt vmcnt(56)
    buffer_load_dwordx4 v16, s[40:43], s23 offen offset:0 nt lds
    buffer_load_dwordx4 v17, s[40:43], s23 offen offset:1024 nt lds
    buffer_load_dwordx4 v18, s[40:43], s23 offen offset:2048 nt lds
    buffer_load_dwordx4 v19, s[40:43], s23 offen offset:3072 nt lds
    s_add_u32 m0, s19, 12288
    s_add_u32 s23, s21, 98304
    s_waitcnt vmcnt(56)
    buffer_load_dwordx4 v20, s[40:43], s23 offen offset:0 nt lds
    buffer_load_dwordx4 v21, s[40:43], s23 offen offset:1024 nt lds
    buffer_load_dwordx4 v22, s[40:43], s23 offen offset:2048 nt lds
    buffer_load_dwordx4 v23, s[40:43], s23 offen offset:3072 nt lds
    s_or_b32 s21, s21, 0x1f000
    s_add_u32 s21, s21, 512
    s_and_b32 s21, s21, 0x60e00
    s_add_u32 s19, s19, 16384
    s_cmp_eq_u32 s19, 49152
    s_cselect_b32 s19, 0, s19
    s_add_u32 m0, s20, 0
    s_add_u32 s23, s22, 0
    s_waitcnt vmcnt(56)
    buffer_load_dwordx4 v28, s[44:47], s23 offen offset:0 nt lds
    buffer_load_dwordx4 v29, s[44:47], s23 offen offset:1024 nt lds
    buffer_load_dwordx4 v30, s[44:47], s23 offen offset:2048 nt lds
    buffer_load_dwordx4 v31, s[44:47], s23 offen offset:3072 nt lds
    s_add_u32 m0, s20, 4096
    s_add_u32 s23, s22, 32768
    s_waitcnt vmcnt(56)
    buffer_load_dwordx4 v28, s[44:47], s23 offen offset:0 nt lds
    buffer_load_dwordx4 v29, s[44:47], s23 offen offset:1024 nt lds
    buffer_load_dwordx4 v30, s[44:47], s23 offen offset:2048 nt lds
    buffer_load_dwordx4 v31, s[44:47], s23 offen offset:3072 nt lds
    s_add_u32 m0, s20, 8192
    s_add_u32 s23, s22, 65536
    s_waitcnt vmcnt(56)
    buffer_load_dwordx4 v28, s[44:47], s23 offen offset:0 nt lds
    buffer_load_dwordx4 v29, s[44:47], s23 offen offset:1024 nt lds
    buffer_load_dwordx4 v30, s[44:47], s23 offen offset:2048 nt lds
    buffer_load_dwordx4 v31, s[44:47], s23 offen offset:3072 nt lds
    s_add_u32 m0, s20, 12288
    s_add_u32 s23, s22, 98304
    s_waitcnt vmcnt(56)
    buffer_load_dwordx4 v28, s[44:47], s23 offen offset:0 nt lds
    buffer_load_dwordx4 v29, s[44:47], s23 offen offset:1024 nt lds
    buffer_load_dwordx4 v30, s[44:47], s23 offen offset:2048 nt lds
    buffer_load_dwordx4 v31, s[44:47], s23 offen offset:3072 nt lds
    s_or_b32 s22, s22, 0x1f000
    s_add_u32 s22, s22, 512
    s_and_b32 s22, s22, 0x60e00
    s_add_u32 s20, s20, 16384
    s_cmp_eq_u32 s20, 98304
    s_cselect_b32 s20, 49152, s20
    s_mov_b32 m0, s60
    s_mov_b32 s23, s61
    s_waitcnt vmcnt(56)
    buffer_load_dwordx4 v24, s[52:55], s23 offen offset:0  lds
    buffer_load_dwordx4 v25, s[52:55], s23 offen offset:1024  lds
    buffer_load_dwordx4 v26, s[52:55], s23 offen offset:2048  lds
    buffer_load_dwordx4 v27, s[52:55], s23 offen offset:3072  lds
    s_add_u32 s60, s60, 4096
    s_add_u32 s61, s61, 28672
    s_cmp_eq_u32 s61, 229376
    s_cselect_b32 s61, 128, s61
    s_sub_u32 s24, s24, 1
    s_cmp_lg_u32 s24, 0
    s_cbranch_scc1 L_ld_loop0
    s_waitcnt vmcnt(40)
    s_barrier
    s_add_u32 m0, s19, 0
    s_add_u32 s23, s21, 0
    s_waitcnt vmcnt(56)
    buffer_load_dwordx4 v16, s[40:43], s23 offen offset:0 nt lds
    buffer_load_dwordx4 v17, s[40:43], s23 offen offset:1024 nt lds
    buffer_load_dwordx4 v18, s[40:43], s23 offen offset:2048 nt lds
    buffer_load_dwordx4 v19, s[40:43], s23 offen offset:3072 nt lds
    s_add_u32 m0, s19, 4096
    s_add_u32 s23, s21, 32768
    s_waitcnt vmcnt(56)
    buffer_load_dwordx4 v20, s[40:43], s23 offen offset:0 nt lds
    buffer_load_dwordx4 v21, s[40:43], s23 offen offset:1024 nt lds
    buffer_load_dwordx4 v22, s[40:43], s23 offen offset:2048 nt lds
    buffer_load_dwordx4 v23, s[40:43], s23 offen offset:3072 nt lds
    s_add_u32 m0, s19, 8192
    s_add_u32 s23, s21, 65536
    s_waitcnt vmcnt(56)
    buffer_load_dwordx4 v16, s[40:43], s23 offen offset:0 nt lds
    buffer_load_dwordx4 v17, s[40:43], s23 offen offset:1024 nt lds
    buffer_load_dwordx4 v18, s[40:43], s23 offen offset:2048 nt lds
    buffer_load_dwordx4 v19, s[40:43], s23 offen offset:3072 nt lds
    s_add_u32 m0, s19, 12288
    s_add_u32 s23, s21, 98304
    s_waitcnt vmcnt(56)
    buffer_load_dwordx4 v20, s[40:43], s23 offen offset:0 nt lds
    buffer_load_dwordx4 v21, s[40:43], s23 offen offset:1024 nt lds
    buffer_load_dwordx4 v22, s[40:43], s23 offen offset:2048 nt lds
    buffer_load_dwordx4 v23, s[40:43], s23 offen offset:3072 nt lds
    s_or_b32 s21, s21, 0x1f000
    s_add_u32 s21, s21, 512
    s_and_b32 s21, s21, 0x60e00
    s_add_u32 s19, s19, 16384
    s_cmp_eq_u32 s19, 49152
    s_cselect_b32 s19, 0, s19
    s_add_u32 m0, s20, 0
    s_add_u32 s23, s22, 0
    s_waitcnt vmcnt(56)
    buffer_load_dwordx4 v28, s[44:47], s23 offen offset:0 nt lds
    buffer_load_dwordx4 v29, s[44:47], s23 offen offset:1024 nt lds
    buffer_load_dwordx4 v30, s[44:47], s23 offen offset:2048 nt lds
    buffer_load_dwordx4 v31, s[44:47], s23 offen offset:3072 nt lds
    s_add_u32 m0, s20, 4096
    s_add_u32 s23, s22, 32768
    s_waitcnt vmcnt(56)
    buffer_load_dwordx4 v28, s[44:47], s23 offen offset:0 nt lds
    buffer_load_dwordx4 v29, s[44:47], s23 offen offset:1024 nt lds
    buffer_load_dwordx4 v30, s[44:47], s23 offen offset:2048 nt lds
    buffer_load_dwordx4 v31, s[44:47], s23 offen offset:3072 nt lds
    s_add_u32 m0, s20, 8192
    s_add_u32 s23, s22, 65536
    s_waitcnt vmcnt(56)
    buffer_load_dwordx4 v28, s[44:47], s23 offen offset:0 nt lds
    buffer_load_dwordx4 v29, s[44:47], s23 offen offset:1024 nt lds
    buffer_load_dwordx4 v30, s[44:47], s23 offen offset:2048 nt lds
    buffer_load_dwordx4 v31, s[44:47], s23 offen offset:3072 nt lds
    s_add_u32 m0, s20, 12288
    s_add_u32 s23, s22, 98304
    s_waitcnt vmcnt(56)
    buffer_load_dwordx4 v28, s[44:47], s23 offen offset:0 nt lds
    buffer_load_dwordx4 v29, s[44:47], s23 offen offset:1024 nt lds
    buffer_load_dwordx4 v30, s[44:47], s23 offen offset:2048 nt lds
    buffer_load_dwordx4 v31, s[44:47], s23 offen offset:3072 nt lds
    s_or_b32 s22, s22, 0x1f000
    s_add_u32 s22, s22, 512
    s_and_b32 s22, s22, 0x60e00
    s_add_u32 s20, s20, 16384
    s_cmp_eq_u32 s20, 98304
    s_cselect_b32 s20, 49152, s20
    s_waitcnt vmcnt(36)
    s_barrier
    s_add_u32 m0, s19, 0
    s_add_u32 s23, s21, 0
    s_waitcnt vmcnt(56)
    buffer_load_dwordx4 v16, s[40:43], s23 offen offset:0 nt lds
    buffer_load_dwordx4 v17, s[40:43], s23 offen offset:1024 nt lds
    buffer_load_dwordx4 v18, s[40:43], s23 offen offset:2048 nt lds
    buffer_load_dwordx4 v19, s[40:43], s23 offen offset:3072 nt lds
    s_add_u32 m0, s19, 4096
    s_add_u32 s23, s21, 32768
    s_waitcnt vmcnt(56)
    buffer_load_dwordx4 v20, s[40:43], s23 offen offset:0 nt lds
    buffer_load_dwordx4 v21, s[40:43], s23 offen offset:1024 nt lds
    buffer_load_dwordx4 v22, s[40:43], s23 offen offset:2048 nt lds
    buffer_load_dwordx4 v23, s[40:43], s23 offen offset:3072 nt lds
    s_add_u32 m0, s19, 8192
    s_add_u32 s23, s21, 65536
    s_waitcnt vmcnt(56)
    buffer_load_dwordx4 v16, s[40:43], s23 offen offset:0 nt lds
    buffer_load_dwordx4 v17, s[40:43], s23 offen offset:1024 nt lds
    buffer_load_dwordx4 v18, s[40:43], s23 offen offset:2048 nt lds
    buffer_load_dwordx4 v19, s[40:43], s23 offen offset:3072 nt lds
    s_add_u32 m0, s19, 12288
    s_add_u32 s23, s21, 98304
    s_waitcnt vmcnt(56)
    buffer_load_dwordx4 v20, s[40:43], s23 offen offset:0 nt lds
    buffer_load_dwordx4 v21, s[40:43], s23 offen offset:1024 nt lds
    buffer_load_dwordx4 v22, s[40:43], s23 offen offset:2048 nt lds
    buffer_load_dwordx4 v23, s[40:43], s23 offen offset:3072 nt lds
    s_or_b32 s21, s21, 0x1f000
    s_add_u32 s21, s21, 512
    s_and_b32 s21, s21, 0x60e00
    s_add_u32 s19, s19, 16384
    s_cmp_eq_u32 s19, 49152
    s_cselect_b32 s19, 0, s19
    s_add_u32 m0, s20, 0
    s_add_u32 s23, s22, 0
    s_waitcnt vmcnt(56)
    buffer_load_dwordx4 v28, s[44:47], s23 offen offset:0 nt lds
    buffer_load_dwordx4 v29, s[44:47], s23 offen offset:1024 nt lds
    buffer_load_dwordx4 v30, s[44:47], s23 offen offset:2048 nt lds
    buffer_load_dwordx4 v31, s[44:47], s23 offen offset:3072 nt lds
    s_add_u32 m0, s20, 4096
    s_add_u32 s23, s22, 32768
    s_waitcnt vmcnt(56)
    buffer_load_dwordx4 v28, s[44:47], s23 offen offset:0 nt lds
    buffer_load_dwordx4 v29, s[44:47], s23 offen offset:1024 nt lds
    buffer_load_dwordx4 v30, s[44:47], s23 offen offset:2048 nt lds
    buffer_load_dwordx4 v31, s[44:47], s23 offen offset:3072 nt lds
    s_add_u32 m0, s20, 8192
    s_add_u32 s23, s22, 65536
    s_waitcnt vmcnt(56)
    buffer_load_dwordx4 v28, s[44:47], s23 offen offset:0 nt lds
    buffer_load_dwordx4 v29, s[44:47], s23 offen offset:1024 nt lds
    buffer_load_dwordx4 v30, s[44:47], s23 offen offset:2048 nt lds
    buffer_load_dwordx4 v31, s[44:47], s23 offen offset:3072 nt lds
    s_add_u32 m0, s20, 12288
    s_add_u32 s23, s22, 98304
    s_waitcnt vmcnt(56)
    buffer_load_dwordx4 v28, s[44:47], s23 offen offset:0 nt lds
    buffer_load_dwordx4 v29, s[44:47], s23 offen offset:1024 nt lds
    buffer_load_dwordx4 v30, s[44:47], s23 offen offset:2048 nt lds
    buffer_load_dwordx4 v31, s[44:47], s23 offen offset:3072 nt lds
    s_or_b32 s22, s22, 0x1f000
    s_add_u32 s22, s22, 512
    s_and_b32 s22, s22, 0x60e00
    s_add_u32 s20, s20, 16384
    s_cmp_eq_u32 s20, 98304
    s_cselect_b32 s20, 49152, s20
    s_mov_b32 s24, 6
L_ld_loop1:
    s_waitcnt vmcnt(32)
    s_barrier
    s_add_u32 m0, s19, 0
    s_add_u32 s23, s21, 0
    s_waitcnt vmcnt(56)
    buffer_load_dwordx4 v16, s[40:43], s23 offen offset:0 nt lds
    buffer_load_dwordx4 v17, s[40:43], s23 offen offset:1024 nt lds
    buffer_load_dwordx4 v18, s[40:43], s23 offen offset:2048 nt lds
    buffer_load_dwordx4 v19, s[40:43], s23 offen offset:3072 nt lds
    s_add_u32 m0, s19, 4096
    s_add_u32 s23, s21, 32768
    s_waitcnt vmcnt(56)
    buffer_load_dwordx4 v20, s[40:43], s23 offen offset:0 nt lds
    buffer_load_dwordx4 v21, s[40:43], s23 offen offset:1024 nt lds
    buffer_load_dwordx4 v22, s[40:43], s23 offen offset:2048 nt lds
    buffer_load_dwordx4 v23, s[40:43], s23 offen offset:3072 nt lds
    s_add_u32 m0, s19, 8192
    s_add_u32 s23, s21, 65536
    s_waitcnt vmcnt(56)
    buffer_load_dwordx4 v16, s[40:43], s23 offen offset:0 nt lds
    buffer_load_dwordx4 v17, s[40:43], s23 offen offset:1024 nt lds
    buffer_load_dwordx4 v18, s[40:43], s23 offen offset:2048 nt lds
    buffer_load_dwordx4 v19, s[40:43], s23 offen offset:3072 nt lds
    s_add_u32 m0, s19, 12288
    s_add_u32 s23, s21, 98304
    s_waitcnt vmcnt(56)
    buffer_load_dwordx4 v20, s[40:43], s23 offen offset:0 nt lds
    buffer_load_dwordx4 v21, s[40:43], s23 offen offset:1024 nt lds
    buffer_load_dwordx4 v22, s[40:43], s23 offen offset:2048 nt lds
    buffer_load_dwordx4 v23, s[40:43], s23 offen offset:3072 nt lds
    s_or_b32 s21, s21, 0x1f000
    s_add_u32 s21, s21, 512
    s_and_b32 s21, s21, 0x60e00
    s_add_u32 s19, s19, 16384
    s_cmp_eq_u32 s19, 49152
    s_cselect_b32 s19, 0, s19
    s_add_u32 m0, s20, 0
    s_add_u32 s23, s22, 0
    s_waitcnt vmcnt(56)
    buffer_load_dwordx4 v28, s[44:47], s23 offen offset:0 nt lds
    buffer_load_dwordx4 v29, s[44:47], s23 offen offset:1024 nt lds
    buffer_load_dwordx4 v30, s[44:47], s23 offen offset:2048 nt lds
    buffer_load_dwordx4 v31, s[44:47], s23 offen offset:3072 nt lds
    s_add_u32 m0, s20, 4096
    s_add_u32 s23, s22, 32768
    s_waitcnt vmcnt(56)
    buffer_load_dwordx4 v28, s[44:47], s23 offen offset:0 nt lds
    buffer_load_dwordx4 v29, s[44:47], s23 offen offset:1024 nt lds
    buffer_load_dwordx4 v30, s[44:47], s23 offen offset:2048 nt lds
    buffer_load_dwordx4 v31, s[44:47], s23 offen offset:3072 nt lds
    s_add_u32 m0, s20, 8192
    s_add_u32 s23, s22, 65536
    s_waitcnt vmcnt(56)
    buffer_load_dwordx4 v28, s[44:47], s23 offen offset:0 nt lds
    buffer_load_dwordx4 v29, s[44:47], s23 offen offset:1024 nt lds
    buffer_load_dwordx4 v30, s[44:47], s23 offen offset:2048 nt lds
    buffer_load_dwordx4 v31, s[44:47], s23 offen offset:3072 nt lds
    s_add_u32 m0, s20, 12288
    s_add_u32 s23, s22, 98304
    s_waitcnt vmcnt(56)
    buffer_load_dwordx4 v28, s[44:47], s23 offen offset:0 nt lds
    buffer_load_dwordx4 v29, s[44:47], s23 offen offset:1024 nt lds
    buffer_load_dwordx4 v30, s[44:47], s23 offen offset:2048 nt lds
    buffer_load_dwordx4 v31, s[44:47], s23 offen offset:3072 nt lds
    s_or_b32 s22, s22, 0x1f000
    s_add_u32 s22, s22, 512
    s_and_b32 s22, s22, 0x60e00
    s_add_u32 s20, s20, 16384
    s_cmp_eq_u32 s20, 98304
    s_cselect_b32 s20, 49152, s20
    s_sub_u32 s24, s24, 1
    s_cmp_lg_u32 s24, 0
    s_cbranch_scc1 L_ld_loop1
    s_waitcnt vmcnt(32)
    s_barrier
    v_mov_b32 v15, 2
    buffer_store_dword v15, v13, s[8:11], s82 offen
    buffer_load_dword v9, v14, s[8:11], s82 offen sc1
    s_add_u32 m0, s19, 0
    s_add_u32 s23, s21, 0
    s_waitcnt vmcnt(56)
    buffer_load_dwordx4 v16, s[40:43], s23 offen offset:0 nt lds
    buffer_load_dwordx4 v17, s[40:43], s23 offen offset:1024 nt lds
    buffer_load_dwordx4 v18, s[40:43], s23 offen offset:2048 nt lds
    buffer_load_dwordx4 v19, s[40:43], s23 offen offset:3072 nt lds
    s_add_u32 m0, s19, 4096
    s_add_u32 s23, s21, 32768
    s_waitcnt vmcnt(56)
    buffer_load_dwordx4 v20, s[40:43], s23 offen offset:0 nt lds
    buffer_load_dwordx4 v21, s[40:43], s23 offen offset:1024 nt lds
    buffer_load_dwordx4 v22, s[40:43], s23 offen offset:2048 nt lds
    buffer_load_dwordx4 v23, s[40:43], s23 offen offset:3072 nt lds
    s_add_u32 m0, s19, 8192
    s_add_u32 s23, s21, 65536
    s_waitcnt vmcnt(56)
    buffer_load_dwordx4 v16, s[40:43], s23 offen offset:0 nt lds
    buffer_load_dwordx4 v17, s[40:43], s23 offen offset:1024 nt lds
    buffer_load_dwordx4 v18, s[40:43], s23 offen offset:2048 nt lds
    buffer_load_dwordx4 v19, s[40:43], s23 offen offset:3072 nt lds
    s_add_u32 m0, s19, 12288
    s_add_u32 s23, s21, 98304
    s_waitcnt vmcnt(56)
    buffer_load_dwordx4 v20, s[40:43], s23 offen offset:0 nt lds
    buffer_load_dwordx4 v21, s[40:43], s23 offen offset:1024 nt lds
    buffer_load_dwordx4 v22, s[40:43], s23 offen offset:2048 nt lds
    buffer_load_dwordx4 v23, s[40:43], s23 offen offset:3072 nt lds
    s_or_b32 s21, s21, 0x1f000
    s_add_u32 s21, s21, 512
    s_and_b32 s21, s21, 0x60e00
    s_add_u32 s19, s19, 16384
    s_cmp_eq_u32 s19, 49152
    s_cselect_b32 s19, 0, s19
    s_add_u32 m0, s20, 0
    s_add_u32 s23, s22, 0
    s_waitcnt vmcnt(56)
    buffer_load_dwordx4 v28, s[44:47], s23 offen offset:0 nt lds
    buffer_load_dwordx4 v29, s[44:47], s23 offen offset:1024 nt lds
    buffer_load_dwordx4 v30, s[44:47], s23 offen offset:2048 nt lds
    buffer_load_dwordx4 v31, s[44:47], s23 offen offset:3072 nt lds
    s_add_u32 m0, s20, 4096
    s_add_u32 s23, s22, 32768
    s_waitcnt vmcnt(56)
    buffer_load_dwordx4 v28, s[44:47], s23 offen offset:0 nt lds
    buffer_load_dwordx4 v29, s[44:47], s23 offen offset:1024 nt lds
    buffer_load_dwordx4 v30, s[44:47], s23 offen offset:2048 nt lds
    buffer_load_dwordx4 v31, s[44:47], s23 offen offset:3072 nt lds
    s_add_u32 m0, s20, 8192
    s_add_u32 s23, s22, 65536
    s_waitcnt vmcnt(56)
    buffer_load_dwordx4 v28, s[44:47], s23 offen offset:0 nt lds
    buffer_load_dwordx4 v29, s[44:47], s23 offen offset:1024 nt lds
    buffer_load_dwordx4 v30, s[44:47], s23 offen offset:2048 nt lds
    buffer_load_dwordx4 v31, s[44:47], s23 offen offset:3072 nt lds
    s_add_u32 m0, s20, 12288
    s_add_u32 s23, s22, 98304
    s_waitcnt vmcnt(56)
    buffer_load_dwordx4 v28, s[44:47], s23 offen offset:0 nt lds
    buffer_load_dwordx4 v29, s[44:47], s23 offen offset:1024 nt lds
    buffer_load_dwordx4 v30, s[44:47], s23 offen offset:2048 nt lds
    buffer_load_dwordx4 v31, s[44:47], s23 offen offset:3072 nt lds
    s_or_b32 s22, s22, 0x1f000
    s_add_u32 s22, s22, 512
    s_and_b32 s22, s22, 0x60e00
    s_add_u32 s20, s20, 16384
    s_cmp_eq_u32 s20, 98304
    s_cselect_b32 s20, 49152, s20
    s_waitcnt vmcnt(32)
    v_cmp_eq_u32 vcc, 1, v9
    v_and_b32 v10, 7, v2
    v_lshlrev_b32 v10, 9, v10
    s_cbranch_vccnz L_notlast
    buffer_store_dword v15, v14, s[8:11], s82 offen offset:128 sc1
L_notlast:
    s_waitcnt vmcnt(34)
    s_barrier
    s_add_u32 m0, s19, 0
    s_add_u32 s23, s21, 0
    s_waitcnt vmcnt(56)
    buffer_load_dwordx4 v16, s[40:43], s23 offen offset:0 nt lds
    buffer_load_dwordx4 v17, s[40:43], s23 offen offset:1024 nt lds
    buffer_load_dwordx4 v18, s[40:43], s23 offen offset:2048 nt lds
    buffer_load_dwordx4 v19, s[40:43], s23 offen offset:3072 nt lds
    s_add_u32 m0, s19, 4096
    s_add_u32 s23, s21, 32768
    s_waitcnt vmcnt(56)
    buffer_load_dwordx4 v20, s[40:43], s23 offen offset:0 nt lds
    buffer_load_dwordx4 v21, s[40:43], s23 offen offset:1024 nt lds
    buffer_load_dwordx4 v22, s[40:43], s23 offen offset:2048 nt lds
    buffer_load_dwordx4 v23, s[40:43], s23 offen offset:3072 nt lds
    s_add_u32 m0, s19, 8192
    s_add_u32 s23, s21, 65536
    s_waitcnt vmcnt(56)
    buffer_load_dwordx4 v16, s[40:43], s23 offen offset:0 nt lds
    buffer_load_dwordx4 v17, s[40:43], s23 offen offset:1024 nt lds
    buffer_load_dwordx4 v18, s[40:43], s23 offen offset:2048 nt lds
    buffer_load_dwordx4 v19, s[40:43], s23 offen offset:3072 nt lds
    s_add_u32 m0, s19, 12288
    s_add_u32 s23, s21, 98304
    s_waitcnt vmcnt(56)
    buffer_load_dwordx4 v20, s[40:43], s23 offen offset:0 nt lds
    buffer_load_dwordx4 v21, s[40:43], s23 offen offset:1024 nt lds
    buffer_load_dwordx4 v22, s[40:43], s23 offen offset:2048 nt lds
    buffer_load_dwordx4 v23, s[40:43], s23 offen offset:3072 nt lds
    s_or_b32 s21, s21, 0x1f000
    s_add_u32 s21, s21, 512
    s_and_b32 s21, s21, 0x60e00
    s_add_u32 s19, s19, 16384
    s_cmp_eq_u32 s19, 49152
    s_cselect_b32 s19, 0, s19
    s_add_u32 m0, s20, 0
    s_add_u32 s23, s22, 0
    s_waitcnt vmcnt(56)
    buffer_load_dwordx4 v28, s[44:47], s23 offen offset:0 nt lds
    buffer_load_dwordx4 v29, s[44:47], s23 offen offset:1024 nt lds
    buffer_load_dwordx4 v30, s[44:47], s23 offen offset:2048 nt lds
    buffer_load_dwordx4 v31, s[44:47], s23 offen offset:3072 nt lds
    s_add_u32 m0, s20, 4096
    s_add_u32 s23, s22, 32768
    s_waitcnt vmcnt(56)
    buffer_load_dwordx4 v28, s[44:47], s23 offen offset:0 nt lds
    buffer_load_dwordx4 v29, s[44:47], s23 offen offset:1024 nt lds
    buffer_load_dwordx4 v30, s[44:47], s23 offen offset:2048 nt lds
    buffer_load_dwordx4 v31, s[44:47], s23 offen offset:3072 nt lds
    s_add_u32 m0, s20, 8192
    s_add_u32 s23, s22, 65536
    s_waitcnt vmcnt(56)
    buffer_load_dwordx4 v28, s[44:47], s23 offen offset:0 nt lds
    buffer_load_dwordx4 v29, s[44:47], s23 offen offset:1024 nt lds
    buffer_load_dwordx4 v30, s[44:47], s23 offen offset:2048 nt lds
    buffer_load_dwordx4 v31, s[44:47], s23 offen offset:3072 nt lds
    s_add_u32 m0, s20, 12288
    s_add_u32 s23, s22, 98304
    s_waitcnt vmcnt(56)
    buffer_load_dwordx4 v28, s[44:47], s23 offen offset:0 nt lds
    buffer_load_dwordx4 v29, s[44:47], s23 offen offset:1024 nt lds
    buffer_load_dwordx4 v30, s[44:47], s23 offen offset:2048 nt lds
    buffer_load_dwordx4 v31, s[44:47], s23 offen offset:3072 nt lds
    s_or_b32 s22, s22, 0x1f000
    s_add_u32 s22, s22, 512
    s_and_b32 s22, s22, 0x60e00
    s_add_u32 s20, s20, 16384
    s_cmp_eq_u32 s20, 98304
    s_cselect_b32 s20, 49152, s20
    s_waitcnt vmcnt(32)
    s_barrier
    s_add_u32 m0, s20, 0
    s_add_u32 s23, s22, 0
    s_waitcnt vmcnt(56)
    buffer_load_dwordx4 v28, s[44:47], s23 offen offset:0 nt lds
    buffer_load_dwordx4 v29, s[44:47], s23 offen offset:1024 nt lds
    buffer_load_dwordx4 v30, s[44:47], s23 offen offset:2048 nt lds
    buffer_load_dwordx4 v31, s[44:47], s23 offen offset:3072 nt lds
    s_add_u32 m0, s20, 4096
    s_add_u32 s23, s22, 32768
    s_waitcnt vmcnt(56)
    buffer_load_dwordx4 v28, s[44:47], s23 offen offset:0 nt lds
    buffer_load_dwordx4 v29, s[44:47], s23 offen offset:1024 nt lds
    buffer_load_dwordx4 v30, s[44:47], s23 offen offset:2048 nt lds
    buffer_load_dwordx4 v31, s[44:47], s23 offen offset:3072 nt lds
    s_add_u32 m0, s20, 8192
    s_add_u32 s23, s22, 65536
    s_waitcnt vmcnt(56)
    buffer_load_dwordx4 v28, s[44:47], s23 offen offset:0 nt lds
    buffer_load_dwordx4 v29, s[44:47], s23 offen offset:1024 nt lds
    buffer_load_dwordx4 v30, s[44:47], s23 offen offset:2048 nt lds
    buffer_load_dwordx4 v31, s[44:47], s23 offen offset:3072 nt lds
    s_add_u32 m0, s20, 12288
    s_add_u32 s23, s22, 98304
    s_waitcnt vmcnt(56)
    buffer_load_dwordx4 v28, s[44:47], s23 offen offset:0 nt lds
    buffer_load_dwordx4 v29, s[44:47], s23 offen offset:1024 nt lds
    buffer_load_dwordx4 v30, s[44:47], s23 offen offset:2048 nt lds
    buffer_load_dwordx4 v31, s[44:47], s23 offen offset:3072 nt lds
    s_or_b32 s22, s22, 0x1f000
    s_add_u32 s22, s22, 512
    s_and_b32 s22, s22, 0x60e00
    s_add_u32 s20, s20, 16384
    s_cmp_eq_u32 s20, 98304
    s_cselect_b32 s20, 49152, s20
    s_waitcnt vmcnt(16)
    s_barrier
    s_mov_b32 m0, 0
    s_mov_b32 s23, 256
    s_waitcnt vmcnt(56)
    buffer_load_dwordx4 v24, s[52:55], s23 offen offset:0  lds
    buffer_load_dwordx4 v25, s[52:55], s23 offen offset:1024  lds
    buffer_load_dwordx4 v26, s[52:55], s23 offen offset:2048  lds
    buffer_load_dwordx4 v27, s[52:55], s23 offen offset:3072  lds
    s_mov_b32 m0, 4096
    s_mov_b32 s23, 28928
    s_waitcnt vmcnt(56)
    buffer_load_dwordx4 v24, s[52:55], s23 offen offset:0  lds
    buffer_load_dwordx4 v25, s[52:55], s23 offen offset:1024  lds
    buffer_load_dwordx4 v26, s[52:55], s23 offen offset:2048  lds
    buffer_load_dwordx4 v27, s[52:55], s23 offen offset:3072  lds
    s_mov_b32 m0, 8192
    s_mov_b32 s23, 57600
    s_waitcnt vmcnt(56)
    buffer_load_dwordx4 v24, s[52:55], s23 offen offset:0  lds
    buffer_load_dwordx4 v25, s[52:55], s23 offen offset:1024  lds
    buffer_load_dwordx4 v26, s[52:55], s23 offen offset:2048  lds
    buffer_load_dwordx4 v27, s[52:55], s23 offen offset:3072  lds
    s_mov_b32 m0, 12288
    s_mov_b32 s23, 86272
    s_waitcnt vmcnt(56)
    buffer_load_dwordx4 v24, s[52:55], s23 offen offset:0  lds
    buffer_load_dwordx4 v25, s[52:55], s23 offen offset:1024  lds
    buffer_load_dwordx4 v26, s[52:55], s23 offen offset:2048  lds
    buffer_load_dwordx4 v27, s[52:55], s23 offen offset:3072  lds
    s_load_dword s18, s[4:5], 0
    s_waitcnt vmcnt(16)
    s_barrier
    buffer_load_dword v9, v10, s[8:11], 0 offen offset:128 sc1
    s_mov_b32 m0, 16384
    s_mov_b32 s23, 114944
    s_waitcnt vmcnt(56)
    buffer_load_dwordx4 v24, s[52:55], s23 offen offset:0  lds
    buffer_load_dwordx4 v25, s[52:55], s23 offen offset:1024  lds
    buffer_load_dwordx4 v26, s[52:55], s23 offen offset:2048  lds
    buffer_load_dwordx4 v27, s[52:55], s23 offen offset:3072  lds
    s_mov_b32 m0, 20480
    s_mov_b32 s23, 143616
    s_waitcnt vmcnt(56)
    buffer_load_dwordx4 v24, s[52:55], s23 offen offset:0  lds
    buffer_load_dwordx4 v25, s[52:55], s23 offen offset:1024  lds
    buffer_load_dwordx4 v26, s[52:55], s23 offen offset:2048  lds
    buffer_load_dwordx4 v27, s[52:55], s23 offen offset:3072  lds
    s_mov_b32 m0, 24576
    s_mov_b32 s23, 172288
    s_waitcnt vmcnt(56)
    buffer_load_dwordx4 v24, s[52:55], s23 offen offset:0  lds
    buffer_load_dwordx4 v25, s[52:55], s23 offen offset:1024  lds
    buffer_load_dwordx4 v26, s[52:55], s23 offen offset:2048  lds
    buffer_load_dwordx4 v27, s[52:55], s23 offen offset:3072  lds
    s_mov_b32 m0, 28672
    s_mov_b32 s23, 200960
    s_waitcnt vmcnt(56)
    buffer_load_dwordx4 v24, s[52:55], s23 offen offset:0  lds
    buffer_load_dwordx4 v25, s[52:55], s23 offen offset:1024  lds
    buffer_load_dwordx4 v26, s[52:55], s23 offen offset:2048  lds
    buffer_load_dwordx4 v27, s[52:55], s23 offen offset:3072  lds
    s_mov_b32 m0, 32768
    s_mov_b32 s23, 384
    s_waitcnt vmcnt(56)
    buffer_load_dwordx4 v24, s[52:55], s23 offen offset:0  lds
    buffer_load_dwordx4 v25, s[52:55], s23 offen offset:1024  lds
    buffer_load_dwordx4 v26, s[52:55], s23 offen offset:2048  lds
    buffer_load_dwordx4 v27, s[52:55], s23 offen offset:3072  lds
    s_mov_b32 m0, 36864
    s_mov_b32 s23, 29056
    s_waitcnt vmcnt(56)
    buffer_load_dwordx4 v24, s[52:55], s23 offen offset:0  lds
    buffer_load_dwordx4 v25, s[52:55], s23 offen offset:1024  lds
    buffer_load_dwordx4 v26, s[52:55], s23 offen offset:2048  lds
    buffer_load_dwordx4 v27, s[52:55], s23 offen offset:3072  lds
    s_mov_b32 m0, 40960
    s_mov_b32 s23, 57728
    s_waitcnt vmcnt(56)
    buffer_load_dwordx4 v24, s[52:55], s23 offen offset:0  lds
    buffer_load_dwordx4 v25, s[52:55], s23 offen offset:1024  lds
    buffer_load_dwordx4 v26, s[52:55], s23 offen offset:2048  lds
    buffer_load_dwordx4 v27, s[52:55], s23 offen offset:3072  lds
    s_mov_b32 m0, 45056
    s_mov_b32 s23, 86400
    s_waitcnt vmcnt(56)
    buffer_load_dwordx4 v24, s[52:55], s23 offen offset:0  lds
    buffer_load_dwordx4 v25, s[52:55], s23 offen offset:1024  lds
    buffer_load_dwordx4 v26, s[52:55], s23 offen offset:2048  lds
    buffer_load_dwordx4 v27, s[52:55], s23 offen offset:3072  lds
    s_mov_b32 m0, 49152
    s_mov_b32 s23, 115072
    s_waitcnt vmcnt(56)
    buffer_load_dwordx4 v24, s[52:55], s23 offen offset:0  lds
    buffer_load_dwordx4 v25, s[52:55], s23 offen offset:1024  lds
    buffer_load_dwordx4 v26, s[52:55], s23 offen offset:2048  lds
    buffer_load_dwordx4 v27, s[52:55], s23 offen offset:3072  lds
    s_mov_b32 m0, 53248
    s_mov_b32 s23, 143744
    s_waitcnt vmcnt(56)
    buffer_load_dwordx4 v24, s[52:55], s23 offen offset:0  lds
    buffer_load_dwordx4 v25, s[52:55], s23 offen offset:1024  lds
    buffer_load_dwordx4 v26, s[52:55], s23 offen offset:2048  lds
    buffer_load_dwordx4 v27, s[52:55], s23 offen offset:3072  lds
    s_mov_b32 m0, 57344
    s_mov_b32 s23, 172416
    s_waitcnt vmcnt(56)
    buffer_load_dwordx4 v24, s[52:55], s23 offen offset:0  lds
    buffer_load_dwordx4 v25, s[52:55], s23 offen offset:1024  lds
    buffer_load_dwordx4 v26, s[52:55], s23 offen offset:2048  lds
    buffer_load_dwordx4 v27, s[52:55], s23 offen offset:3072  lds
    s_mov_b32 m0, 61440
    s_mov_b32 s23, 201088
    s_waitcnt vmcnt(56)
    buffer_load_dwordx4 v24, s[52:55], s23 offen offset:0  lds
    buffer_load_dwordx4 v25, s[52:55], s23 offen offset:1024  lds
    buffer_load_dwordx4 v26, s[52:55], s23 offen offset:2048  lds
    buffer_load_dwordx4 v27, s[52:55], s23 offen offset:3072  lds
    s_mov_b32 m0, 81920
    s_mov_b32 s23, 512
    s_waitcnt vmcnt(56)
    buffer_load_dwordx4 v24, s[52:55], s23 offen offset:0  lds
    buffer_load_dwordx4 v25, s[52:55], s23 offen offset:1024  lds
    buffer_load_dwordx4 v26, s[52:55], s23 offen offset:2048  lds
    buffer_load_dwordx4 v27, s[52:55], s23 offen offset:3072  lds
    s_mov_b32 m0, 86016
    s_mov_b32 s23, 29184
    s_waitcnt vmcnt(56)
    buffer_load_dwordx4 v24, s[52:55], s23 offen offset:0  lds
    buffer_load_dwordx4 v25, s[52:55], s23 offen offset:1024  lds
    buffer_load_dwordx4 v26, s[52:55], s23 offen offset:2048  lds
    buffer_load_dwordx4 v27, s[52:55], s23 offen offset:3072  lds
    s_mov_b32 m0, 90112
    s_mov_b32 s23, 57856
    s_waitcnt vmcnt(56)
    buffer_load_dwordx4 v24, s[52:55], s23 offen offset:0  lds
    buffer_load_dwordx4 v25, s[52:55], s23 offen offset:1024  lds
    buffer_load_dwordx4 v26, s[52:55], s23 offen offset:2048  lds
    buffer_load_dwordx4 v27, s[52:55], s23 offen offset:3072  lds
    s_mov_b32 m0, 94208
    s_mov_b32 s23, 86528
    s_waitcnt vmcnt(56)
    buffer_load_dwordx4 v24, s[52:55], s23 offen offset:0  lds
    buffer_load_dwordx4 v25, s[52:55], s23 offen offset:1024  lds
    buffer_load_dwordx4 v26, s[52:55], s23 offen offset:2048  lds
    buffer_load_dwordx4 v27, s[52:55], s23 offen offset:3072  lds
    s_mul_i32 s3, s28, 1376256
    s_add_u32 s84, s80, s3
    s_addc_u32 s85, s81, 0
    s_mov_b32 s86, 1376256
    s_mov_b32 s87, 0x20000
    s_mul_i32 s3, s29, 172032
    s_mul_i32 s23, s30, 896
    s_add_u32 s3, s3, s23
    s_sub_u32 s23, 172032, s23
    s_add_u32 s72, s76, s3
    s_addc_u32 s73, s77, 0
    s_mov_b32 s74, s23
    s_mov_b32 s75, 0x20000
    v_lshrrev_b32 v5, 5, v2
    v_bfe_u32 v6, v2, 3, 1
    v_and_b32 v7, 7, v2
    v_and_b32 v4, 16, v2
    v_lshlrev_b32 v8, 11, v6
    v_lshl_add_u32 v8, v4, 5, v8
    v_lshl_add_u32 v8, v5, 8, v8
    v_lshl_add_u32 v0, v7, 4, v8
    v_mul_u32_u24 v8, 1792, v7
    v_lshl_add_u32 v8, v6, 6, v8
    v_lshl_add_u32 v8, v5, 5, v8
    v_add_u32 v11, v8, v4
    v_and_b32 v8, 15, v2
    v_lshlrev_b32 v12, 6, v8
    s_add_u32 s26, s31, 0
    s_mul_i32 s39, s26, 43
    s_lshr_b32 s39, s39, 9
    s_mul_i32 s3, s39, 12
    s_sub_u32 s3, s26, s3
    s_lshr_b32 s23, s3, 2
    s_mul_i32 s36, s23, 28672
    s_lshl_b32 s38, s23, 10
    s_lshl_b32 s23, s39, 12
    s_add_u32 s36, s36, s23
    s_and_b32 s23, s3, 2
    s_lshl_b32 s23, s23, 9
    s_add_u32 s36, s36, s23
    s_and_b32 s23, s3, 1
    s_lshl_b32 s23, s23, 7
    s_add_u32 s36, s36, s23
    s_mul_i32 s37, s3, 14336
    s_lshl_b32 s23, s39, 7
    s_add_u32 s37, s37, s23
    s_add_u32 s26, s31, 16
    s_mul_i32 s43, s26, 43
    s_lshr_b32 s43, s43, 9
    s_mul_i32 s3, s43, 12
    s_sub_u32 s3, s26, s3
    s_lshr_b32 s23, s3, 2
    s_mul_i32 s40, s23, 28672
    s_lshl_b32 s42, s23, 10
    s_lshl_b32 s23, s43, 12
    s_add_u32 s40, s40, s23
    s_and_b32 s23, s3, 2
    s_lshl_b32 s23, s23, 9
    s_add_u32 s40, s40, s23
    s_and_b32 s23, s3, 1
    s_lshl_b32 s23, s23, 7
    s_add_u32 s40, s40, s23
    s_mul_i32 s41, s3, 14336
    s_lshl_b32 s23, s43, 7
    s_add_u32 s41, s41, s23
    s_add_u32 s26, s31, 32
    s_mul_i32 s47, s26, 43
    s_lshr_b32 s47, s47, 9
    s_mul_i32 s3, s47, 12
    s_sub_u32 s3, s26, s3
    s_lshr_b32 s23, s3, 2
    s_mul_i32 s44, s23, 28672
    s_lshl_b32 s46, s23, 10
    s_lshl_b32 s23, s47, 12
    s_add_u32 s44, s44, s23
    s_and_b32 s23, s3, 2
    s_lshl_b32 s23, s23, 9
    s_add_u32 s44, s44, s23
    s_and_b32 s23, s3, 1
    s_lshl_b32 s23, s23, 7
    s_add_u32 s44, s44, s23
    s_mul_i32 s45, s3, 14336
    s_lshl_b32 s23, s47, 7
    s_add_u32 s45, s45, s23
    s_mov_b32 s24, 0
    s_waitcnt vmcnt(56)
    v_cmp_eq_u32 vcc, 0, v9
    s_nop 0
    s_cbranch_vccz L_gated
L_gate:
L_gate1:
    buffer_load_dword v9, v10, s[8:11], 0 offen offset:128 sc1
    s_add_u32 s24, s24, 1
    s_waitcnt vmcnt(0)
    v_cmp_eq_u32 vcc, 0, v9
    s_cmp_gt_u32 s24, 20
    s_cbranch_scc1 L_gated
    s_cbranch_vccnz L_gate
L_gated:
    s_waitcnt vmcnt(63)
    s_barrier
    s_mov_b32 m0, 65536
    s_mov_b32 s23, 115200
    s_waitcnt vmcnt(56)
    buffer_load_dwordx4 v24, s[52:55], s23 offen offset:0  lds
    buffer_load_dwordx4 v25, s[52:55], s23 offen offset:1024  lds
    buffer_load_dwordx4 v26, s[52:55], s23 offen offset:2048  lds
    buffer_load_dwordx4 v27, s[52:55], s23 offen offset:3072  lds
    s_mov_b32 m0, 69632
    s_mov_b32 s23, 143872
    s_waitcnt vmcnt(56)
    buffer_load_dwordx4 v24, s[52:55], s23 offen offset:0  lds
    buffer_load_dwordx4 v25, s[52:55], s23 offen offset:1024  lds
    buffer_load_dwordx4 v26, s[52:55], s23 offen offset:2048  lds
    buffer_load_dwordx4 v27, s[52:55], s23 offen offset:3072  lds
    s_mov_b32 m0, 73728
    s_mov_b32 s23, 172544
    s_waitcnt vmcnt(56)
    buffer_load_dwordx4 v24, s[52:55], s23 offen offset:0  lds
    buffer_load_dwordx4 v25, s[52:55], s23 offen offset:1024  lds
    buffer_load_dwordx4 v26, s[52:55], s23 offen offset:2048  lds
    buffer_load_dwordx4 v27, s[52:55], s23 offen offset:3072  lds
    s_mov_b32 m0, 77824
    s_mov_b32 s23, 201216
    s_waitcnt vmcnt(56)
    buffer_load_dwordx4 v24, s[52:55], s23 offen offset:0  lds
    buffer_load_dwordx4 v25, s[52:55], s23 offen offset:1024  lds
    buffer_load_dwordx4 v26, s[52:55], s23 offen offset:2048  lds
    buffer_load_dwordx4 v27, s[52:55], s23 offen offset:3072  lds
    s_waitcnt lgkmcnt(0)
    s_cmp_eq_u32 s18, 1
    s_cbranch_scc1 L_pdone_c
    v_mov_b32 v10, 0
    s_mov_b32 s24, 0
L_poll_c:
    buffer_load_dword v9, v10, s[4:7], 0 offen sc1
    s_add_u32 s24, s24, 1
    s_cmp_gt_u32 s24, 0x40000
    s_cbranch_scc1 L_pdone_c
    s_waitcnt vmcnt(0)
    v_cmp_ge_u32 vcc, 0, v9
    s_cbranch_vccnz L_poll_c
L_pdone_c:
    s_waitcnt vmcnt(63)
    s_barrier
    s_mov_b32 m0, 98304
    s_mov_b32 s23, 640
    s_waitcnt vmcnt(56)
    buffer_load_dwordx4 v24, s[52:55], s23 offen offset:0  lds
    buffer_load_dwordx4 v25, s[52:55], s23 offen offset:1024  lds
    buffer_load_dwordx4 v26, s[52:55], s23 offen offset:2048  lds
    buffer_load_dwordx4 v27, s[52:55], s23 offen offset:3072  lds
    s_mov_b32 m0, 102400
    s_mov_b32 s23, 29312
    s_waitcnt vmcnt(56)
    buffer_load_dwordx4 v24, s[52:55], s23 offen offset:0  lds
    buffer_load_dwordx4 v25, s[52:55], s23 offen offset:1024  lds
    buffer_load_dwordx4 v26, s[52:55], s23 offen offset:2048  lds
    buffer_load_dwordx4 v27, s[52:55], s23 offen offset:3072  lds
    s_mov_b32 m0, 106496
    s_mov_b32 s23, 57984
    s_waitcnt vmcnt(56)
    buffer_load_dwordx4 v24, s[52:55], s23 offen offset:0  lds
    buffer_load_dwordx4 v25, s[52:55], s23 offen offset:1024  lds
    buffer_load_dwordx4 v26, s[52:55], s23 offen offset:2048  lds
    buffer_load_dwordx4 v27, s[52:55], s23 offen offset:3072  lds
    s_mov_b32 m0, 110592
    s_mov_b32 s23, 86656
    s_waitcnt vmcnt(56)
    buffer_load_dwordx4 v24, s[52:55], s23 offen offset:0  lds
    buffer_load_dwordx4 v25, s[52:55], s23 offen offset:1024  lds
    buffer_load_dwordx4 v26, s[52:55], s23 offen offset:2048  lds
    buffer_load_dwordx4 v27, s[52:55], s23 offen offset:3072  lds
    s_mov_b32 m0, 114688
    s_mov_b32 s23, 115328
    s_waitcnt vmcnt(56)
    buffer_load_dwordx4 v24, s[52:55], s23 offen offset:0  lds
    buffer_load_dwordx4 v25, s[52:55], s23 offen offset:1024  lds
    buffer_load_dwordx4 v26, s[52:55], s23 offen offset:2048  lds
    buffer_load_dwordx4 v27, s[52:55], s23 offen offset:3072  lds
    s_mov_b32 m0, 118784
    s_mov_b32 s23, 144000
    s_waitcnt vmcnt(56)
    buffer_load_dwordx4 v24, s[52:55], s23 offen offset:0  lds
    buffer_load_dwordx4 v25, s[52:55], s23 offen offset:1024  lds
    buffer_load_dwordx4 v26, s[52:55], s23 offen offset:2048  lds
    buffer_load_dwordx4 v27, s[52:55], s23 offen offset:3072  lds
    s_mov_b32 m0, 122880
    s_mov_b32 s23, 172672
    s_waitcnt vmcnt(56)
    buffer_load_dwordx4 v24, s[52:55], s23 offen offset:0  lds
    buffer_load_dwordx4 v25, s[52:55], s23 offen offset:1024  lds
    buffer_load_dwordx4 v26, s[52:55], s23 offen offset:2048  lds
    buffer_load_dwordx4 v27, s[52:55], s23 offen offset:3072  lds
    s_mov_b32 m0, 126976
    s_mov_b32 s23, 201344
    s_waitcnt vmcnt(56)
    buffer_load_dwordx4 v24, s[52:55], s23 offen offset:0  lds
    buffer_load_dwordx4 v25, s[52:55], s23 offen offset:1024  lds
    buffer_load_dwordx4 v26, s[52:55], s23 offen offset:2048  lds
    buffer_load_dwordx4 v27, s[52:55], s23 offen offset:3072  lds
    s_waitcnt vmcnt(63)
    s_barrier
    s_mov_b32 m0, 131072
    s_mov_b32 s23, 768
    s_waitcnt vmcnt(56)
    buffer_load_dwordx4 v24, s[52:55], s23 offen offset:0  lds
    buffer_load_dwordx4 v25, s[52:55], s23 offen offset:1024  lds
    buffer_load_dwordx4 v26, s[52:55], s23 offen offset:2048  lds
    buffer_load_dwordx4 v27, s[52:55], s23 offen offset:3072  lds
    s_mov_b32 m0, 135168
    s_mov_b32 s23, 29440
    s_waitcnt vmcnt(56)
    buffer_load_dwordx4 v24, s[52:55], s23 offen offset:0  lds
    buffer_load_dwordx4 v25, s[52:55], s23 offen offset:1024  lds
    buffer_load_dwordx4 v26, s[52:55], s23 offen offset:2048  lds
    buffer_load_dwordx4 v27, s[52:55], s23 offen offset:3072  lds
    s_mov_b32 m0, 139264
    s_mov_b32 s23, 58112
    s_waitcnt vmcnt(56)
    buffer_load_dwordx4 v24, s[52:55], s23 offen offset:0  lds
    buffer_load_dwordx4 v25, s[52:55], s23 offen offset:1024  lds
    buffer_load_dwordx4 v26, s[52:55], s23 offen offset:2048  lds
    buffer_load_dwordx4 v27, s[52:55], s23 offen offset:3072  lds
    s_mov_b32 m0, 143360
    s_mov_b32 s23, 86784
    s_waitcnt vmcnt(56)
    buffer_load_dwordx4 v24, s[52:55], s23 offen offset:0  lds
    buffer_load_dwordx4 v25, s[52:55], s23 offen offset:1024  lds
    buffer_load_dwordx4 v26, s[52:55], s23 offen offset:2048  lds
    buffer_load_dwordx4 v27, s[52:55], s23 offen offset:3072  lds
    s_mov_b32 m0, 147456
    s_mov_b32 s23, 115456
    s_waitcnt vmcnt(56)
    buffer_load_dwordx4 v24, s[52:55], s23 offen offset:0  lds
    buffer_load_dwordx4 v25, s[52:55], s23 offen offset:1024  lds
    buffer_load_dwordx4 v26, s[52:55], s23 offen offset:2048  lds
    buffer_load_dwordx4 v27, s[52:55], s23 offen offset:3072  lds
    s_mov_b32 m0, 151552
    s_mov_b32 s23, 144128
    s_waitcnt vmcnt(56)
    buffer_load_dwordx4 v24, s[52:55], s23 offen offset:0  lds
    buffer_load_dwordx4 v25, s[52:55], s23 offen offset:1024  lds
    buffer_load_dwordx4 v26, s[52:55], s23 offen offset:2048  lds
    buffer_load_dwordx4 v27, s[52:55], s23 offen offset:3072  lds
    s_mov_b32 m0, 155648
    s_mov_b32 s23, 172800
    s_waitcnt vmcnt(56)
    buffer_load_dwordx4 v24, s[52:55], s23 offen offset:0  lds
    buffer_load_dwordx4 v25, s[52:55], s23 offen offset:1024  lds
    buffer_load_dwordx4 v26, s[52:55], s23 offen offset:2048  lds
    buffer_load_dwordx4 v27, s[52:55], s23 offen offset:3072  lds
    s_mov_b32 m0, 159744
    s_mov_b32 s23, 201472
    s_waitcnt vmcnt(56)
    buffer_load_dwordx4 v24, s[52:55], s23 offen offset:0  lds
    buffer_load_dwordx4 v25, s[52:55], s23 offen offset:1024  lds
    buffer_load_dwordx4 v26, s[52:55], s23 offen offset:2048  lds
    buffer_load_dwordx4 v27, s[52:55], s23 offen offset:3072  lds
    s_waitcnt vmcnt(63)
    s_barrier
    s_waitcnt vmcnt(0)
    s_barrier
    v_lshrrev_b32 v10, 4, v2
    v_min_u32 v10, 2, v10
    v_lshl_add_u32 v10, v10, 10, v12
    s_cmp_lt_u32 s31, 4
    s_cbranch_scc1 L_three
    s_mov_b32 s24, 0
    s_mov_b32 s26, 0xffff
    s_mov_b32 s27, 0
    s_cmp_eq_u32 s27, 0
    s_cbranch_scc1 L_rf0_l2
L_rb0_l2:
    s_ff1_i32_b32 s3, s27
    s_bitset0_b32 s27, s3
    s_mul_i32 s3, s3, 86016
    s_add_u32 s23, s3, s36
    buffer_load_dwordx4 v[64:67], v0, s[84:87], s23 offen sc1
    s_add_u32 s23, s3, s40
    buffer_load_dwordx4 v[128:131], v0, s[84:87], s23 offen sc1
    s_cmp_eq_u32 s27, 0
    s_cbranch_scc1 L_rf1_l2
L_rb1_l2:
    s_ff1_i32_b32 s3, s27
    s_bitset0_b32 s27, s3
    s_mul_i32 s3, s3, 86016
    s_add_u32 s23, s3, s36
    buffer_load_dwordx4 v[68:71], v0, s[84:87], s23 offen sc1
    s_add_u32 s23, s3, s40
    buffer_load_dwordx4 v[132:135], v0, s[84:87], s23 offen sc1
    s_cmp_eq_u32 s27, 0
    s_cbranch_scc1 L_rf2_l2
L_rb2_l2:
    s_ff1_i32_b32 s3, s27
    s_bitset0_b32 s27, s3
    s_mul_i32 s3, s3, 86016
    s_add_u32 s23, s3, s36
    buffer_load_dwordx4 v[72:75], v0, s[84:87], s23 offen sc1
    s_add_u32 s23, s3, s40
    buffer_load_dwordx4 v[136:139], v0, s[84:87], s23 offen sc1
    s_cmp_eq_u32 s27, 0
    s_cbranch_scc1 L_rf3_l2
L_rb3_l2:
    s_ff1_i32_b32 s3, s27
    s_bitset0_b32 s27, s3
    s_mul_i32 s3, s3, 86016
    s_add_u32 s23, s3, s36
    buffer_load_dwordx4 v[76:79], v0, s[84:87], s23 offen sc1
    s_add_u32 s23, s3, s40
    buffer_load_dwordx4 v[140:143], v0, s[84:87], s23 offen sc1
    s_cmp_eq_u32 s27, 0
    s_cbranch_scc1 L_rf4_l2
L_rb4_l2:
    s_ff1_i32_b32 s3, s27
    s_bitset0_b32 s27, s3
    s_mul_i32 s3, s3, 86016
    s_add_u32 s23, s3, s36
    buffer_load_dwordx4 v[80:83], v0, s[84:87], s23 offen sc1
    s_add_u32 s23, s3, s40
    buffer_load_dwordx4 v[144:147], v0, s[84:87], s23 offen sc1
    s_cmp_eq_u32 s27, 0
    s_cbranch_scc1 L_rf5_l2
L_rb5_l2:
    s_ff1_i32_b32 s3, s27
    s_bitset0_b32 s27, s3
    s_mul_i32 s3, s3, 86016
    s_add_u32 s23, s3, s36
    buffer_load_dwordx4 v[84:87], v0, s[84:87], s23 offen sc1
    s_add_u32 s23, s3, s40
    buffer_load_dwordx4 v[148:151], v0, s[84:87], s23 offen sc1
    s_cmp_eq_u32 s27, 0
    s_cbranch_scc1 L_rf6_l2
L_rb6_l2:
    s_ff1_i32_b32 s3, s27
    s_bitset0_b32 s27, s3
    s_mul_i32 s3, s3, 86016
    s_add_u32 s23, s3, s36
    buffer_load_dwordx4 v[88:91], v0, s[84:87], s23 offen sc1
    s_add_u32 s23, s3, s40
    buffer_load_dwordx4 v[152:155], v0, s[84:87], s23 offen sc1
    s_cmp_eq_u32 s27, 0
    s_cbranch_scc1 L_rf7_l2
L_rb7_l2:
    s_ff1_i32_b32 s3, s27
    s_bitset0_b32 s27, s3
    s_mul_i32 s3, s3, 86016
    s_add_u32 s23, s3, s36
    buffer_load_dwordx4 v[92:95], v0, s[84:87], s23 offen sc1
    s_add_u32 s23, s3, s40
    buffer_load_dwordx4 v[156:159], v0, s[84:87], s23 offen sc1
    s_cmp_eq_u32 s27, 0
    s_cbranch_scc1 L_rf8_l2
L_rb8_l2:
    s_ff1_i32_b32 s3, s27
    s_bitset0_b32 s27, s3
    s_mul_i32 s3, s3, 86016
    s_add_u32 s23, s3, s36
    buffer_load_dwordx4 v[96:99], v0, s[84:87], s23 offen sc1
    s_add_u32 s23, s3, s40
    buffer_load_dwordx4 v[160:163], v0, s[84:87], s23 offen sc1
    s_cmp_eq_u32 s27, 0
    s_cbranch_scc1 L_rf9_l2
L_rb9_l2:
    s_ff1_i32_b32 s3, s27
    s_bitset0_b32 s27, s3
    s_mul_i32 s3, s3, 86016
    s_add_u32 s23, s3, s36
    buffer_load_dwordx4 v[100:103], v0, s[84:87], s23 offen sc1
    s_add_u32 s23, s3, s40
    buffer_load_dwordx4 v[164:167], v0, s[84:87], s23 offen sc1
    s_cmp_eq_u32 s27, 0
    s_cbranch_scc1 L_rf10_l2
L_rb10_l2:
    s_ff1_i32_b32 s3, s27
    s_bitset0_b32 s27, s3
    s_mul_i32 s3, s3, 86016
    s_add_u32 s23, s3, s36
    buffer_load_dwordx4 v[104:107], v0, s[84:87], s23 offen sc1
    s_add_u32 s23, s3, s40
    buffer_load_dwordx4 v[168:171], v0, s[84:87], s23 offen sc1
    s_cmp_eq_u32 s27, 0
    s_cbranch_scc1 L_rf11_l2
L_rb11_l2:
    s_ff1_i32_b32 s3, s27
    s_bitset0_b32 s27, s3
    s_mul_i32 s3, s3, 86016
    s_add_u32 s23, s3, s36
    buffer_load_dwordx4 v[108:111], v0, s[84:87], s23 offen sc1
    s_add_u32 s23, s3, s40
    buffer_load_dwordx4 v[172:175], v0, s[84:87], s23 offen sc1
    s_cmp_eq_u32 s27, 0
    s_cbranch_scc1 L_rf12_l2
L_rb12_l2:
    s_ff1_i32_b32 s3, s27
    s_bitset0_b32 s27, s3
    s_mul_i32 s3, s3, 86016
    s_add_u32 s23, s3, s36
    buffer_load_dwordx4 v[112:115], v0, s[84:87], s23 offen sc1
    s_add_u32 s23, s3, s40
    buffer_load_dwordx4 v[176:179], v0, s[84:87], s23 offen sc1
    s_cmp_eq_u32 s27, 0
    s_cbranch_scc1 L_rf13_l2
L_rb13_l2:
    s_ff1_i32_b32 s3, s27
    s_bitset0_b32 s27, s3
    s_mul_i32 s3, s3, 86016
    s_add_u32 s23, s3, s36
    buffer_load_dwordx4 v[116:119], v0, s[84:87], s23 offen sc1
    s_add_u32 s23, s3, s40
    buffer_load_dwordx4 v[180:183], v0, s[84:87], s23 offen sc1
    s_cmp_eq_u32 s27, 0
    s_cbranch_scc1 L_rf14_l2
L_rb14_l2:
    s_ff1_i32_b32 s3, s27
    s_bitset0_b32 s27, s3
    s_mul_i32 s3, s3, 86016
    s_add_u32 s23, s3, s36
    buffer_load_dwordx4 v[120:123], v0, s[84:87], s23 offen sc1
    s_add_u32 s23, s3, s40
    buffer_load_dwordx4 v[184:187], v0, s[84:87], s23 offen sc1
    s_cmp_eq_u32 s27, 0
    s_cbranch_scc1 L_rf15_l2
L_rb15_l2:
    s_ff1_i32_b32 s3, s27
    s_bitset0_b32 s27, s3
    s_mul_i32 s3, s3, 86016
    s_add_u32 s23, s3, s36
    buffer_load_dwordx4 v[124:127], v0, s[84:87], s23 offen sc1
    s_add_u32 s23, s3, s40
    buffer_load_dwordx4 v[188:191], v0, s[84:87], s23 offen sc1
    s_waitcnt vmcnt(30)
    v_lshlrev_b32 v40, 16, v64
    v_and_b32 v41, 0xffff0000, v64
    v_lshlrev_b32 v42, 16, v65
    v_and_b32 v43, 0xffff0000, v65
    v_lshlrev_b32 v44, 16, v66
    v_and_b32 v45, 0xffff0000, v66
    v_lshlrev_b32 v46, 16, v67
    v_and_b32 v47, 0xffff0000, v67
    v_lshlrev_b32 v48, 16, v128
    v_and_b32 v49, 0xffff0000, v128
    v_lshlrev_b32 v50, 16, v129
    v_and_b32 v51, 0xffff0000, v129
    v_lshlrev_b32 v52, 16, v130
    v_and_b32 v53, 0xffff0000, v130
    v_lshlrev_b32 v54, 16, v131
    v_and_b32 v55, 0xffff0000, v131
    s_waitcnt vmcnt(28)
    v_lshlrev_b32 v4, 16, v68
    v_and_b32 v5, 0xffff0000, v68
    v_pk_add_f32 v[40:41], v[40:41], v[4:5]
    v_lshlrev_b32 v6, 16, v69
    v_and_b32 v7, 0xffff0000, v69
    v_pk_add_f32 v[42:43], v[42:43], v[6:7]
    v_lshlrev_b32 v4, 16, v70
    v_and_b32 v5, 0xffff0000, v70
    v_pk_add_f32 v[44:45], v[44:45], v[4:5]
    v_lshlrev_b32 v6, 16, v71
    v_and_b32 v7, 0xffff0000, v71
    v_pk_add_f32 v[46:47], v[46:47], v[6:7]
    v_lshlrev_b32 v4, 16, v132
    v_and_b32 v5, 0xffff0000, v132
    v_pk_add_f32 v[48:49], v[48:49], v[4:5]
    v_lshlrev_b32 v6, 16, v133
    v_and_b32 v7, 0xffff0000, v133
    v_pk_add_f32 v[50:51], v[50:51], v[6:7]
    v_lshlrev_b32 v4, 16, v134
    v_and_b32 v5, 0xffff0000, v134
    v_pk_add_f32 v[52:53], v[52:53], v[4:5]
    v_lshlrev_b32 v6, 16, v135
    v_and_b32 v7, 0xffff0000, v135
    v_pk_add_f32 v[54:55], v[54:55], v[6:7]
    s_waitcnt vmcnt(26)
    v_lshlrev_b32 v4, 16, v72
    v_and_b32 v5, 0xffff0000, v72
    v_pk_add_f32 v[40:41], v[40:41], v[4:5]
    v_lshlrev_b32 v6, 16, v73
    v_and_b32 v7, 0xffff0000, v73
    v_pk_add_f32 v[42:43], v[42:43], v[6:7]
    v_lshlrev_b32 v4, 16, v74
    v_and_b32 v5, 0xffff0000, v74
    v_pk_add_f32 v[44:45], v[44:45], v[4:5]
    v_lshlrev_b32 v6, 16, v75
    v_and_b32 v7, 0xffff0000, v75
    v_pk_add_f32 v[46:47], v[46:47], v[6:7]
    v_lshlrev_b32 v4, 16, v136
    v_and_b32 v5, 0xffff0000, v136
    v_pk_add_f32 v[48:49], v[48:49], v[4:5]
    v_lshlrev_b32 v6, 16, v137
    v_and_b32 v7, 0xffff0000, v137
    v_pk_add_f32 v[50:51], v[50:51], v[6:7]
    v_lshlrev_b32 v4, 16, v138
    v_and_b32 v5, 0xffff0000, v138
    v_pk_add_f32 v[52:53], v[52:53], v[4:5]
    v_lshlrev_b32 v6, 16, v139
    v_and_b32 v7, 0xffff0000, v139
    v_pk_add_f32 v[54:55], v[54:55], v[6:7]
    s_waitcnt vmcnt(24)
    v_lshlrev_b32 v4, 16, v76
    v_and_b32 v5, 0xffff0000, v76
    v_pk_add_f32 v[40:41], v[40:41], v[4:5]
    v_lshlrev_b32 v6, 16, v77
    v_and_b32 v7, 0xffff0000, v77
    v_pk_add_f32 v[42:43], v[42:43], v[6:7]
    v_lshlrev_b32 v4, 16, v78
    v_and_b32 v5, 0xffff0000, v78
    v_pk_add_f32 v[44:45], v[44:45], v[4:5]
    v_lshlrev_b32 v6, 16, v79
    v_and_b32 v7, 0xffff0000, v79
    v_pk_add_f32 v[46:47], v[46:47], v[6:7]
    v_lshlrev_b32 v4, 16, v140
    v_and_b32 v5, 0xffff0000, v140
    v_pk_add_f32 v[48:49], v[48:49], v[4:5]
    v_lshlrev_b32 v6, 16, v141
    v_and_b32 v7, 0xffff0000, v141
    v_pk_add_f32 v[50:51], v[50:51], v[6:7]
    v_lshlrev_b32 v4, 16, v142
    v_and_b32 v5, 0xffff0000, v142
    v_pk_add_f32 v[52:53], v[52:53], v[4:5]
    v_lshlrev_b32 v6, 16, v143
    v_and_b32 v7, 0xffff0000, v143
    v_pk_add_f32 v[54:55], v[54:55], v[6:7]
    s_waitcnt vmcnt(22)
    v_lshlrev_b32 v4, 16, v80
    v_and_b32 v5, 0xffff0000, v80
    v_pk_add_f32 v[40:41], v[40:41], v[4:5]
    v_lshlrev_b32 v6, 16, v81
    v_and_b32 v7, 0xffff0000, v81
    v_pk_add_f32 v[42:43], v[42:43], v[6:7]
    v_lshlrev_b32 v4, 16, v82
    v_and_b32 v5, 0xffff0000, v82
    v_pk_add_f32 v[44:45], v[44:45], v[4:5]
    v_lshlrev_b32 v6, 16, v83
    v_and_b32 v7, 0xffff0000, v83
    v_pk_add_f32 v[46:47], v[46:47], v[6:7]
    v_lshlrev_b32 v4, 16, v144
    v_and_b32 v5, 0xffff0000, v144
    v_pk_add_f32 v[48:49], v[48:49], v[4:5]
    v_lshlrev_b32 v6, 16, v145
    v_and_b32 v7, 0xffff0000, v145
    v_pk_add_f32 v[50:51], v[50:51], v[6:7]
    v_lshlrev_b32 v4, 16, v146
    v_and_b32 v5, 0xffff0000, v146
    v_pk_add_f32 v[52:53], v[52:53], v[4:5]
    v_lshlrev_b32 v6, 16, v147
    v_and_b32 v7, 0xffff0000, v147
    v_pk_add_f32 v[54:55], v[54:55], v[6:7]
    s_waitcnt vmcnt(20)
    v_lshlrev_b32 v4, 16, v84
    v_and_b32 v5, 0xffff0000, v84
    v_pk_add_f32 v[40:41], v[40:41], v[4:5]
    v_lshlrev_b32 v6, 16, v85
    v_and_b32 v7, 0xffff0000, v85
    v_pk_add_f32 v[42:43], v[42:43], v[6:7]
    v_lshlrev_b32 v4, 16, v86
    v_and_b32 v5, 0xffff0000, v86
    v_pk_add_f32 v[44:45], v[44:45], v[4:5]
    v_lshlrev_b32 v6, 16, v87
    v_and_b32 v7, 0xffff0000, v87
    v_pk_add_f32 v[46:47], v[46:47], v[6:7]
    v_lshlrev_b32 v4, 16, v148
    v_and_b32 v5, 0xffff0000, v148
    v_pk_add_f32 v[48:49], v[48:49], v[4:5]
    v_lshlrev_b32 v6, 16, v149
    v_and_b32 v7, 0xffff0000, v149
    v_pk_add_f32 v[50:51], v[50:51], v[6:7]
    v_lshlrev_b32 v4, 16, v150
    v_and_b32 v5, 0xffff0000, v150
    v_pk_add_f32 v[52:53], v[52:53], v[4:5]
    v_lshlrev_b32 v6, 16, v151
    v_and_b32 v7, 0xffff0000, v151
    v_pk_add_f32 v[54:55], v[54:55], v[6:7]
    s_waitcnt vmcnt(18)
    v_lshlrev_b32 v4, 16, v88
    v_and_b32 v5, 0xffff0000, v88
    v_pk_add_f32 v[40:41], v[40:41], v[4:5]
    v_lshlrev_b32 v6, 16, v89
    v_and_b32 v7, 0xffff0000, v89
    v_pk_add_f32 v[42:43], v[42:43], v[6:7]
    v_lshlrev_b32 v4, 16, v90
    v_and_b32 v5, 0xffff0000, v90
    v_pk_add_f32 v[44:45], v[44:45], v[4:5]
    v_lshlrev_b32 v6, 16, v91
    v_and_b32 v7, 0xffff0000, v91
    v_pk_add_f32 v[46:47], v[46:47], v[6:7]
    v_lshlrev_b32 v4, 16, v152
    v_and_b32 v5, 0xffff0000, v152
    v_pk_add_f32 v[48:49], v[48:49], v[4:5]
    v_lshlrev_b32 v6, 16, v153
    v_and_b32 v7, 0xffff0000, v153
    v_pk_add_f32 v[50:51], v[50:51], v[6:7]
    v_lshlrev_b32 v4, 16, v154
    v_and_b32 v5, 0xffff0000, v154
    v_pk_add_f32 v[52:53], v[52:53], v[4:5]
    v_lshlrev_b32 v6, 16, v155
    v_and_b32 v7, 0xffff0000, v155
    v_pk_add_f32 v[54:55], v[54:55], v[6:7]
    s_waitcnt vmcnt(16)
    v_lshlrev_b32 v4, 16, v92
    v_and_b32 v5, 0xffff0000, v92
    v_pk_add_f32 v[40:41], v[40:41], v[4:5]
    v_lshlrev_b32 v6, 16, v93
    v_and_b32 v7, 0xffff0000, v93
    v_pk_add_f32 v[42:43], v[42:43], v[6:7]
    v_lshlrev_b32 v4, 16, v94
    v_and_b32 v5, 0xffff0000, v94
    v_pk_add_f32 v[44:45], v[44:45], v[4:5]
    v_lshlrev_b32 v6, 16, v95
    v_and_b32 v7, 0xffff0000, v95
    v_pk_add_f32 v[46:47], v[46:47], v[6:7]
    v_lshlrev_b32 v4, 16, v156
    v_and_b32 v5, 0xffff0000, v156
    v_pk_add_f32 v[48:49], v[48:49], v[4:5]
    v_lshlrev_b32 v6, 16, v157
    v_and_b32 v7, 0xffff0000, v157
    v_pk_add_f32 v[50:51], v[50:51], v[6:7]
    v_lshlrev_b32 v4, 16, v158
    v_and_b32 v5, 0xffff0000, v158
    v_pk_add_f32 v[52:53], v[52:53], v[4:5]
    v_lshlrev_b32 v6, 16, v159
    v_and_b32 v7, 0xffff0000, v159
    v_pk_add_f32 v[54:55], v[54:55], v[6:7]
    s_waitcnt vmcnt(14)
    v_lshlrev_b32 v4, 16, v96
    v_and_b32 v5, 0xffff0000, v96
    v_pk_add_f32 v[40:41], v[40:41], v[4:5]
    v_lshlrev_b32 v6, 16, v97
    v_and_b32 v7, 0xffff0000, v97
    v_pk_add_f32 v[42:43], v[42:43], v[6:7]
    v_lshlrev_b32 v4, 16, v98
    v_and_b32 v5, 0xffff0000, v98
    v_pk_add_f32 v[44:45], v[44:45], v[4:5]
    v_lshlrev_b32 v6, 16, v99
    v_and_b32 v7, 0xffff0000, v99
    v_pk_add_f32 v[46:47], v[46:47], v[6:7]
    v_lshlrev_b32 v4, 16, v160
    v_and_b32 v5, 0xffff0000, v160
    v_pk_add_f32 v[48:49], v[48:49], v[4:5]
    v_lshlrev_b32 v6, 16, v161
    v_and_b32 v7, 0xffff0000, v161
    v_pk_add_f32 v[50:51], v[50:51], v[6:7]
    v_lshlrev_b32 v4, 16, v162
    v_and_b32 v5, 0xffff0000, v162
    v_pk_add_f32 v[52:53], v[52:53], v[4:5]
    v_lshlrev_b32 v6, 16, v163
    v_and_b32 v7, 0xffff0000, v163
    v_pk_add_f32 v[54:55], v[54:55], v[6:7]
    s_waitcnt vmcnt(12)
    v_lshlrev_b32 v4, 16, v100
    v_and_b32 v5, 0xffff0000, v100
    v_pk_add_f32 v[40:41], v[40:41], v[4:5]
    v_lshlrev_b32 v6, 16, v101
    v_and_b32 v7, 0xffff0000, v101
    v_pk_add_f32 v[42:43], v[42:43], v[6:7]
    v_lshlrev_b32 v4, 16, v102
    v_and_b32 v5, 0xffff0000, v102
    v_pk_add_f32 v[44:45], v[44:45], v[4:5]
    v_lshlrev_b32 v6, 16, v103
    v_and_b32 v7, 0xffff0000, v103
    v_pk_add_f32 v[46:47], v[46:47], v[6:7]
    v_lshlrev_b32 v4, 16, v164
    v_and_b32 v5, 0xffff0000, v164
    v_pk_add_f32 v[48:49], v[48:49], v[4:5]
    v_lshlrev_b32 v6, 16, v165
    v_and_b32 v7, 0xffff0000, v165
    v_pk_add_f32 v[50:51], v[50:51], v[6:7]
    v_lshlrev_b32 v4, 16, v166
    v_and_b32 v5, 0xffff0000, v166
    v_pk_add_f32 v[52:53], v[52:53], v[4:5]
    v_lshlrev_b32 v6, 16, v167
    v_and_b32 v7, 0xffff0000, v167
    v_pk_add_f32 v[54:55], v[54:55], v[6:7]
    s_waitcnt vmcnt(10)
    v_lshlrev_b32 v4, 16, v104
    v_and_b32 v5, 0xffff0000, v104
    v_pk_add_f32 v[40:41], v[40:41], v[4:5]
    v_lshlrev_b32 v6, 16, v105
    v_and_b32 v7, 0xffff0000, v105
    v_pk_add_f32 v[42:43], v[42:43], v[6:7]
    v_lshlrev_b32 v4, 16, v106
    v_and_b32 v5, 0xffff0000, v106
    v_pk_add_f32 v[44:45], v[44:45], v[4:5]
    v_lshlrev_b32 v6, 16, v107
    v_and_b32 v7, 0xffff0000, v107
    v_pk_add_f32 v[46:47], v[46:47], v[6:7]
    v_lshlrev_b32 v4, 16, v168
    v_and_b32 v5, 0xffff0000, v168
    v_pk_add_f32 v[48:49], v[48:49], v[4:5]
    v_lshlrev_b32 v6, 16, v169
    v_and_b32 v7, 0xffff0000, v169
    v_pk_add_f32 v[50:51], v[50:51], v[6:7]
    v_lshlrev_b32 v4, 16, v170
    v_and_b32 v5, 0xffff0000, v170
    v_pk_add_f32 v[52:53], v[52:53], v[4:5]
    v_lshlrev_b32 v6, 16, v171
    v_and_b32 v7, 0xffff0000, v171
    v_pk_add_f32 v[54:55], v[54:55], v[6:7]
    s_waitcnt vmcnt(8)
    v_lshlrev_b32 v4, 16, v108
    v_and_b32 v5, 0xffff0000, v108
    v_pk_add_f32 v[40:41], v[40:41], v[4:5]
    v_lshlrev_b32 v6, 16, v109
    v_and_b32 v7, 0xffff0000, v109
    v_pk_add_f32 v[42:43], v[42:43], v[6:7]
    v_lshlrev_b32 v4, 16, v110
    v_and_b32 v5, 0xffff0000, v110
    v_pk_add_f32 v[44:45], v[44:45], v[4:5]
    v_lshlrev_b32 v6, 16, v111
    v_and_b32 v7, 0xffff0000, v111
    v_pk_add_f32 v[46:47], v[46:47], v[6:7]
    v_lshlrev_b32 v4, 16, v172
    v_and_b32 v5, 0xffff0000, v172
    v_pk_add_f32 v[48:49], v[48:49], v[4:5]
    v_lshlrev_b32 v6, 16, v173
    v_and_b32 v7, 0xffff0000, v173
    v_pk_add_f32 v[50:51], v[50:51], v[6:7]
    v_lshlrev_b32 v4, 16, v174
    v_and_b32 v5, 0xffff0000, v174
    v_pk_add_f32 v[52:53], v[52:53], v[4:5]
    v_lshlrev_b32 v6, 16, v175
    v_and_b32 v7, 0xffff0000, v175
    v_pk_add_f32 v[54:55], v[54:55], v[6:7]
    s_waitcnt vmcnt(6)
    v_lshlrev_b32 v4, 16, v112
    v_and_b32 v5, 0xffff0000, v112
    v_pk_add_f32 v[40:41], v[40:41], v[4:5]
    v_lshlrev_b32 v6, 16, v113
    v_and_b32 v7, 0xffff0000, v113
    v_pk_add_f32 v[42:43], v[42:43], v[6:7]
    v_lshlrev_b32 v4, 16, v114
    v_and_b32 v5, 0xffff0000, v114
    v_pk_add_f32 v[44:45], v[44:45], v[4:5]
    v_lshlrev_b32 v6, 16, v115
    v_and_b32 v7, 0xffff0000, v115
    v_pk_add_f32 v[46:47], v[46:47], v[6:7]
    v_lshlrev_b32 v4, 16, v176
    v_and_b32 v5, 0xffff0000, v176
    v_pk_add_f32 v[48:49], v[48:49], v[4:5]
    v_lshlrev_b32 v6, 16, v177
    v_and_b32 v7, 0xffff0000, v177
    v_pk_add_f32 v[50:51], v[50:51], v[6:7]
    v_lshlrev_b32 v4, 16, v178
    v_and_b32 v5, 0xffff0000, v178
    v_pk_add_f32 v[52:53], v[52:53], v[4:5]
    v_lshlrev_b32 v6, 16, v179
    v_and_b32 v7, 0xffff0000, v179
    v_pk_add_f32 v[54:55], v[54:55], v[6:7]
    s_waitcnt vmcnt(4)
    v_lshlrev_b32 v4, 16, v116
    v_and_b32 v5, 0xffff0000, v116
    v_pk_add_f32 v[40:41], v[40:41], v[4:5]
    v_lshlrev_b32 v6, 16, v117
    v_and_b32 v7, 0xffff0000, v117
    v_pk_add_f32 v[42:43], v[42:43], v[6:7]
    v_lshlrev_b32 v4, 16, v118
    v_and_b32 v5, 0xffff0000, v118
    v_pk_add_f32 v[44:45], v[44:45], v[4:5]
    v_lshlrev_b32 v6, 16, v119
    v_and_b32 v7, 0xffff0000, v119
    v_pk_add_f32 v[46:47], v[46:47], v[6:7]
    v_lshlrev_b32 v4, 16, v180
    v_and_b32 v5, 0xffff0000, v180
    v_pk_add_f32 v[48:49], v[48:49], v[4:5]
    v_lshlrev_b32 v6, 16, v181
    v_and_b32 v7, 0xffff0000, v181
    v_pk_add_f32 v[50:51], v[50:51], v[6:7]
    v_lshlrev_b32 v4, 16, v182
    v_and_b32 v5, 0xffff0000, v182
    v_pk_add_f32 v[52:53], v[52:53], v[4:5]
    v_lshlrev_b32 v6, 16, v183
    v_and_b32 v7, 0xffff0000, v183
    v_pk_add_f32 v[54:55], v[54:55], v[6:7]
    s_waitcnt vmcnt(2)
    v_lshlrev_b32 v4, 16, v120
    v_and_b32 v5, 0xffff0000, v120
    v_pk_add_f32 v[40:41], v[40:41], v[4:5]
    v_lshlrev_b32 v6, 16, v121
    v_and_b32 v7, 0xffff0000, v121
    v_pk_add_f32 v[42:43], v[42:43], v[6:7]
    v_lshlrev_b32 v4, 16, v122
    v_and_b32 v5, 0xffff0000, v122
    v_pk_add_f32 v[44:45], v[44:45], v[4:5]
    v_lshlrev_b32 v6, 16, v123
    v_and_b32 v7, 0xffff0000, v123
    v_pk_add_f32 v[46:47], v[46:47], v[6:7]
    v_lshlrev_b32 v4, 16, v184
    v_and_b32 v5, 0xffff0000, v184
    v_pk_add_f32 v[48:49], v[48:49], v[4:5]
    v_lshlrev_b32 v6, 16, v185
    v_and_b32 v7, 0xffff0000, v185
    v_pk_add_f32 v[50:51], v[50:51], v[6:7]
    v_lshlrev_b32 v4, 16, v186
    v_and_b32 v5, 0xffff0000, v186
    v_pk_add_f32 v[52:53], v[52:53], v[4:5]
    v_lshlrev_b32 v6, 16, v187
    v_and_b32 v7, 0xffff0000, v187
    v_pk_add_f32 v[54:55], v[54:55], v[6:7]
    s_waitcnt vmcnt(0)
    v_lshlrev_b32 v4, 16, v124
    v_and_b32 v5, 0xffff0000, v124
    v_pk_add_f32 v[40:41], v[40:41], v[4:5]
    v_lshlrev_b32 v6, 16, v125
    v_and_b32 v7, 0xffff0000, v125
    v_pk_add_f32 v[42:43], v[42:43], v[6:7]
    v_lshlrev_b32 v4, 16, v126
    v_and_b32 v5, 0xffff0000, v126
    v_pk_add_f32 v[44:45], v[44:45], v[4:5]
    v_lshlrev_b32 v6, 16, v127
    v_and_b32 v7, 0xffff0000, v127
    v_pk_add_f32 v[46:47], v[46:47], v[6:7]
    v_lshlrev_b32 v4, 16, v188
    v_and_b32 v5, 0xffff0000, v188
    v_pk_add_f32 v[48:49], v[48:49], v[4:5]
    v_lshlrev_b32 v6, 16, v189
    v_and_b32 v7, 0xffff0000, v189
    v_pk_add_f32 v[50:51], v[50:51], v[6:7]
    v_lshlrev_b32 v4, 16, v190
    v_and_b32 v5, 0xffff0000, v190
    v_pk_add_f32 v[52:53], v[52:53], v[4:5]
    v_lshlrev_b32 v6, 16, v191
    v_and_b32 v7, 0xffff0000, v191
    v_pk_add_f32 v[54:55], v[54:55], v[6:7]
    v_cvt_pk_bf16_f32 v40, v40, v41
    v_cvt_pk_bf16_f32 v41, v42, v43
    v_cvt_pk_bf16_f32 v42, v44, v45
    v_cvt_pk_bf16_f32 v43, v46, v47
    s_nop 0
    v_permlane32_swap_b32 v40, v42
    v_permlane32_swap_b32 v41, v43
    buffer_store_dwordx4 v[40:43], v11, s[72:75], s37 offen
    v_cvt_pk_bf16_f32 v48, v48, v49
    v_cvt_pk_bf16_f32 v49, v50, v51
    v_cvt_pk_bf16_f32 v50, v52, v53
    v_cvt_pk_bf16_f32 v51, v54, v55
    s_nop 0
    v_permlane32_swap_b32 v48, v50
    v_permlane32_swap_b32 v49, v51
    buffer_store_dwordx4 v[48:51], v11, s[72:75], s41 offen
    s_branch L_ldone
L_three:
    s_mov_b32 s24, 0
    s_mov_b32 s26, 0xffff
    s_mov_b32 s27, 0
    s_cmp_eq_u32 s27, 0
    s_cbranch_scc1 L_rf0_l3
L_rb0_l3:
    s_ff1_i32_b32 s3, s27
    s_bitset0_b32 s27, s3
    s_mul_i32 s3, s3, 86016
    s_add_u32 s23, s3, s36
    buffer_load_dwordx4 v[64:67], v0, s[84:87], s23 offen sc1
    s_add_u32 s23, s3, s40
    buffer_load_dwordx4 v[128:131], v0, s[84:87], s23 offen sc1
    s_add_u32 s23, s3, s44
    buffer_load_dwordx4 v[192:195], v0, s[84:87], s23 offen sc1
    s_cmp_eq_u32 s27, 0
    s_cbranch_scc1 L_rf1_l3
L_rb1_l3:
    s_ff1_i32_b32 s3, s27
    s_bitset0_b32 s27, s3
    s_mul_i32 s3, s3, 86016
    s_add_u32 s23, s3, s36
    buffer_load_dwordx4 v[68:71], v0, s[84:87], s23 offen sc1
    s_add_u32 s23, s3, s40
    buffer_load_dwordx4 v[132:135], v0, s[84:87], s23 offen sc1
    s_add_u32 s23, s3, s44
    buffer_load_dwordx4 v[196:199], v0, s[84:87], s23 offen sc1
    s_cmp_eq_u32 s27, 0
    s_cbranch_scc1 L_rf2_l3
L_rb2_l3:
    s_ff1_i32_b32 s3, s27
    s_bitset0_b32 s27, s3
    s_mul_i32 s3, s3, 86016
    s_add_u32 s23, s3, s36
    buffer_load_dwordx4 v[72:75], v0, s[84:87], s23 offen sc1
    s_add_u32 s23, s3, s40
    buffer_load_dwordx4 v[136:139], v0, s[84:87], s23 offen sc1
    s_add_u32 s23, s3, s44
    buffer_load_dwordx4 v[200:203], v0, s[84:87], s23 offen sc1
    s_cmp_eq_u32 s27, 0
    s_cbranch_scc1 L_rf3_l3
L_rb3_l3:
    s_ff1_i32_b32 s3, s27
    s_bitset0_b32 s27, s3
    s_mul_i32 s3, s3, 86016
    s_add_u32 s23, s3, s36
    buffer_load_dwordx4 v[76:79], v0, s[84:87], s23 offen sc1
    s_add_u32 s23, s3, s40
    buffer_load_dwordx4 v[140:143], v0, s[84:87], s23 offen sc1
    s_add_u32 s23, s3, s44
    buffer_load_dwordx4 v[204:207], v0, s[84:87], s23 offen sc1
    s_cmp_eq_u32 s27, 0
    s_cbranch_scc1 L_rf4_l3
L_rb4_l3:
    s_ff1_i32_b32 s3, s27
    s_bitset0_b32 s27, s3
    s_mul_i32 s3, s3, 86016
    s_add_u32 s23, s3, s36
    buffer_load_dwordx4 v[80:83], v0, s[84:87], s23 offen sc1
    s_add_u32 s23, s3, s40
    buffer_load_dwordx4 v[144:147], v0, s[84:87], s23 offen sc1
    s_add_u32 s23, s3, s44
    buffer_load_dwordx4 v[208:211], v0, s[84:87], s23 offen sc1
    s_cmp_eq_u32 s27, 0
    s_cbranch_scc1 L_rf5_l3
L_rb5_l3:
    s_ff1_i32_b32 s3, s27
    s_bitset0_b32 s27, s3
    s_mul_i32 s3, s3, 86016
    s_add_u32 s23, s3, s36
    buffer_load_dwordx4 v[84:87], v0, s[84:87], s23 offen sc1
    s_add_u32 s23, s3, s40
    buffer_load_dwordx4 v[148:151], v0, s[84:87], s23 offen sc1
    s_add_u32 s23, s3, s44
    buffer_load_dwordx4 v[212:215], v0, s[84:87], s23 offen sc1
    s_cmp_eq_u32 s27, 0
    s_cbranch_scc1 L_rf6_l3
L_rb6_l3:
    s_ff1_i32_b32 s3, s27
    s_bitset0_b32 s27, s3
    s_mul_i32 s3, s3, 86016
    s_add_u32 s23, s3, s36
    buffer_load_dwordx4 v[88:91], v0, s[84:87], s23 offen sc1
    s_add_u32 s23, s3, s40
    buffer_load_dwordx4 v[152:155], v0, s[84:87], s23 offen sc1
    s_add_u32 s23, s3, s44
    buffer_load_dwordx4 v[216:219], v0, s[84:87], s23 offen sc1
    s_cmp_eq_u32 s27, 0
    s_cbranch_scc1 L_rf7_l3
L_rb7_l3:
    s_ff1_i32_b32 s3, s27
    s_bitset0_b32 s27, s3
    s_mul_i32 s3, s3, 86016
    s_add_u32 s23, s3, s36
    buffer_load_dwordx4 v[92:95], v0, s[84:87], s23 offen sc1
    s_add_u32 s23, s3, s40
    buffer_load_dwordx4 v[156:159], v0, s[84:87], s23 offen sc1
    s_add_u32 s23, s3, s44
    buffer_load_dwordx4 v[220:223], v0, s[84:87], s23 offen sc1
    s_cmp_eq_u32 s27, 0
    s_cbranch_scc1 L_rf8_l3
L_rb8_l3:
    s_ff1_i32_b32 s3, s27
    s_bitset0_b32 s27, s3
    s_mul_i32 s3, s3, 86016
    s_add_u32 s23, s3, s36
    buffer_load_dwordx4 v[96:99], v0, s[84:87], s23 offen sc1
    s_add_u32 s23, s3, s40
    buffer_load_dwordx4 v[160:163], v0, s[84:87], s23 offen sc1
    s_add_u32 s23, s3, s44
    buffer_load_dwordx4 v[224:227], v0, s[84:87], s23 offen sc1
    s_cmp_eq_u32 s27, 0
    s_cbranch_scc1 L_rf9_l3
L_rb9_l3:
    s_ff1_i32_b32 s3, s27
    s_bitset0_b32 s27, s3
    s_mul_i32 s3, s3, 86016
    s_add_u32 s23, s3, s36
    buffer_load_dwordx4 v[100:103], v0, s[84:87], s23 offen sc1
    s_add_u32 s23, s3, s40
    buffer_load_dwordx4 v[164:167], v0, s[84:87], s23 offen sc1
    s_add_u32 s23, s3, s44
    buffer_load_dwordx4 v[228:231], v0, s[84:87], s23 offen sc1
    s_cmp_eq_u32 s27, 0
    s_cbranch_scc1 L_rf10_l3
L_rb10_l3:
    s_ff1_i32_b32 s3, s27
    s_bitset0_b32 s27, s3
    s_mul_i32 s3, s3, 86016
    s_add_u32 s23, s3, s36
    buffer_load_dwordx4 v[104:107], v0, s[84:87], s23 offen sc1
    s_add_u32 s23, s3, s40
    buffer_load_dwordx4 v[168:171], v0, s[84:87], s23 offen sc1
    s_add_u32 s23, s3, s44
    buffer_load_dwordx4 v[232:235], v0, s[84:87], s23 offen sc1
    s_cmp_eq_u32 s27, 0
    s_cbranch_scc1 L_rf11_l3
L_rb11_l3:
    s_ff1_i32_b32 s3, s27
    s_bitset0_b32 s27, s3
    s_mul_i32 s3, s3, 86016
    s_add_u32 s23, s3, s36
    buffer_load_dwordx4 v[108:111], v0, s[84:87], s23 offen sc1
    s_add_u32 s23, s3, s40
    buffer_load_dwordx4 v[172:175], v0, s[84:87], s23 offen sc1
    s_add_u32 s23, s3, s44
    buffer_load_dwordx4 v[236:239], v0, s[84:87], s23 offen sc1
    s_cmp_eq_u32 s27, 0
    s_cbranch_scc1 L_rf12_l3
L_rb12_l3:
    s_ff1_i32_b32 s3, s27
    s_bitset0_b32 s27, s3
    s_mul_i32 s3, s3, 86016
    s_add_u32 s23, s3, s36
    buffer_load_dwordx4 v[112:115], v0, s[84:87], s23 offen sc1
    s_add_u32 s23, s3, s40
    buffer_load_dwordx4 v[176:179], v0, s[84:87], s23 offen sc1
    s_add_u32 s23, s3, s44
    buffer_load_dwordx4 v[240:243], v0, s[84:87], s23 offen sc1
    s_cmp_eq_u32 s27, 0
    s_cbranch_scc1 L_rf13_l3
L_rb13_l3:
    s_ff1_i32_b32 s3, s27
    s_bitset0_b32 s27, s3
    s_mul_i32 s3, s3, 86016
    s_add_u32 s23, s3, s36
    buffer_load_dwordx4 v[116:119], v0, s[84:87], s23 offen sc1
    s_add_u32 s23, s3, s40
    buffer_load_dwordx4 v[180:183], v0, s[84:87], s23 offen sc1
    s_add_u32 s23, s3, s44
    buffer_load_dwordx4 v[244:247], v0, s[84:87], s23 offen sc1
    s_cmp_eq_u32 s27, 0
    s_cbranch_scc1 L_rf14_l3
L_rb14_l3:
    s_ff1_i32_b32 s3, s27
    s_bitset0_b32 s27, s3
    s_mul_i32 s3, s3, 86016
    s_add_u32 s23, s3, s36
    buffer_load_dwordx4 v[120:123], v0, s[84:87], s23 offen sc1
    s_add_u32 s23, s3, s40
    buffer_load_dwordx4 v[184:187], v0, s[84:87], s23 offen sc1
    s_add_u32 s23, s3, s44
    buffer_load_dwordx4 v[248:251], v0, s[84:87], s23 offen sc1
    s_cmp_eq_u32 s27, 0
    s_cbranch_scc1 L_rf15_l3
L_rb15_l3:
    s_ff1_i32_b32 s3, s27
    s_bitset0_b32 s27, s3
    s_mul_i32 s3, s3, 86016
    s_add_u32 s23, s3, s36
    buffer_load_dwordx4 v[124:127], v0, s[84:87], s23 offen sc1
    s_add_u32 s23, s3, s40
    buffer_load_dwordx4 v[188:191], v0, s[84:87], s23 offen sc1
    s_add_u32 s23, s3, s44
    buffer_load_dwordx4 v[252:255], v0, s[84:87], s23 offen sc1
    s_waitcnt vmcnt(45)
    v_lshlrev_b32 v40, 16, v64
    v_and_b32 v41, 0xffff0000, v64
    v_lshlrev_b32 v42, 16, v65
    v_and_b32 v43, 0xffff0000, v65
    v_lshlrev_b32 v44, 16, v66
    v_and_b32 v45, 0xffff0000, v66
    v_lshlrev_b32 v46, 16, v67
    v_and_b32 v47, 0xffff0000, v67
    v_lshlrev_b32 v48, 16, v128
    v_and_b32 v49, 0xffff0000, v128
    v_lshlrev_b32 v50, 16, v129
    v_and_b32 v51, 0xffff0000, v129
    v_lshlrev_b32 v52, 16, v130
    v_and_b32 v53, 0xffff0000, v130
    v_lshlrev_b32 v54, 16, v131
    v_and_b32 v55, 0xffff0000, v131
    v_lshlrev_b32 v56, 16, v192
    v_and_b32 v57, 0xffff0000, v192
    v_lshlrev_b32 v58, 16, v193
    v_and_b32 v59, 0xffff0000, v193
    v_lshlrev_b32 v60, 16, v194
    v_and_b32 v61, 0xffff0000, v194
    v_lshlrev_b32 v62, 16, v195
    v_and_b32 v63, 0xffff0000, v195
    s_waitcnt vmcnt(42)
    v_lshlrev_b32 v4, 16, v68
    v_and_b32 v5, 0xffff0000, v68
    v_pk_add_f32 v[40:41], v[40:41], v[4:5]
    v_lshlrev_b32 v6, 16, v69
    v_and_b32 v7, 0xffff0000, v69
    v_pk_add_f32 v[42:43], v[42:43], v[6:7]
    v_lshlrev_b32 v4, 16, v70
    v_and_b32 v5, 0xffff0000, v70
    v_pk_add_f32 v[44:45], v[44:45], v[4:5]
    v_lshlrev_b32 v6, 16, v71
    v_and_b32 v7, 0xffff0000, v71
    v_pk_add_f32 v[46:47], v[46:47], v[6:7]
    v_lshlrev_b32 v4, 16, v132
    v_and_b32 v5, 0xffff0000, v132
    v_pk_add_f32 v[48:49], v[48:49], v[4:5]
    v_lshlrev_b32 v6, 16, v133
    v_and_b32 v7, 0xffff0000, v133
    v_pk_add_f32 v[50:51], v[50:51], v[6:7]
    v_lshlrev_b32 v4, 16, v134
    v_and_b32 v5, 0xffff0000, v134
    v_pk_add_f32 v[52:53], v[52:53], v[4:5]
    v_lshlrev_b32 v6, 16, v135
    v_and_b32 v7, 0xffff0000, v135
    v_pk_add_f32 v[54:55], v[54:55], v[6:7]
    v_lshlrev_b32 v4, 16, v196
    v_and_b32 v5, 0xffff0000, v196
    v_pk_add_f32 v[56:57], v[56:57], v[4:5]
    v_lshlrev_b32 v6, 16, v197
    v_and_b32 v7, 0xffff0000, v197
    v_pk_add_f32 v[58:59], v[58:59], v[6:7]
    v_lshlrev_b32 v4, 16, v198
    v_and_b32 v5, 0xffff0000, v198
    v_pk_add_f32 v[60:61], v[60:61], v[4:5]
    v_lshlrev_b32 v6, 16, v199
    v_and_b32 v7, 0xffff0000, v199
    v_pk_add_f32 v[62:63], v[62:63], v[6:7]
    s_waitcnt vmcnt(39)
    v_lshlrev_b32 v4, 16, v72
    v_and_b32 v5, 0xffff0000, v72
    v_pk_add_f32 v[40:41], v[40:41], v[4:5]
    v_lshlrev_b32 v6, 16, v73
    v_and_b32 v7, 0xffff0000, v73
    v_pk_add_f32 v[42:43], v[42:43], v[6:7]
    v_lshlrev_b32 v4, 16, v74
    v_and_b32 v5, 0xffff0000, v74
    v_pk_add_f32 v[44:45], v[44:45], v[4:5]
    v_lshlrev_b32 v6, 16, v75
    v_and_b32 v7, 0xffff0000, v75
    v_pk_add_f32 v[46:47], v[46:47], v[6:7]
    v_lshlrev_b32 v4, 16, v136
    v_and_b32 v5, 0xffff0000, v136
    v_pk_add_f32 v[48:49], v[48:49], v[4:5]
    v_lshlrev_b32 v6, 16, v137
    v_and_b32 v7, 0xffff0000, v137
    v_pk_add_f32 v[50:51], v[50:51], v[6:7]
    v_lshlrev_b32 v4, 16, v138
    v_and_b32 v5, 0xffff0000, v138
    v_pk_add_f32 v[52:53], v[52:53], v[4:5]
    v_lshlrev_b32 v6, 16, v139
    v_and_b32 v7, 0xffff0000, v139
    v_pk_add_f32 v[54:55], v[54:55], v[6:7]
    v_lshlrev_b32 v4, 16, v200
    v_and_b32 v5, 0xffff0000, v200
    v_pk_add_f32 v[56:57], v[56:57], v[4:5]
    v_lshlrev_b32 v6, 16, v201
    v_and_b32 v7, 0xffff0000, v201
    v_pk_add_f32 v[58:59], v[58:59], v[6:7]
    v_lshlrev_b32 v4, 16, v202
    v_and_b32 v5, 0xffff0000, v202
    v_pk_add_f32 v[60:61], v[60:61], v[4:5]
    v_lshlrev_b32 v6, 16, v203
    v_and_b32 v7, 0xffff0000, v203
    v_pk_add_f32 v[62:63], v[62:63], v[6:7]
    s_waitcnt vmcnt(36)
    v_lshlrev_b32 v4, 16, v76
    v_and_b32 v5, 0xffff0000, v76
    v_pk_add_f32 v[40:41], v[40:41], v[4:5]
    v_lshlrev_b32 v6, 16, v77
    v_and_b32 v7, 0xffff0000, v77
    v_pk_add_f32 v[42:43], v[42:43], v[6:7]
    v_lshlrev_b32 v4, 16, v78
    v_and_b32 v5, 0xffff0000, v78
    v_pk_add_f32 v[44:45], v[44:45], v[4:5]
    v_lshlrev_b32 v6, 16, v79
    v_and_b32 v7, 0xffff0000, v79
    v_pk_add_f32 v[46:47], v[46:47], v[6:7]
    v_lshlrev_b32 v4, 16, v140
    v_and_b32 v5, 0xffff0000, v140
    v_pk_add_f32 v[48:49], v[48:49], v[4:5]
    v_lshlrev_b32 v6, 16, v141
    v_and_b32 v7, 0xffff0000, v141
    v_pk_add_f32 v[50:51], v[50:51], v[6:7]
    v_lshlrev_b32 v4, 16, v142
    v_and_b32 v5, 0xffff0000, v142
    v_pk_add_f32 v[52:53], v[52:53], v[4:5]
    v_lshlrev_b32 v6, 16, v143
    v_and_b32 v7, 0xffff0000, v143
    v_pk_add_f32 v[54:55], v[54:55], v[6:7]
    v_lshlrev_b32 v4, 16, v204
    v_and_b32 v5, 0xffff0000, v204
    v_pk_add_f32 v[56:57], v[56:57], v[4:5]
    v_lshlrev_b32 v6, 16, v205
    v_and_b32 v7, 0xffff0000, v205
    v_pk_add_f32 v[58:59], v[58:59], v[6:7]
    v_lshlrev_b32 v4, 16, v206
    v_and_b32 v5, 0xffff0000, v206
    v_pk_add_f32 v[60:61], v[60:61], v[4:5]
    v_lshlrev_b32 v6, 16, v207
    v_and_b32 v7, 0xffff0000, v207
    v_pk_add_f32 v[62:63], v[62:63], v[6:7]
    s_waitcnt vmcnt(33)
    v_lshlrev_b32 v4, 16, v80
    v_and_b32 v5, 0xffff0000, v80
    v_pk_add_f32 v[40:41], v[40:41], v[4:5]
    v_lshlrev_b32 v6, 16, v81
    v_and_b32 v7, 0xffff0000, v81
    v_pk_add_f32 v[42:43], v[42:43], v[6:7]
    v_lshlrev_b32 v4, 16, v82
    v_and_b32 v5, 0xffff0000, v82
    v_pk_add_f32 v[44:45], v[44:45], v[4:5]
    v_lshlrev_b32 v6, 16, v83
    v_and_b32 v7, 0xffff0000, v83
    v_pk_add_f32 v[46:47], v[46:47], v[6:7]
    v_lshlrev_b32 v4, 16, v144
    v_and_b32 v5, 0xffff0000, v144
    v_pk_add_f32 v[48:49], v[48:49], v[4:5]
    v_lshlrev_b32 v6, 16, v145
    v_and_b32 v7, 0xffff0000, v145
    v_pk_add_f32 v[50:51], v[50:51], v[6:7]
    v_lshlrev_b32 v4, 16, v146
    v_and_b32 v5, 0xffff0000, v146
    v_pk_add_f32 v[52:53], v[52:53], v[4:5]
    v_lshlrev_b32 v6, 16, v147
    v_and_b32 v7, 0xffff0000, v147
    v_pk_add_f32 v[54:55], v[54:55], v[6:7]
    v_lshlrev_b32 v4, 16, v208
    v_and_b32 v5, 0xffff0000, v208
    v_pk_add_f32 v[56:57], v[56:57], v[4:5]
    v_lshlrev_b32 v6, 16, v209
    v_and_b32 v7, 0xffff0000, v209
    v_pk_add_f32 v[58:59], v[58:59], v[6:7]
    v_lshlrev_b32 v4, 16, v210
    v_and_b32 v5, 0xffff0000, v210
    v_pk_add_f32 v[60:61], v[60:61], v[4:5]
    v_lshlrev_b32 v6, 16, v211
    v_and_b32 v7, 0xffff0000, v211
    v_pk_add_f32 v[62:63], v[62:63], v[6:7]
    s_waitcnt vmcnt(30)
    v_lshlrev_b32 v4, 16, v84
    v_and_b32 v5, 0xffff0000, v84
    v_pk_add_f32 v[40:41], v[40:41], v[4:5]
    v_lshlrev_b32 v6, 16, v85
    v_and_b32 v7, 0xffff0000, v85
    v_pk_add_f32 v[42:43], v[42:43], v[6:7]
    v_lshlrev_b32 v4, 16, v86
    v_and_b32 v5, 0xffff0000, v86
    v_pk_add_f32 v[44:45], v[44:45], v[4:5]
    v_lshlrev_b32 v6, 16, v87
    v_and_b32 v7, 0xffff0000, v87
    v_pk_add_f32 v[46:47], v[46:47], v[6:7]
    v_lshlrev_b32 v4, 16, v148
    v_and_b32 v5, 0xffff0000, v148
    v_pk_add_f32 v[48:49], v[48:49], v[4:5]
    v_lshlrev_b32 v6, 16, v149
    v_and_b32 v7, 0xffff0000, v149
    v_pk_add_f32 v[50:51], v[50:51], v[6:7]
    v_lshlrev_b32 v4, 16, v150
    v_and_b32 v5, 0xffff0000, v150
    v_pk_add_f32 v[52:53], v[52:53], v[4:5]
    v_lshlrev_b32 v6, 16, v151
    v_and_b32 v7, 0xffff0000, v151
    v_pk_add_f32 v[54:55], v[54:55], v[6:7]
    v_lshlrev_b32 v4, 16, v212
    v_and_b32 v5, 0xffff0000, v212
    v_pk_add_f32 v[56:57], v[56:57], v[4:5]
    v_lshlrev_b32 v6, 16, v213
    v_and_b32 v7, 0xffff0000, v213
    v_pk_add_f32 v[58:59], v[58:59], v[6:7]
    v_lshlrev_b32 v4, 16, v214
    v_and_b32 v5, 0xffff0000, v214
    v_pk_add_f32 v[60:61], v[60:61], v[4:5]
    v_lshlrev_b32 v6, 16, v215
    v_and_b32 v7, 0xffff0000, v215
    v_pk_add_f32 v[62:63], v[62:63], v[6:7]
    s_waitcnt vmcnt(27)
    v_lshlrev_b32 v4, 16, v88
    v_and_b32 v5, 0xffff0000, v88
    v_pk_add_f32 v[40:41], v[40:41], v[4:5]
    v_lshlrev_b32 v6, 16, v89
    v_and_b32 v7, 0xffff0000, v89
    v_pk_add_f32 v[42:43], v[42:43], v[6:7]
    v_lshlrev_b32 v4, 16, v90
    v_and_b32 v5, 0xffff0000, v90
    v_pk_add_f32 v[44:45], v[44:45], v[4:5]
    v_lshlrev_b32 v6, 16, v91
    v_and_b32 v7, 0xffff0000, v91
    v_pk_add_f32 v[46:47], v[46:47], v[6:7]
    v_lshlrev_b32 v4, 16, v152
    v_and_b32 v5, 0xffff0000, v152
    v_pk_add_f32 v[48:49], v[48:49], v[4:5]
    v_lshlrev_b32 v6, 16, v153
    v_and_b32 v7, 0xffff0000, v153
    v_pk_add_f32 v[50:51], v[50:51], v[6:7]
    v_lshlrev_b32 v4, 16, v154
    v_and_b32 v5, 0xffff0000, v154
    v_pk_add_f32 v[52:53], v[52:53], v[4:5]
    v_lshlrev_b32 v6, 16, v155
    v_and_b32 v7, 0xffff0000, v155
    v_pk_add_f32 v[54:55], v[54:55], v[6:7]
    v_lshlrev_b32 v4, 16, v216
    v_and_b32 v5, 0xffff0000, v216
    v_pk_add_f32 v[56:57], v[56:57], v[4:5]
    v_lshlrev_b32 v6, 16, v217
    v_and_b32 v7, 0xffff0000, v217
    v_pk_add_f32 v[58:59], v[58:59], v[6:7]
    v_lshlrev_b32 v4, 16, v218
    v_and_b32 v5, 0xffff0000, v218
    v_pk_add_f32 v[60:61], v[60:61], v[4:5]
    v_lshlrev_b32 v6, 16, v219
    v_and_b32 v7, 0xffff0000, v219
    v_pk_add_f32 v[62:63], v[62:63], v[6:7]
    s_waitcnt vmcnt(24)
    v_lshlrev_b32 v4, 16, v92
    v_and_b32 v5, 0xffff0000, v92
    v_pk_add_f32 v[40:41], v[40:41], v[4:5]
    v_lshlrev_b32 v6, 16, v93
    v_and_b32 v7, 0xffff0000, v93
    v_pk_add_f32 v[42:43], v[42:43], v[6:7]
    v_lshlrev_b32 v4, 16, v94
    v_and_b32 v5, 0xffff0000, v94
    v_pk_add_f32 v[44:45], v[44:45], v[4:5]
    v_lshlrev_b32 v6, 16, v95
    v_and_b32 v7, 0xffff0000, v95
    v_pk_add_f32 v[46:47], v[46:47], v[6:7]
    v_lshlrev_b32 v4, 16, v156
    v_and_b32 v5, 0xffff0000, v156
    v_pk_add_f32 v[48:49], v[48:49], v[4:5]
    v_lshlrev_b32 v6, 16, v157
    v_and_b32 v7, 0xffff0000, v157
    v_pk_add_f32 v[50:51], v[50:51], v[6:7]
    v_lshlrev_b32 v4, 16, v158
    v_and_b32 v5, 0xffff0000, v158
    v_pk_add_f32 v[52:53], v[52:53], v[4:5]
    v_lshlrev_b32 v6, 16, v159
    v_and_b32 v7, 0xffff0000, v159
    v_pk_add_f32 v[54:55], v[54:55], v[6:7]
    v_lshlrev_b32 v4, 16, v220
    v_and_b32 v5, 0xffff0000, v220
    v_pk_add_f32 v[56:57], v[56:57], v[4:5]
    v_lshlrev_b32 v6, 16, v221
    v_and_b32 v7, 0xffff0000, v221
    v_pk_add_f32 v[58:59], v[58:59], v[6:7]
    v_lshlrev_b32 v4, 16, v222
    v_and_b32 v5, 0xffff0000, v222
    v_pk_add_f32 v[60:61], v[60:61], v[4:5]
    v_lshlrev_b32 v6, 16, v223
    v_and_b32 v7, 0xffff0000, v223
    v_pk_add_f32 v[62:63], v[62:63], v[6:7]
    s_waitcnt vmcnt(21)
    v_lshlrev_b32 v4, 16, v96
    v_and_b32 v5, 0xffff0000, v96
    v_pk_add_f32 v[40:41], v[40:41], v[4:5]
    v_lshlrev_b32 v6, 16, v97
    v_and_b32 v7, 0xffff0000, v97
    v_pk_add_f32 v[42:43], v[42:43], v[6:7]
    v_lshlrev_b32 v4, 16, v98
    v_and_b32 v5, 0xffff0000, v98
    v_pk_add_f32 v[44:45], v[44:45], v[4:5]
    v_lshlrev_b32 v6, 16, v99
    v_and_b32 v7, 0xffff0000, v99
    v_pk_add_f32 v[46:47], v[46:47], v[6:7]
    v_lshlrev_b32 v4, 16, v160
    v_and_b32 v5, 0xffff0000, v160
    v_pk_add_f32 v[48:49], v[48:49], v[4:5]
    v_lshlrev_b32 v6, 16, v161
    v_and_b32 v7, 0xffff0000, v161
    v_pk_add_f32 v[50:51], v[50:51], v[6:7]
    v_lshlrev_b32 v4, 16, v162
    v_and_b32 v5, 0xffff0000, v162
    v_pk_add_f32 v[52:53], v[52:53], v[4:5]
    v_lshlrev_b32 v6, 16, v163
    v_and_b32 v7, 0xffff0000, v163
    v_pk_add_f32 v[54:55], v[54:55], v[6:7]
    v_lshlrev_b32 v4, 16, v224
    v_and_b32 v5, 0xffff0000, v224
    v_pk_add_f32 v[56:57], v[56:57], v[4:5]
    v_lshlrev_b32 v6, 16, v225
    v_and_b32 v7, 0xffff0000, v225
    v_pk_add_f32 v[58:59], v[58:59], v[6:7]
    v_lshlrev_b32 v4, 16, v226
    v_and_b32 v5, 0xffff0000, v226
    v_pk_add_f32 v[60:61], v[60:61], v[4:5]
    v_lshlrev_b32 v6, 16, v227
    v_and_b32 v7, 0xffff0000, v227
    v_pk_add_f32 v[62:63], v[62:63], v[6:7]
    s_waitcnt vmcnt(18)
    v_lshlrev_b32 v4, 16, v100
    v_and_b32 v5, 0xffff0000, v100
    v_pk_add_f32 v[40:41], v[40:41], v[4:5]
    v_lshlrev_b32 v6, 16, v101
    v_and_b32 v7, 0xffff0000, v101
    v_pk_add_f32 v[42:43], v[42:43], v[6:7]
    v_lshlrev_b32 v4, 16, v102
    v_and_b32 v5, 0xffff0000, v102
    v_pk_add_f32 v[44:45], v[44:45], v[4:5]
    v_lshlrev_b32 v6, 16, v103
    v_and_b32 v7, 0xffff0000, v103
    v_pk_add_f32 v[46:47], v[46:47], v[6:7]
    v_lshlrev_b32 v4, 16, v164
    v_and_b32 v5, 0xffff0000, v164
    v_pk_add_f32 v[48:49], v[48:49], v[4:5]
    v_lshlrev_b32 v6, 16, v165
    v_and_b32 v7, 0xffff0000, v165
    v_pk_add_f32 v[50:51], v[50:51], v[6:7]
    v_lshlrev_b32 v4, 16, v166
    v_and_b32 v5, 0xffff0000, v166
    v_pk_add_f32 v[52:53], v[52:53], v[4:5]
    v_lshlrev_b32 v6, 16, v167
    v_and_b32 v7, 0xffff0000, v167
    v_pk_add_f32 v[54:55], v[54:55], v[6:7]
    v_lshlrev_b32 v4, 16, v228
    v_and_b32 v5, 0xffff0000, v228
    v_pk_add_f32 v[56:57], v[56:57], v[4:5]
    v_lshlrev_b32 v6, 16, v229
    v_and_b32 v7, 0xffff0000, v229
    v_pk_add_f32 v[58:59], v[58:59], v[6:7]
    v_lshlrev_b32 v4, 16, v230
    v_and_b32 v5, 0xffff0000, v230
    v_pk_add_f32 v[60:61], v[60:61], v[4:5]
    v_lshlrev_b32 v6, 16, v231
    v_and_b32 v7, 0xffff0000, v231
    v_pk_add_f32 v[62:63], v[62:63], v[6:7]
    s_waitcnt vmcnt(15)
    v_lshlrev_b32 v4, 16, v104
    v_and_b32 v5, 0xffff0000, v104
    v_pk_add_f32 v[40:41], v[40:41], v[4:5]
    v_lshlrev_b32 v6, 16, v105
    v_and_b32 v7, 0xffff0000, v105
    v_pk_add_f32 v[42:43], v[42:43], v[6:7]
    v_lshlrev_b32 v4, 16, v106
    v_and_b32 v5, 0xffff0000, v106
    v_pk_add_f32 v[44:45], v[44:45], v[4:5]
    v_lshlrev_b32 v6, 16, v107
    v_and_b32 v7, 0xffff0000, v107
    v_pk_add_f32 v[46:47], v[46:47], v[6:7]
    v_lshlrev_b32 v4, 16, v168
    v_and_b32 v5, 0xffff0000, v168
    v_pk_add_f32 v[48:49], v[48:49], v[4:5]
    v_lshlrev_b32 v6, 16, v169
    v_and_b32 v7, 0xffff0000, v169
    v_pk_add_f32 v[50:51], v[50:51], v[6:7]
    v_lshlrev_b32 v4, 16, v170
    v_and_b32 v5, 0xffff0000, v170
    v_pk_add_f32 v[52:53], v[52:53], v[4:5]
    v_lshlrev_b32 v6, 16, v171
    v_and_b32 v7, 0xffff0000, v171
    v_pk_add_f32 v[54:55], v[54:55], v[6:7]
    v_lshlrev_b32 v4, 16, v232
    v_and_b32 v5, 0xffff0000, v232
    v_pk_add_f32 v[56:57], v[56:57], v[4:5]
    v_lshlrev_b32 v6, 16, v233
    v_and_b32 v7, 0xffff0000, v233
    v_pk_add_f32 v[58:59], v[58:59], v[6:7]
    v_lshlrev_b32 v4, 16, v234
    v_and_b32 v5, 0xffff0000, v234
    v_pk_add_f32 v[60:61], v[60:61], v[4:5]
    v_lshlrev_b32 v6, 16, v235
    v_and_b32 v7, 0xffff0000, v235
    v_pk_add_f32 v[62:63], v[62:63], v[6:7]
    s_waitcnt vmcnt(12)
    v_lshlrev_b32 v4, 16, v108
    v_and_b32 v5, 0xffff0000, v108
    v_pk_add_f32 v[40:41], v[40:41], v[4:5]
    v_lshlrev_b32 v6, 16, v109
    v_and_b32 v7, 0xffff0000, v109
    v_pk_add_f32 v[42:43], v[42:43], v[6:7]
    v_lshlrev_b32 v4, 16, v110
    v_and_b32 v5, 0xffff0000, v110
    v_pk_add_f32 v[44:45], v[44:45], v[4:5]
    v_lshlrev_b32 v6, 16, v111
    v_and_b32 v7, 0xffff0000, v111
    v_pk_add_f32 v[46:47], v[46:47], v[6:7]
    v_lshlrev_b32 v4, 16, v172
    v_and_b32 v5, 0xffff0000, v172
    v_pk_add_f32 v[48:49], v[48:49], v[4:5]
    v_lshlrev_b32 v6, 16, v173
    v_and_b32 v7, 0xffff0000, v173
    v_pk_add_f32 v[50:51], v[50:51], v[6:7]
    v_lshlrev_b32 v4, 16, v174
    v_and_b32 v5, 0xffff0000, v174
    v_pk_add_f32 v[52:53], v[52:53], v[4:5]
    v_lshlrev_b32 v6, 16, v175
    v_and_b32 v7, 0xffff0000, v175
    v_pk_add_f32 v[54:55], v[54:55], v[6:7]
    v_lshlrev_b32 v4, 16, v236
    v_and_b32 v5, 0xffff0000, v236
    v_pk_add_f32 v[56:57], v[56:57], v[4:5]
    v_lshlrev_b32 v6, 16, v237
    v_and_b32 v7, 0xffff0000, v237
    v_pk_add_f32 v[58:59], v[58:59], v[6:7]
    v_lshlrev_b32 v4, 16, v238
    v_and_b32 v5, 0xffff0000, v238
    v_pk_add_f32 v[60:61], v[60:61], v[4:5]
    v_lshlrev_b32 v6, 16, v239
    v_and_b32 v7, 0xffff0000, v239
    v_pk_add_f32 v[62:63], v[62:63], v[6:7]
    s_waitcnt vmcnt(9)
    v_lshlrev_b32 v4, 16, v112
    v_and_b32 v5, 0xffff0000, v112
    v_pk_add_f32 v[40:41], v[40:41], v[4:5]
    v_lshlrev_b32 v6, 16, v113
    v_and_b32 v7, 0xffff0000, v113
    v_pk_add_f32 v[42:43], v[42:43], v[6:7]
    v_lshlrev_b32 v4, 16, v114
    v_and_b32 v5, 0xffff0000, v114
    v_pk_add_f32 v[44:45], v[44:45], v[4:5]
    v_lshlrev_b32 v6, 16, v115
    v_and_b32 v7, 0xffff0000, v115
    v_pk_add_f32 v[46:47], v[46:47], v[6:7]
    v_lshlrev_b32 v4, 16, v176
    v_and_b32 v5, 0xffff0000, v176
    v_pk_add_f32 v[48:49], v[48:49], v[4:5]
    v_lshlrev_b32 v6, 16, v177
    v_and_b32 v7, 0xffff0000, v177
    v_pk_add_f32 v[50:51], v[50:51], v[6:7]
    v_lshlrev_b32 v4, 16, v178
    v_and_b32 v5, 0xffff0000, v178
    v_pk_add_f32 v[52:53], v[52:53], v[4:5]
    v_lshlrev_b32 v6, 16, v179
    v_and_b32 v7, 0xffff0000, v179
    v_pk_add_f32 v[54:55], v[54:55], v[6:7]
    v_lshlrev_b32 v4, 16, v240
    v_and_b32 v5, 0xffff0000, v240
    v_pk_add_f32 v[56:57], v[56:57], v[4:5]
    v_lshlrev_b32 v6, 16, v241
    v_and_b32 v7, 0xffff0000, v241
    v_pk_add_f32 v[58:59], v[58:59], v[6:7]
    v_lshlrev_b32 v4, 16, v242
    v_and_b32 v5, 0xffff0000, v242
    v_pk_add_f32 v[60:61], v[60:61], v[4:5]
    v_lshlrev_b32 v6, 16, v243
    v_and_b32 v7, 0xffff0000, v243
    v_pk_add_f32 v[62:63], v[62:63], v[6:7]
    s_waitcnt vmcnt(6)
    v_lshlrev_b32 v4, 16, v116
    v_and_b32 v5, 0xffff0000, v116
    v_pk_add_f32 v[40:41], v[40:41], v[4:5]
    v_lshlrev_b32 v6, 16, v117
    v_and_b32 v7, 0xffff0000, v117
    v_pk_add_f32 v[42:43], v[42:43], v[6:7]
    v_lshlrev_b32 v4, 16, v118
    v_and_b32 v5, 0xffff0000, v118
    v_pk_add_f32 v[44:45], v[44:45], v[4:5]
    v_lshlrev_b32 v6, 16, v119
    v_and_b32 v7, 0xffff0000, v119
    v_pk_add_f32 v[46:47], v[46:47], v[6:7]
    v_lshlrev_b32 v4, 16, v180
    v_and_b32 v5, 0xffff0000, v180
    v_pk_add_f32 v[48:49], v[48:49], v[4:5]
    v_lshlrev_b32 v6, 16, v181
    v_and_b32 v7, 0xffff0000, v181
    v_pk_add_f32 v[50:51], v[50:51], v[6:7]
    v_lshlrev_b32 v4, 16, v182
    v_and_b32 v5, 0xffff0000, v182
    v_pk_add_f32 v[52:53], v[52:53], v[4:5]
    v_lshlrev_b32 v6, 16, v183
    v_and_b32 v7, 0xffff0000, v183
    v_pk_add_f32 v[54:55], v[54:55], v[6:7]
    v_lshlrev_b32 v4, 16, v244
    v_and_b32 v5, 0xffff0000, v244
    v_pk_add_f32 v[56:57], v[56:57], v[4:5]
    v_lshlrev_b32 v6, 16, v245
    v_and_b32 v7, 0xffff0000, v245
    v_pk_add_f32 v[58:59], v[58:59], v[6:7]
    v_lshlrev_b32 v4, 16, v246
    v_and_b32 v5, 0xffff0000, v246
    v_pk_add_f32 v[60:61], v[60:61], v[4:5]
    v_lshlrev_b32 v6, 16, v247
    v_and_b32 v7, 0xffff0000, v247
    v_pk_add_f32 v[62:63], v[62:63], v[6:7]
    s_waitcnt vmcnt(3)
    v_lshlrev_b32 v4, 16, v120
    v_and_b32 v5, 0xffff0000, v120
    v_pk_add_f32 v[40:41], v[40:41], v[4:5]
    v_lshlrev_b32 v6, 16, v121
    v_and_b32 v7, 0xffff0000, v121
    v_pk_add_f32 v[42:43], v[42:43], v[6:7]
    v_lshlrev_b32 v4, 16, v122
    v_and_b32 v5, 0xffff0000, v122
    v_pk_add_f32 v[44:45], v[44:45], v[4:5]
    v_lshlrev_b32 v6, 16, v123
    v_and_b32 v7, 0xffff0000, v123
    v_pk_add_f32 v[46:47], v[46:47], v[6:7]
    v_lshlrev_b32 v4, 16, v184
    v_and_b32 v5, 0xffff0000, v184
    v_pk_add_f32 v[48:49], v[48:49], v[4:5]
    v_lshlrev_b32 v6, 16, v185
    v_and_b32 v7, 0xffff0000, v185
    v_pk_add_f32 v[50:51], v[50:51], v[6:7]
    v_lshlrev_b32 v4, 16, v186
    v_and_b32 v5, 0xffff0000, v186
    v_pk_add_f32 v[52:53], v[52:53], v[4:5]
    v_lshlrev_b32 v6, 16, v187
    v_and_b32 v7, 0xffff0000, v187
    v_pk_add_f32 v[54:55], v[54:55], v[6:7]
    v_lshlrev_b32 v4, 16, v248
    v_and_b32 v5, 0xffff0000, v248
    v_pk_add_f32 v[56:57], v[56:57], v[4:5]
    v_lshlrev_b32 v6, 16, v249
    v_and_b32 v7, 0xffff0000, v249
    v_pk_add_f32 v[58:59], v[58:59], v[6:7]
    v_lshlrev_b32 v4, 16, v250
    v_and_b32 v5, 0xffff0000, v250
    v_pk_add_f32 v[60:61], v[60:61], v[4:5]
    v_lshlrev_b32 v6, 16, v251
    v_and_b32 v7, 0xffff0000, v251
    v_pk_add_f32 v[62:63], v[62:63], v[6:7]
    s_waitcnt vmcnt(0)
    v_lshlrev_b32 v4, 16, v124
    v_and_b32 v5, 0xffff0000, v124
    v_pk_add_f32 v[40:41], v[40:41], v[4:5]
    v_lshlrev_b32 v6, 16, v125
    v_and_b32 v7, 0xffff0000, v125
    v_pk_add_f32 v[42:43], v[42:43], v[6:7]
    v_lshlrev_b32 v4, 16, v126
    v_and_b32 v5, 0xffff0000, v126
    v_pk_add_f32 v[44:45], v[44:45], v[4:5]
    v_lshlrev_b32 v6, 16, v127
    v_and_b32 v7, 0xffff0000, v127
    v_pk_add_f32 v[46:47], v[46:47], v[6:7]
    v_lshlrev_b32 v4, 16, v188
    v_and_b32 v5, 0xffff0000, v188
    v_pk_add_f32 v[48:49], v[48:49], v[4:5]
    v_lshlrev_b32 v6, 16, v189
    v_and_b32 v7, 0xffff0000, v189
    v_pk_add_f32 v[50:51], v[50:51], v[6:7]
    v_lshlrev_b32 v4, 16, v190
    v_and_b32 v5, 0xffff0000, v190
    v_pk_add_f32 v[52:53], v[52:53], v[4:5]
    v_lshlrev_b32 v6, 16, v191
    v_and_b32 v7, 0xffff0000, v191
    v_pk_add_f32 v[54:55], v[54:55], v[6:7]
    v_lshlrev_b32 v4, 16, v252
    v_and_b32 v5, 0xffff0000, v252
    v_pk_add_f32 v[56:57], v[56:57], v[4:5]
    v_lshlrev_b32 v6, 16, v253
    v_and_b32 v7, 0xffff0000, v253
    v_pk_add_f32 v[58:59], v[58:59], v[6:7]
    v_lshlrev_b32 v4, 16, v254
    v_and_b32 v5, 0xffff0000, v254
    v_pk_add_f32 v[60:61], v[60:61], v[4:5]
    v_lshlrev_b32 v6, 16, v255
    v_and_b32 v7, 0xffff0000, v255
    v_pk_add_f32 v[62:63], v[62:63], v[6:7]
    v_cvt_pk_bf16_f32 v40, v40, v41
    v_cvt_pk_bf16_f32 v41, v42, v43
    v_cvt_pk_bf16_f32 v42, v44, v45
    v_cvt_pk_bf16_f32 v43, v46, v47
    s_nop 0
    v_permlane32_swap_b32 v40, v42
    v_permlane32_swap_b32 v41, v43
    buffer_store_dwordx4 v[40:43], v11, s[72:75], s37 offen
    v_cvt_pk_bf16_f32 v48, v48, v49
    v_cvt_pk_bf16_f32 v49, v50, v51
    v_cvt_pk_bf16_f32 v50, v52, v53
    v_cvt_pk_bf16_f32 v51, v54, v55
    s_nop 0
    v_permlane32_swap_b32 v48, v50
    v_permlane32_swap_b32 v49, v51
    buffer_store_dwordx4 v[48:51], v11, s[72:75], s41 offen
    v_cvt_pk_bf16_f32 v56, v56, v57
    v_cvt_pk_bf16_f32 v57, v58, v59
    v_cvt_pk_bf16_f32 v58, v60, v61
    v_cvt_pk_bf16_f32 v59, v62, v63
    s_nop 0
    v_permlane32_swap_b32 v56, v58
    v_permlane32_swap_b32 v57, v59
    buffer_store_dwordx4 v[56:59], v11, s[72:75], s45 offen
L_ldone:
    s_endpgm
L_rf0_l2:
    s_call_b64 s[64:65], L_refill_l2
    s_branch L_rb0_l2
L_rf1_l2:
    s_call_b64 s[64:65], L_refill_l2
    s_branch L_rb1_l2
L_rf2_l2:
    s_call_b64 s[64:65], L_refill_l2
    s_branch L_rb2_l2
L_rf3_l2:
    s_call_b64 s[64:65], L_refill_l2
    s_branch L_rb3_l2
L_rf4_l2:
    s_call_b64 s[64:65], L_refill_l2
    s_branch L_rb4_l2
L_rf5_l2:
    s_call_b64 s[64:65], L_refill_l2
    s_branch L_rb5_l2
L_rf6_l2:
    s_call_b64 s[64:65], L_refill_l2
    s_branch L_rb6_l2
L_rf7_l2:
    s_call_b64 s[64:65], L_refill_l2
    s_branch L_rb7_l2
L_rf8_l2:
    s_call_b64 s[64:65], L_refill_l2
    s_branch L_rb8_l2
L_rf9_l2:
    s_call_b64 s[64:65], L_refill_l2
    s_branch L_rb9_l2
L_rf10_l2:
    s_call_b64 s[64:65], L_refill_l2
    s_branch L_rb10_l2
L_rf11_l2:
    s_call_b64 s[64:65], L_refill_l2
    s_branch L_rb11_l2
L_rf12_l2:
    s_call_b64 s[64:65], L_refill_l2
    s_branch L_rb12_l2
L_rf13_l2:
    s_call_b64 s[64:65], L_refill_l2
    s_branch L_rb13_l2
L_rf14_l2:
    s_call_b64 s[64:65], L_refill_l2
    s_branch L_rb14_l2
L_rf15_l2:
    s_call_b64 s[64:65], L_refill_l2
    s_branch L_rb15_l2
L_refill_l2:
    s_mul_i32 exec_lo, s26, 0x10001
    s_mov_b32 exec_hi, s26
    s_branch L_go_l2
L_slp_l2:
L_go_l2:
    buffer_load_dword v9, v10, s[12:15], 0 offen sc1
    s_mov_b32 s27, s26
    s_add_u32 s24, s24, 1
    s_cmp_gt_u32 s24, 0x40000
    s_waitcnt vmcnt(0)
    s_cbranch_scc1 L_got_l2
    v_cmp_lt_u32 vcc, 2, v9
    s_nop 0
    s_lshr_b32 s27, vcc_lo, 16
    s_and_b32 s27, s27, vcc_lo
    s_and_b32 s27, s27, vcc_hi
    s_cbranch_scc0 L_slp_l2
L_got_l2:
    s_andn2_b32 s26, s26, s27
    s_mov_b64 exec, -1
    s_setpc_b64 s[64:65]
L_rf0_l3:
    s_call_b64 s[64:65], L_refill_l3
    s_branch L_rb0_l3
L_rf1_l3:
    s_call_b64 s[64:65], L_refill_l3
    s_branch L_rb1_l3
L_rf2_l3:
    s_call_b64 s[64:65], L_refill_l3
    s_branch L_rb2_l3
L_rf3_l3:
    s_call_b64 s[64:65], L_refill_l3
    s_branch L_rb3_l3
L_rf4_l3:
    s_call_b64 s[64:65], L_refill_l3
    s_branch L_rb4_l3
L_rf5_l3:
    s_call_b64 s[64:65], L_refill_l3
    s_branch L_rb5_l3
L_rf6_l3:
    s_call_b64 s[64:65], L_refill_l3
    s_branch L_rb6_l3
L_rf7_l3:
    s_call_b64 s[64:65], L_refill_l3
    s_branch L_rb7_l3
L_rf8_l3:
    s_call_b64 s[64:65], L_refill_l3
    s_branch L_rb8_l3
L_rf9_l3:
    s_call_b64 s[64:65], L_refill_l3
    s_branch L_rb9_l3
L_rf10_l3:
    s_call_b64 s[64:65], L_refill_l3
    s_branch L_rb10_l3
L_rf11_l3:
    s_call_b64 s[64:65], L_refill_l3
    s_branch L_rb11_l3
L_rf12_l3:
    s_call_b64 s[64:65], L_refill_l3
    s_branch L_rb12_l3
L_rf13_l3:
    s_call_b64 s[64:65], L_refill_l3
    s_branch L_rb13_l3
L_rf14_l3:
    s_call_b64 s[64:65], L_refill_l3
    s_branch L_rb14_l3
L_rf15_l3:
    s_call_b64 s[64:65], L_refill_l3
    s_branch L_rb15_l3
L_refill_l3:
    s_mul_i32 exec_lo, s26, 0x10001
    s_mov_b32 exec_hi, s26
    s_branch L_go_l3
L_slp_l3:
L_go_l3:
    buffer_load_dword v9, v10, s[12:15], 0 offen sc1
    s_mov_b32 s27, s26
    s_add_u32 s24, s24, 1
    s_cmp_gt_u32 s24, 0x40000
    s_waitcnt vmcnt(0)
    s_cbranch_scc1 L_got_l3
    v_cmp_lt_u32 vcc, 2, v9
    s_nop 0
    s_lshr_b32 s27, vcc_lo, 16
    s_and_b32 s27, s27, vcc_lo
    s_and_b32 s27, s27, vcc_hi
    s_cbranch_scc0 L_slp_l3
L_got_l3:
    s_andn2_b32 s26, s26, s27
    s_mov_b64 exec, -1
    s_setpc_b64 s[64:65]
.p2align 6
L_compute:
    v_and_b32 v2, 63, v0
    s_and_b32 s26, s2, 7
    s_bfe_u32 s29, s2, 0x30004
    s_bfe_u32 s28, s2, 0x10003
    s_lshl_b32 s31, s26, 1
    s_add_u32 s31, s31, s28
    s_lshl_b32 s32, s29, 3
    s_add_u32 s32, s32, s26
    s_lshl_b32 s35, s29, 4
    s_add_u32 s35, s35, s31
    s_cmp_eq_u32 s30, 0
    s_cselect_b32 s32, s32, s35
    s_lshr_b32 s28, s2, 4
    s_mul_i32 s63, s33, 28672
    s_waitcnt lgkmcnt(0)
    s_lshl_b32 s3, s30, 7
    s_add_u32 s3, s3, s35
    s_mul_i32 s3, s3, 86016
    s_add_u32 s56, s80, s3
    s_addc_u32 s57, s81, 0
    s_mov_b32 s58, 86016
    s_mov_b32 s59, 0x20000
    s_lshl_b32 s3, s28, 13
    s_add_u32 s3, s3, 33554432
    s_add_u32 s12, s80, s3
    s_addc_u32 s13, s81, 0
    s_mov_b32 s14, 6144
    s_mov_b32 s15, 0x20000
    s_lshl_b32 s3, s28, 4
    s_add_u32 s4, s78, s3
    s_addc_u32 s5, s79, 0
    s_mov_b32 s6, 16
    s_mov_b32 s7, 0x20000
    s_add_u32 s8, s80, 34603008
    s_addc_u32 s9, s81, 0
    s_mov_b32 s10, 4096
    s_mov_b32 s11, 0x20000
    s_and_b32 s82, s2, 7
    s_lshl_b32 s82, s82, 9
    s_or_b32 s22, s33, s31
    s_cmp_lg_u32 s22, 0
    s_cbranch_scc1 L_noclear
    v_lshlrev_b32 v14, 4, v2
    v_mov_b32 v16, 0
    v_mov_b32 v17, 0
    v_mov_b32 v18, 0
    v_mov_b32 v19, 0
    s_mov_b32 s21, 3072
    buffer_store_dwordx4 v[16:19], v14, s[12:15], 0 offen offset:0 sc1
    buffer_store_dwordx4 v[16:19], v14, s[12:15], 0 offen offset:1024 sc1
    buffer_store_dwordx4 v[16:19], v14, s[12:15], 0 offen offset:2048 sc1
    s_nop 1
L_noclear:
    s_lshr_b32 s3, s2, 3
    s_or_b32 s3, s3, s33
    s_cmp_lg_u32 s3, 0
    s_cbranch_scc1 L_noclear2
    v_lshlrev_b32 v14, 2, v2
    v_mov_b32 v16, 0
    buffer_store_dword v16, v14, s[8:11], s82 offen sc1
L_noclear2:
    s_lshl_b32 s3, s33, 10
    s_lshl_b32 s21, s31, 6
    s_add_u32 s3, s3, s21
    v_lshrrev_b32 v5, 4, v2
    v_lshlrev_b32 v5, 14, v5
    v_lshl_add_u32 v5, v2, 2, v5
    v_add_u32 v127, s3, v5
    v_and_b32 v3, 15, v2
    v_lshrrev_b32 v4, 4, v2
    v_bfe_u32 v6, v2, 1, 3
    v_xor_b32 v6, v6, v4
    v_lshlrev_b32 v6, 4, v6
    v_lshl_add_u32 v6, v3, 7, v6
    s_mul_i32 s3, s33, 32768
    s_mul_i32 s21, s33, 16384
    s_add_u32 s21, s21, 98304
    v_xor_b32 v5, 0, v6
    v_add_u32 v40, s3, v5
    v_add_u32 v42, s21, v5
    v_xor_b32 v5, 64, v6
    v_add_u32 v41, s3, v5
    v_add_u32 v43, s21, v5
    v_bfe_u32 v7, v2, 2, 2
    v_and_b32 v8, 3, v2
    v_lshlrev_b32 v8, 3, v8
    v_bfe_u32 v9, v2, 2, 3
    v_lshl_add_u32 v10, v9, 5, v8
    v_lshl_add_u32 v11, v4, 3, v7
    v_lshl_add_u32 v6, v11, 8, v10
    v_xor_b32 v16, 0, v6
    v_add_u32 v24, 0x10000, v16
    v_add_u32 v32, 0x20000, v16
    v_xor_b32 v17, 32, v6
    v_add_u32 v25, 0x10000, v17
    v_add_u32 v33, 0x20000, v17
    v_xor_b32 v18, 64, v6
    v_add_u32 v26, 0x10000, v18
    v_add_u32 v34, 0x20000, v18
    v_xor_b32 v19, 96, v6
    v_add_u32 v27, 0x10000, v19
    v_add_u32 v35, 0x20000, v19
    v_xor_b32 v20, 128, v6
    v_add_u32 v28, 0x10000, v20
    v_add_u32 v36, 0x20000, v20
    v_xor_b32 v21, 160, v6
    v_add_u32 v29, 0x10000, v21
    v_add_u32 v37, 0x20000, v21
    v_xor_b32 v22, 192, v6
    v_add_u32 v30, 0x10000, v22
    v_add_u32 v38, 0x20000, v22
    v_xor_b32 v23, 224, v6
    v_add_u32 v31, 0x10000, v23
    v_add_u32 v39, 0x20000, v23
    v_lshrrev_b32 v11, 2, v2
    v_lshl_add_u32 v6, v11, 9, v10
    v_xor_b32 v5, 0, v6
    v_add_u32 v88, 49152, v5
    v_xor_b32 v5, 32, v6
    v_add_u32 v89, 49152, v5
    v_xor_b32 v5, 64, v6
    v_add_u32 v90, 49152, v5
    v_xor_b32 v5, 96, v6
    v_add_u32 v91, 49152, v5
    v_xor_b32 v5, 128, v6
    v_add_u32 v92, 49152, v5
    v_xor_b32 v5, 160, v6
    v_add_u32 v93, 49152, v5
    v_xor_b32 v5, 192, v6
    v_add_u32 v94, 49152, v5
    v_xor_b32 v5, 224, v6
    v_add_u32 v95, 49152, v5
    v_bfe_u32 v9, v2, 3, 2
    v_lshl_add_u32 v10, v9, 5, v8
    v_lshl_add_u32 v6, v11, 7, v10
    v_xor_b32 v104, 0, v6
    v_add_u32 v108, 0x10000, v104
    v_add_u32 v112, 0x20000, v104
    v_xor_b32 v105, 32, v6
    v_add_u32 v109, 0x10000, v105
    v_add_u32 v113, 0x20000, v105
    v_xor_b32 v106, 64, v6
    v_add_u32 v110, 0x10000, v106
    v_add_u32 v114, 0x20000, v106
    v_xor_b32 v107, 96, v6
    v_add_u32 v111, 0x10000, v107
    v_add_u32 v115, 0x20000, v107
    v_xor_b32 v6, v3, v4
    v_lshlrev_b32 v6, 4, v6
    v_lshl_add_u32 v6, v3, 9, v6
    v_xor_b32 v80, 0, v6
    v_add_u32 v84, 114688, v80
    v_xor_b32 v81, 64, v6
    v_add_u32 v85, 114688, v81
    v_xor_b32 v82, 128, v6
    v_add_u32 v86, 114688, v82
    v_xor_b32 v83, 192, v6
    v_add_u32 v87, 114688, v83
    v_lshlrev_b32 v124, 4, v2
    s_mul_i32 s3, s28, 1376256
    s_add_u32 s84, s80, s3
    s_addc_u32 s85, s81, 0
    s_mov_b32 s86, 1376256
    s_mov_b32 s87, 0x20000
    s_mul_i32 s3, s29, 172032
    s_mul_i32 s23, s30, 896
    s_add_u32 s3, s3, s23
    s_sub_u32 s23, 172032, s23
    s_add_u32 s72, s76, s3
    s_addc_u32 s73, s77, 0
    s_mov_b32 s74, s23
    s_mov_b32 s75, 0x20000
    v_lshrrev_b32 v5, 5, v2
    v_bfe_u32 v6, v2, 3, 1
    v_and_b32 v7, 7, v2
    v_and_b32 v4, 16, v2
    v_lshlrev_b32 v8, 11, v6
    v_lshl_add_u32 v8, v4, 5, v8
    v_lshl_add_u32 v8, v5, 8, v8
    v_lshl_add_u32 v0, v7, 4, v8
    v_mul_u32_u24 v8, 1792, v7
    v_lshl_add_u32 v8, v6, 6, v8
    v_lshl_add_u32 v8, v5, 5, v8
    v_add_u32 v11, v8, v4
    v_and_b32 v8, 15, v2
    v_lshlrev_b32 v12, 6, v8
    s_lshr_b32 s20, s31, 2
    s_mul_i32 s20, s20, 12
    s_and_b32 s21, s31, 3
    s_add_u32 s20, s20, s21
    s_lshl_b32 s21, s33, 2
    s_add_u32 s20, s20, s21
    s_add_u32 s20, s20, 36
    s_mul_i32 s19, s20, 43
    s_lshr_b32 s19, s19, 9
    s_mul_i32 s3, s19, 12
    s_sub_u32 s3, s20, s3
    s_lshr_b32 s23, s3, 2
    s_mul_i32 s16, s23, 28672
    s_lshl_b32 s18, s23, 10
    s_lshl_b32 s23, s19, 12
    s_add_u32 s16, s16, s23
    s_and_b32 s23, s3, 2
    s_lshl_b32 s23, s23, 9
    s_add_u32 s16, s16, s23
    s_and_b32 s23, s3, 1
    s_lshl_b32 s23, s23, 7
    s_add_u32 s16, s16, s23
    s_mul_i32 s17, s3, 14336
    s_lshl_b32 s23, s19, 7
    s_add_u32 s17, s17, s23
    s_lshl_b32 s20, 1, s31
    s_mov_b32 s60, 0x3db8aa3b
    s_mov_b32 s61, 0x47800000
    v_mov_b32 v5, 0x3f803f80
    v_accvgpr_write_b32 a240, v5
    v_accvgpr_write_b32 a241, v5
    v_accvgpr_write_b32 a242, v5
    v_accvgpr_write_b32 a243, v5
    s_mov_b32 s62, 4
    s_cmp_eq_u32 s22, 0
    s_barrier
    ds_read_b128 a[128:131], v40 offset:0
    ds_read_b128 a[132:135], v40 offset:2048
    ds_read_b128 a[136:139], v41 offset:0
    ds_read_b128 a[140:143], v41 offset:2048
    ds_read_b64_tr_b16 a[64:65], v16 offset:16384
    ds_read_b64_tr_b16 a[66:67], v16 offset:17408
    ds_read_b64_tr_b16 a[68:69], v17 offset:16384
    ds_read_b64_tr_b16 a[70:71], v17 offset:17408
    ds_read_b64_tr_b16 a[72:73], v18 offset:16384
    ds_read_b64_tr_b16 a[74:75], v18 offset:17408
    ds_read_b64_tr_b16 a[76:77], v19 offset:16384
    ds_read_b64_tr_b16 a[78:79], v19 offset:17408
    ds_read_b64_tr_b16 a[80:81], v20 offset:16384
    ds_read_b64_tr_b16 a[82:83], v20 offset:17408
    ds_read_b64_tr_b16 a[84:85], v21 offset:16384
    s_waitcnt lgkmcnt(13)
    ds_read_b64_tr_b16 a[86:87], v21 offset:17408
    s_waitcnt lgkmcnt(8)
    v_mfma_f32_16x16x32_bf16 v[128:131], a[64:67], a[128:131], 0
    ds_read_b64_tr_b16 a[88:89], v22 offset:16384
    ds_read_b64_tr_b16 a[90:91], v22 offset:17408
    v_mfma_f32_16x16x32_bf16 v[136:139], a[64:67], a[132:135], 0
    v_mfma_f32_16x16x32_bf16 v[140:143], a[68:71], a[132:135], 0
    ds_read_b64_tr_b16 a[92:93], v23 offset:16384
    ds_read_b64_tr_b16 a[94:95], v23 offset:17408
    ds_read_b64_tr_b16 a[96:97], v16 offset:24576
    v_mfma_f32_16x16x32_bf16 v[132:135], a[68:71], a[128:131], 0
    ds_read_b64_tr_b16 a[98:99], v16 offset:25600
    s_waitcnt lgkmcnt(10)
    v_mfma_f32_16x16x32_bf16 v[144:147], a[72:75], a[128:131], 0
    ds_read_b64_tr_b16 a[100:101], v17 offset:24576
    ds_read_b64_tr_b16 a[102:103], v17 offset:25600
    v_mfma_f32_16x16x32_bf16 v[152:155], a[72:75], a[132:135], 0
    v_mfma_f32_16x16x32_bf16 v[156:159], a[76:79], a[132:135], 0
    ds_read_b64_tr_b16 a[104:105], v18 offset:24576
    v_mfma_f32_16x16x32_bf16 v[148:151], a[76:79], a[128:131], 0
    ds_read_b64_tr_b16 a[106:107], v18 offset:25600
    s_waitcnt lgkmcnt(10)
    v_mfma_f32_16x16x32_bf16 v[160:163], a[80:83], a[128:131], 0
    ds_read_b64_tr_b16 a[108:109], v19 offset:24576
    ds_read_b64_tr_b16 a[110:111], v19 offset:25600
    v_mfma_f32_16x16x32_bf16 v[168:171], a[80:83], a[132:135], 0
    v_mfma_f32_16x16x32_bf16 v[172:175], a[84:87], a[132:135], 0
    ds_read_b64_tr_b16 a[112:113], v20 offset:24576
    v_mfma_f32_16x16x32_bf16 v[164:167], a[84:87], a[128:131], 0
    ds_read_b64_tr_b16 a[114:115], v20 offset:25600
    s_waitcnt lgkmcnt(10)
    v_mfma_f32_16x16x32_bf16 v[176:179], a[88:91], a[128:131], 0
    ds_read_b64_tr_b16 a[116:117], v21 offset:24576
    ds_read_b64_tr_b16 a[118:119], v21 offset:25600
    v_mfma_f32_16x16x32_bf16 v[184:187], a[88:91], a[132:135], 0
    v_mfma_f32_16x16x32_bf16 v[188:191], a[92:95], a[132:135], 0
    ds_read_b64_tr_b16 a[120:121], v22 offset:24576
    v_mfma_f32_16x16x32_bf16 v[180:183], a[92:95], a[128:131], 0
    ds_read_b64_tr_b16 a[122:123], v22 offset:25600
    s_waitcnt lgkmcnt(10)
    v_mfma_f32_16x16x32_bf16 v[128:131], a[96:99], a[136:139], v[128:131]
    ds_read_b64_tr_b16 a[124:125], v23 offset:24576
    ds_read_b64_tr_b16 a[126:127], v23 offset:25600
    v_mfma_f32_16x16x32_bf16 v[136:139], a[96:99], a[140:143], v[136:139]
    v_mfma_f32_16x16x32_bf16 v[140:143], a[100:103], a[140:143], v[140:143]
    v_mfma_f32_16x16x32_bf16 v[132:135], a[100:103], a[136:139], v[132:135]
    s_waitcnt lgkmcnt(8)
    v_mfma_f32_16x16x32_bf16 v[144:147], a[104:107], a[136:139], v[144:147]
    v_mfma_f32_16x16x32_bf16 v[152:155], a[104:107], a[140:143], v[152:155]
    v_mfma_f32_16x16x32_bf16 v[156:159], a[108:111], a[140:143], v[156:159]
    s_waitcnt lgkmcnt(0)
    s_barrier
    v_mfma_f32_16x16x32_bf16 v[148:151], a[108:111], a[136:139], v[148:151]
    ds_read_b64_tr_b16 a[64:65], v16 offset:49152
    ds_read_b64_tr_b16 a[66:67], v16 offset:50176
    ds_read_b64_tr_b16 a[68:69], v17 offset:49152
    ds_read_b64_tr_b16 a[70:71], v17 offset:50176
    v_mfma_f32_16x16x32_bf16 v[160:163], a[112:115], a[136:139], v[160:163]
    ds_read_b64_tr_b16 a[72:73], v18 offset:49152
    ds_read_b64_tr_b16 a[74:75], v18 offset:50176
    v_mfma_f32_16x16x32_bf16 v[168:171], a[112:115], a[140:143], v[168:171]
    ds_read_b128 a[144:147], v40 offset:4096
    v_mfma_f32_16x16x32_bf16 v[172:175], a[116:119], a[140:143], v[172:175]
    ds_read_b64_tr_b16 a[76:77], v19 offset:49152
    ds_read_b64_tr_b16 a[78:79], v19 offset:50176
    v_mfma_f32_16x16x32_bf16 v[164:167], a[116:119], a[136:139], v[164:167]
    ds_read_b128 a[148:151], v40 offset:6144
    v_mfma_f32_16x16x32_bf16 v[176:179], a[120:123], a[136:139], v[176:179]
    ds_read_b64_tr_b16 a[80:81], v20 offset:49152
    ds_read_b64_tr_b16 a[82:83], v20 offset:50176
    v_mfma_f32_16x16x32_bf16 v[184:187], a[120:123], a[140:143], v[184:187]
    ds_read_b128 a[152:155], v41 offset:4096
    v_mfma_f32_16x16x32_bf16 v[188:191], a[124:127], a[140:143], v[188:191]
    ds_read_b64_tr_b16 a[84:85], v21 offset:49152
    ds_read_b128 a[156:159], v41 offset:6144
    v_mfma_f32_16x16x32_bf16 v[180:183], a[124:127], a[136:139], v[180:183]
    s_waitcnt lgkmcnt(13)
    ds_read_b64_tr_b16 a[86:87], v21 offset:50176
    s_waitcnt lgkmcnt(6)
    v_mfma_f32_16x16x32_bf16 v[128:131], a[64:67], a[144:147], v[128:131]
    ds_read_b64_tr_b16 a[88:89], v22 offset:49152
    ds_read_b64_tr_b16 a[90:91], v22 offset:50176
    v_mfma_f32_16x16x32_bf16 v[136:139], a[64:67], a[148:151], v[136:139]
    v_mfma_f32_16x16x32_bf16 v[140:143], a[68:71], a[148:151], v[140:143]
    ds_read_b64_tr_b16 a[92:93], v23 offset:49152
    ds_read_b64_tr_b16 a[94:95], v23 offset:50176
    ds_read_b64_tr_b16 a[96:97], v16 offset:57344
    v_mfma_f32_16x16x32_bf16 v[132:135], a[68:71], a[144:147], v[132:135]
    ds_read_b64_tr_b16 a[98:99], v16 offset:58368
    v_mfma_f32_16x16x32_bf16 v[144:147], a[72:75], a[144:147], v[144:147]
    ds_read_b64_tr_b16 a[100:101], v17 offset:57344
    ds_read_b64_tr_b16 a[102:103], v17 offset:58368
    v_mfma_f32_16x16x32_bf16 v[152:155], a[72:75], a[148:151], v[152:155]
    v_mfma_f32_16x16x32_bf16 v[156:159], a[76:79], a[148:151], v[156:159]
    ds_read_b64_tr_b16 a[104:105], v18 offset:57344
    v_mfma_f32_16x16x32_bf16 v[148:151], a[76:79], a[144:147], v[148:151]
    s_waitcnt lgkmcnt(13)
    ds_read_b64_tr_b16 a[106:107], v18 offset:58368
    s_waitcnt lgkmcnt(10)
    v_mfma_f32_16x16x32_bf16 v[160:163], a[80:83], a[144:147], v[160:163]
    ds_read_b64_tr_b16 a[108:109], v19 offset:57344
    ds_read_b64_tr_b16 a[110:111], v19 offset:58368
    v_mfma_f32_16x16x32_bf16 v[168:171], a[80:83], a[148:151], v[168:171]
    v_mfma_f32_16x16x32_bf16 v[172:175], a[84:87], a[148:151], v[172:175]
    ds_read_b64_tr_b16 a[112:113], v20 offset:57344
    v_mfma_f32_16x16x32_bf16 v[164:167], a[84:87], a[144:147], v[164:167]
    ds_read_b64_tr_b16 a[114:115], v20 offset:58368
    s_waitcnt lgkmcnt(10)
    v_mfma_f32_16x16x32_bf16 v[176:179], a[88:91], a[144:147], v[176:179]
    ds_read_b64_tr_b16 a[116:117], v21 offset:57344
    ds_read_b64_tr_b16 a[118:119], v21 offset:58368
    v_mfma_f32_16x16x32_bf16 v[184:187], a[88:91], a[148:151], v[184:187]
    v_mfma_f32_16x16x32_bf16 v[188:191], a[92:95], a[148:151], v[188:191]
    ds_read_b64_tr_b16 a[120:121], v22 offset:57344
    v_mfma_f32_16x16x32_bf16 v[180:183], a[92:95], a[144:147], v[180:183]
    ds_read_b64_tr_b16 a[122:123], v22 offset:58368
    s_waitcnt lgkmcnt(10)
    v_mfma_f32_16x16x32_bf16 v[128:131], a[96:99], a[152:155], v[128:131]
    ds_read_b64_tr_b16 a[124:125], v23 offset:57344
    ds_read_b64_tr_b16 a[126:127], v23 offset:58368
    v_mfma_f32_16x16x32_bf16 v[136:139], a[96:99], a[156:159], v[136:139]
    v_mfma_f32_16x16x32_bf16 v[140:143], a[100:103], a[156:159], v[140:143]
    v_mfma_f32_16x16x32_bf16 v[132:135], a[100:103], a[152:155], v[132:135]
    s_waitcnt lgkmcnt(8)
    v_mfma_f32_16x16x32_bf16 v[144:147], a[104:107], a[152:155], v[144:147]
    v_mfma_f32_16x16x32_bf16 v[152:155], a[104:107], a[156:159], v[152:155]
    v_mfma_f32_16x16x32_bf16 v[156:159], a[108:111], a[156:159], v[156:159]
    s_waitcnt lgkmcnt(0)
    s_barrier
    v_mfma_f32_16x16x32_bf16 v[148:151], a[108:111], a[152:155], v[148:151]
    ds_read_b64_tr_b16 a[64:65], v32 offset:16384
    ds_read_b64_tr_b16 a[66:67], v32 offset:17408
    ds_read_b64_tr_b16 a[68:69], v33 offset:16384
    ds_read_b64_tr_b16 a[70:71], v33 offset:17408
    v_mfma_f32_16x16x32_bf16 v[160:163], a[112:115], a[152:155], v[160:163]
    ds_read_b64_tr_b16 a[72:73], v34 offset:16384
    ds_read_b64_tr_b16 a[74:75], v34 offset:17408
    v_mfma_f32_16x16x32_bf16 v[168:171], a[112:115], a[156:159], v[168:171]
    ds_read_b128 a[160:163], v40 offset:8192
    v_mfma_f32_16x16x32_bf16 v[172:175], a[116:119], a[156:159], v[172:175]
    ds_read_b64_tr_b16 a[76:77], v35 offset:16384
    ds_read_b64_tr_b16 a[78:79], v35 offset:17408
    v_mfma_f32_16x16x32_bf16 v[164:167], a[116:119], a[152:155], v[164:167]
    ds_read_b128 a[164:167], v40 offset:10240
    v_mfma_f32_16x16x32_bf16 v[176:179], a[120:123], a[152:155], v[176:179]
    ds_read_b64_tr_b16 a[80:81], v36 offset:16384
    ds_read_b64_tr_b16 a[82:83], v36 offset:17408
    v_mfma_f32_16x16x32_bf16 v[184:187], a[120:123], a[156:159], v[184:187]
    ds_read_b128 a[168:171], v41 offset:8192
    v_mfma_f32_16x16x32_bf16 v[188:191], a[124:127], a[156:159], v[188:191]
    ds_read_b64_tr_b16 a[84:85], v37 offset:16384
    ds_read_b128 a[172:175], v41 offset:10240
    v_mfma_f32_16x16x32_bf16 v[180:183], a[124:127], a[152:155], v[180:183]
    s_waitcnt lgkmcnt(13)
    ds_read_b64_tr_b16 a[86:87], v37 offset:17408
    s_waitcnt lgkmcnt(6)
    v_mfma_f32_16x16x32_bf16 v[128:131], a[64:67], a[160:163], v[128:131]
    ds_read_b64_tr_b16 a[88:89], v38 offset:16384
    ds_read_b64_tr_b16 a[90:91], v38 offset:17408
    v_mfma_f32_16x16x32_bf16 v[136:139], a[64:67], a[164:167], v[136:139]
    v_mfma_f32_16x16x32_bf16 v[140:143], a[68:71], a[164:167], v[140:143]
    ds_read_b64_tr_b16 a[92:93], v39 offset:16384
    ds_read_b64_tr_b16 a[94:95], v39 offset:17408
    ds_read_b64_tr_b16 a[96:97], v32 offset:24576
    v_mfma_f32_16x16x32_bf16 v[132:135], a[68:71], a[160:163], v[132:135]
    ds_read_b64_tr_b16 a[98:99], v32 offset:25600
    v_mfma_f32_16x16x32_bf16 v[144:147], a[72:75], a[160:163], v[144:147]
    ds_read_b64_tr_b16 a[100:101], v33 offset:24576
    ds_read_b64_tr_b16 a[102:103], v33 offset:25600
    v_mfma_f32_16x16x32_bf16 v[152:155], a[72:75], a[164:167], v[152:155]
    v_mfma_f32_16x16x32_bf16 v[156:159], a[76:79], a[164:167], v[156:159]
    ds_read_b64_tr_b16 a[104:105], v34 offset:24576
    v_mfma_f32_16x16x32_bf16 v[148:151], a[76:79], a[160:163], v[148:151]
    s_waitcnt lgkmcnt(13)
    ds_read_b64_tr_b16 a[106:107], v34 offset:25600
    s_waitcnt lgkmcnt(10)
    v_mfma_f32_16x16x32_bf16 v[160:163], a[80:83], a[160:163], v[160:163]
    ds_read_b64_tr_b16 a[108:109], v35 offset:24576
    ds_read_b64_tr_b16 a[110:111], v35 offset:25600
    v_mfma_f32_16x16x32_bf16 v[168:171], a[80:83], a[164:167], v[168:171]
    v_mfma_f32_16x16x32_bf16 v[172:175], a[84:87], a[164:167], v[172:175]
    ds_read_b64_tr_b16 a[112:113], v36 offset:24576
    v_mfma_f32_16x16x32_bf16 v[164:167], a[84:87], a[160:163], v[164:167]
    ds_read_b64_tr_b16 a[114:115], v36 offset:25600
    s_waitcnt lgkmcnt(10)
    v_mfma_f32_16x16x32_bf16 v[176:179], a[88:91], a[160:163], v[176:179]
    ds_read_b64_tr_b16 a[116:117], v37 offset:24576
    ds_read_b64_tr_b16 a[118:119], v37 offset:25600
    v_mfma_f32_16x16x32_bf16 v[184:187], a[88:91], a[164:167], v[184:187]
    v_mfma_f32_16x16x32_bf16 v[188:191], a[92:95], a[164:167], v[188:191]
    ds_read_b64_tr_b16 a[120:121], v38 offset:24576
    v_mfma_f32_16x16x32_bf16 v[180:183], a[92:95], a[160:163], v[180:183]
    ds_read_b64_tr_b16 a[122:123], v38 offset:25600
    s_waitcnt lgkmcnt(10)
    v_mfma_f32_16x16x32_bf16 v[128:131], a[96:99], a[168:171], v[128:131]
    ds_read_b64_tr_b16 a[124:125], v39 offset:24576
    ds_read_b64_tr_b16 a[126:127], v39 offset:25600
    v_mfma_f32_16x16x32_bf16 v[136:139], a[96:99], a[172:175], v[136:139]
    v_mfma_f32_16x16x32_bf16 v[140:143], a[100:103], a[172:175], v[140:143]
    v_mfma_f32_16x16x32_bf16 v[132:135], a[100:103], a[168:171], v[132:135]
    s_waitcnt lgkmcnt(8)
    v_mfma_f32_16x16x32_bf16 v[144:147], a[104:107], a[168:171], v[144:147]
    v_mfma_f32_16x16x32_bf16 v[152:155], a[104:107], a[172:175], v[152:155]
    v_mfma_f32_16x16x32_bf16 v[156:159], a[108:111], a[172:175], v[156:159]
    s_waitcnt lgkmcnt(0)
    s_barrier
    v_mfma_f32_16x16x32_bf16 v[148:151], a[108:111], a[168:171], v[148:151]
    ds_read_b64_tr_b16 a[64:65], v24 offset:16384
    ds_read_b64_tr_b16 a[66:67], v24 offset:17408
    ds_read_b64_tr_b16 a[68:69], v25 offset:16384
    ds_read_b64_tr_b16 a[70:71], v25 offset:17408
    v_mfma_f32_16x16x32_bf16 v[160:163], a[112:115], a[168:171], v[160:163]
    ds_read_b64_tr_b16 a[72:73], v26 offset:16384
    ds_read_b64_tr_b16 a[74:75], v26 offset:17408
    v_mfma_f32_16x16x32_bf16 v[168:171], a[112:115], a[172:175], v[168:171]
    ds_read_b128 a[176:179], v40 offset:12288
    v_mfma_f32_16x16x32_bf16 v[172:175], a[116:119], a[172:175], v[172:175]
    ds_read_b64_tr_b16 a[76:77], v27 offset:16384
    ds_read_b64_tr_b16 a[78:79], v27 offset:17408
    v_mfma_f32_16x16x32_bf16 v[164:167], a[116:119], a[168:171], v[164:167]
    ds_read_b128 a[180:183], v40 offset:14336
    v_mfma_f32_16x16x32_bf16 v[176:179], a[120:123], a[168:171], v[176:179]
    ds_read_b64_tr_b16 a[80:81], v28 offset:16384
    ds_read_b64_tr_b16 a[82:83], v28 offset:17408
    v_mfma_f32_16x16x32_bf16 v[184:187], a[120:123], a[172:175], v[184:187]
    ds_read_b128 a[184:187], v41 offset:12288
    v_mfma_f32_16x16x32_bf16 v[188:191], a[124:127], a[172:175], v[188:191]
    ds_read_b64_tr_b16 a[84:85], v29 offset:16384
    ds_read_b128 a[188:191], v41 offset:14336
    v_mfma_f32_16x16x32_bf16 v[180:183], a[124:127], a[168:171], v[180:183]
    s_waitcnt lgkmcnt(13)
    ds_read_b64_tr_b16 a[86:87], v29 offset:17408
    s_waitcnt lgkmcnt(6)
    v_mfma_f32_16x16x32_bf16 v[128:131], a[64:67], a[176:179], v[128:131]
    ds_read_b64_tr_b16 a[88:89], v30 offset:16384
    ds_read_b64_tr_b16 a[90:91], v30 offset:17408
    v_mfma_f32_16x16x32_bf16 v[136:139], a[64:67], a[180:183], v[136:139]
    v_mfma_f32_16x16x32_bf16 v[140:143], a[68:71], a[180:183], v[140:143]
    ds_read_b64_tr_b16 a[92:93], v31 offset:16384
    ds_read_b64_tr_b16 a[94:95], v31 offset:17408
    ds_read_b64_tr_b16 a[96:97], v24 offset:24576
    v_mfma_f32_16x16x32_bf16 v[132:135], a[68:71], a[176:179], v[132:135]
    ds_read_b64_tr_b16 a[98:99], v24 offset:25600
    v_mfma_f32_16x16x32_bf16 v[144:147], a[72:75], a[176:179], v[144:147]
    ds_read_b64_tr_b16 a[100:101], v25 offset:24576
    ds_read_b64_tr_b16 a[102:103], v25 offset:25600
    v_mfma_f32_16x16x32_bf16 v[152:155], a[72:75], a[180:183], v[152:155]
    v_mfma_f32_16x16x32_bf16 v[156:159], a[76:79], a[180:183], v[156:159]
    ds_read_b64_tr_b16 a[104:105], v26 offset:24576
    v_mfma_f32_16x16x32_bf16 v[148:151], a[76:79], a[176:179], v[148:151]
    s_waitcnt lgkmcnt(13)
    ds_read_b64_tr_b16 a[106:107], v26 offset:25600
    s_waitcnt lgkmcnt(10)
    v_mfma_f32_16x16x32_bf16 v[160:163], a[80:83], a[176:179], v[160:163]
    ds_read_b64_tr_b16 a[108:109], v27 offset:24576
    ds_read_b64_tr_b16 a[110:111], v27 offset:25600
    v_mfma_f32_16x16x32_bf16 v[168:171], a[80:83], a[180:183], v[168:171]
    v_mfma_f32_16x16x32_bf16 v[172:175], a[84:87], a[180:183], v[172:175]
    ds_read_b64_tr_b16 a[112:113], v28 offset:24576
    v_mfma_f32_16x16x32_bf16 v[164:167], a[84:87], a[176:179], v[164:167]
    ds_read_b64_tr_b16 a[114:115], v28 offset:25600
    s_waitcnt lgkmcnt(10)
    v_mfma_f32_16x16x32_bf16 v[176:179], a[88:91], a[176:179], v[176:179]
    ds_read_b64_tr_b16 a[116:117], v29 offset:24576
    ds_read_b64_tr_b16 a[118:119], v29 offset:25600
    v_mfma_f32_16x16x32_bf16 v[184:187], a[88:91], a[180:183], v[184:187]
    v_mfma_f32_16x16x32_bf16 v[188:191], a[92:95], a[180:183], v[188:191]
    ds_read_b64_tr_b16 a[120:121], v30 offset:24576
    v_mfma_f32_16x16x32_bf16 v[180:183], a[92:95], a[176:179], v[180:183]
    ds_read_b64_tr_b16 a[122:123], v30 offset:25600
    s_waitcnt lgkmcnt(10)
    v_mfma_f32_16x16x32_bf16 v[128:131], a[96:99], a[184:187], v[128:131]
    ds_read_b64_tr_b16 a[124:125], v31 offset:24576
    ds_read_b64_tr_b16 a[126:127], v31 offset:25600
    v_mfma_f32_16x16x32_bf16 v[136:139], a[96:99], a[188:191], v[136:139]
    v_mfma_f32_16x16x32_bf16 v[140:143], a[100:103], a[188:191], v[140:143]
    v_mfma_f32_16x16x32_bf16 v[132:135], a[100:103], a[184:187], v[132:135]
    s_waitcnt lgkmcnt(8)
    v_mfma_f32_16x16x32_bf16 v[144:147], a[104:107], a[184:187], v[144:147]
    v_mfma_f32_16x16x32_bf16 v[152:155], a[104:107], a[188:191], v[152:155]
    v_mfma_f32_16x16x32_bf16 v[156:159], a[108:111], a[188:191], v[156:159]
    s_waitcnt lgkmcnt(0)
    s_barrier
    v_mfma_f32_16x16x32_bf16 v[148:151], a[108:111], a[184:187], v[148:151]
    ds_read_b64_tr_b16 a[64:65], v16 offset:16384
    ds_read_b64_tr_b16 a[66:67], v16 offset:17408
    ds_read_b64_tr_b16 a[68:69], v17 offset:16384
    ds_read_b64_tr_b16 a[70:71], v17 offset:17408
    v_mfma_f32_16x16x32_bf16 v[160:163], a[112:115], a[184:187], v[160:163]
    ds_read_b64_tr_b16 a[72:73], v18 offset:16384
    ds_read_b64_tr_b16 a[74:75], v18 offset:17408
    v_mfma_f32_16x16x32_bf16 v[168:171], a[112:115], a[188:191], v[168:171]
    ds_read_b128 a[192:195], v42 offset:0
    v_mfma_f32_16x16x32_bf16 v[172:175], a[116:119], a[188:191], v[172:175]
    ds_read_b64_tr_b16 a[76:77], v19 offset:16384
    ds_read_b64_tr_b16 a[78:79], v19 offset:17408
    v_mfma_f32_16x16x32_bf16 v[164:167], a[116:119], a[184:187], v[164:167]
    ds_read_b128 a[196:199], v42 offset:2048
    v_mfma_f32_16x16x32_bf16 v[176:179], a[120:123], a[184:187], v[176:179]
    ds_read_b64_tr_b16 a[80:81], v20 offset:16384
    ds_read_b64_tr_b16 a[82:83], v20 offset:17408
    v_mfma_f32_16x16x32_bf16 v[184:187], a[120:123], a[188:191], v[184:187]
    ds_read_b128 a[200:203], v43 offset:0
    v_mfma_f32_16x16x32_bf16 v[188:191], a[124:127], a[188:191], v[188:191]
    ds_read_b64_tr_b16 a[84:85], v21 offset:16384
    ds_read_b128 a[204:207], v43 offset:2048
    v_mfma_f32_16x16x32_bf16 v[180:183], a[124:127], a[184:187], v[180:183]
    s_waitcnt lgkmcnt(13)
    ds_read_b64_tr_b16 a[86:87], v21 offset:17408
    s_waitcnt lgkmcnt(6)
    v_mfma_f32_16x16x32_bf16 v[128:131], a[64:67], a[192:195], v[128:131]
    ds_read_b64_tr_b16 a[88:89], v22 offset:16384
    ds_read_b64_tr_b16 a[90:91], v22 offset:17408
    v_mfma_f32_16x16x32_bf16 v[136:139], a[64:67], a[196:199], v[136:139]
    v_mfma_f32_16x16x32_bf16 v[140:143], a[68:71], a[196:199], v[140:143]
    ds_read_b64_tr_b16 a[92:93], v23 offset:16384
    ds_read_b64_tr_b16 a[94:95], v23 offset:17408
    ds_read_b64_tr_b16 a[96:97], v16 offset:24576
    v_mfma_f32_16x16x32_bf16 v[132:135], a[68:71], a[192:195], v[132:135]
    ds_read_b64_tr_b16 a[98:99], v16 offset:25600
    v_mfma_f32_16x16x32_bf16 v[144:147], a[72:75], a[192:195], v[144:147]
    ds_read_b64_tr_b16 a[100:101], v17 offset:24576
    ds_read_b64_tr_b16 a[102:103], v17 offset:25600
    v_mfma_f32_16x16x32_bf16 v[152:155], a[72:75], a[196:199], v[152:155]
    v_mfma_f32_16x16x32_bf16 v[156:159], a[76:79], a[196:199], v[156:159]
    ds_read_b64_tr_b16 a[104:105], v18 offset:24576
    v_mfma_f32_16x16x32_bf16 v[148:151], a[76:79], a[192:195], v[148:151]
    s_waitcnt lgkmcnt(13)
    ds_read_b64_tr_b16 a[106:107], v18 offset:25600
    s_waitcnt lgkmcnt(10)
    v_mfma_f32_16x16x32_bf16 v[160:163], a[80:83], a[192:195], v[160:163]
    ds_read_b64_tr_b16 a[108:109], v19 offset:24576
    ds_read_b64_tr_b16 a[110:111], v19 offset:25600
    v_mfma_f32_16x16x32_bf16 v[168:171], a[80:83], a[196:199], v[168:171]
    v_mfma_f32_16x16x32_bf16 v[172:175], a[84:87], a[196:199], v[172:175]
    ds_read_b64_tr_b16 a[112:113], v20 offset:24576
    v_mfma_f32_16x16x32_bf16 v[164:167], a[84:87], a[192:195], v[164:167]
    ds_read_b64_tr_b16 a[114:115], v20 offset:25600
    s_waitcnt lgkmcnt(10)
    v_mfma_f32_16x16x32_bf16 v[176:179], a[88:91], a[192:195], v[176:179]
    ds_read_b64_tr_b16 a[116:117], v21 offset:24576
    ds_read_b64_tr_b16 a[118:119], v21 offset:25600
    v_mfma_f32_16x16x32_bf16 v[184:187], a[88:91], a[196:199], v[184:187]
    v_mfma_f32_16x16x32_bf16 v[188:191], a[92:95], a[196:199], v[188:191]
    ds_read_b64_tr_b16 a[120:121], v22 offset:24576
    v_mfma_f32_16x16x32_bf16 v[180:183], a[92:95], a[192:195], v[180:183]
    ds_read_b64_tr_b16 a[122:123], v22 offset:25600
    s_waitcnt lgkmcnt(10)
    v_mfma_f32_16x16x32_bf16 v[128:131], a[96:99], a[200:203], v[128:131]
    ds_read_b64_tr_b16 a[124:125], v23 offset:24576
    ds_read_b64_tr_b16 a[126:127], v23 offset:25600
    v_mfma_f32_16x16x32_bf16 v[136:139], a[96:99], a[204:207], v[136:139]
    v_mfma_f32_16x16x32_bf16 v[140:143], a[100:103], a[204:207], v[140:143]
    v_mfma_f32_16x16x32_bf16 v[132:135], a[100:103], a[200:203], v[132:135]
    s_waitcnt lgkmcnt(8)
    v_mfma_f32_16x16x32_bf16 v[144:147], a[104:107], a[200:203], v[144:147]
    v_mfma_f32_16x16x32_bf16 v[152:155], a[104:107], a[204:207], v[152:155]
    v_mfma_f32_16x16x32_bf16 v[156:159], a[108:111], a[204:207], v[156:159]
    s_waitcnt lgkmcnt(0)
    s_barrier
    v_mfma_f32_16x16x32_bf16 v[148:151], a[108:111], a[200:203], v[148:151]
    ds_read_b64_tr_b16 a[64:65], v16 offset:49152
    ds_read_b64_tr_b16 a[66:67], v16 offset:50176
    ds_read_b64_tr_b16 a[68:69], v17 offset:49152
    ds_read_b64_tr_b16 a[70:71], v17 offset:50176
    v_mfma_f32_16x16x32_bf16 v[160:163], a[112:115], a[200:203], v[160:163]
    ds_read_b64_tr_b16 a[72:73], v18 offset:49152
    ds_read_b64_tr_b16 a[74:75], v18 offset:50176
    v_mfma_f32_16x16x32_bf16 v[168:171], a[112:115], a[204:207], v[168:171]
    ds_read_b128 a[208:211], v42 offset:4096
    v_mfma_f32_16x16x32_bf16 v[172:175], a[116:119], a[204:207], v[172:175]
    ds_read_b64_tr_b16 a[76:77], v19 offset:49152
    ds_read_b64_tr_b16 a[78:79], v19 offset:50176
    v_mfma_f32_16x16x32_bf16 v[164:167], a[116:119], a[200:203], v[164:167]
    ds_read_b128 a[212:215], v42 offset:6144
    v_mfma_f32_16x16x32_bf16 v[176:179], a[120:123], a[200:203], v[176:179]
    ds_read_b64_tr_b16 a[80:81], v20 offset:49152
    ds_read_b64_tr_b16 a[82:83], v20 offset:50176
    v_mfma_f32_16x16x32_bf16 v[184:187], a[120:123], a[204:207], v[184:187]
    ds_read_b128 a[216:219], v43 offset:4096
    v_mfma_f32_16x16x32_bf16 v[188:191], a[124:127], a[204:207], v[188:191]
    ds_read_b64_tr_b16 a[84:85], v21 offset:49152
    ds_read_b128 a[220:223], v43 offset:6144
    v_mfma_f32_16x16x32_bf16 v[180:183], a[124:127], a[200:203], v[180:183]
    s_waitcnt lgkmcnt(13)
    ds_read_b64_tr_b16 a[86:87], v21 offset:50176
    s_waitcnt lgkmcnt(6)
    v_mfma_f32_16x16x32_bf16 v[128:131], a[64:67], a[208:211], v[128:131]
    ds_read_b64_tr_b16 a[88:89], v22 offset:49152
    ds_read_b64_tr_b16 a[90:91], v22 offset:50176
    v_mfma_f32_16x16x32_bf16 v[136:139], a[64:67], a[212:215], v[136:139]
    v_mfma_f32_16x16x32_bf16 v[140:143], a[68:71], a[212:215], v[140:143]
    ds_read_b64_tr_b16 a[92:93], v23 offset:49152
    ds_read_b64_tr_b16 a[94:95], v23 offset:50176
    ds_read_b64_tr_b16 a[96:97], v16 offset:57344
    v_mfma_f32_16x16x32_bf16 v[132:135], a[68:71], a[208:211], v[132:135]
    ds_read_b64_tr_b16 a[98:99], v16 offset:58368
    v_mfma_f32_16x16x32_bf16 v[144:147], a[72:75], a[208:211], v[144:147]
    ds_read_b64_tr_b16 a[100:101], v17 offset:57344
    ds_read_b64_tr_b16 a[102:103], v17 offset:58368
    v_mfma_f32_16x16x32_bf16 v[152:155], a[72:75], a[212:215], v[152:155]
    v_mfma_f32_16x16x32_bf16 v[156:159], a[76:79], a[212:215], v[156:159]
    ds_read_b64_tr_b16 a[104:105], v18 offset:57344
    v_mfma_f32_16x16x32_bf16 v[148:151], a[76:79], a[208:211], v[148:151]
    s_waitcnt lgkmcnt(13)
    ds_read_b64_tr_b16 a[106:107], v18 offset:58368
    s_waitcnt lgkmcnt(10)
    v_mfma_f32_16x16x32_bf16 v[160:163], a[80:83], a[208:211], v[160:163]
    ds_read_b64_tr_b16 a[108:109], v19 offset:57344
    ds_read_b64_tr_b16 a[110:111], v19 offset:58368
    v_mfma_f32_16x16x32_bf16 v[168:171], a[80:83], a[212:215], v[168:171]
    v_mfma_f32_16x16x32_bf16 v[172:175], a[84:87], a[212:215], v[172:175]
    ds_read_b64_tr_b16 a[112:113], v20 offset:57344
    v_mfma_f32_16x16x32_bf16 v[164:167], a[84:87], a[208:211], v[164:167]
    ds_read_b64_tr_b16 a[114:115], v20 offset:58368
    s_waitcnt lgkmcnt(10)
    v_mfma_f32_16x16x32_bf16 v[176:179], a[88:91], a[208:211], v[176:179]
    ds_read_b64_tr_b16 a[116:117], v21 offset:57344
    ds_read_b64_tr_b16 a[118:119], v21 offset:58368
    v_mfma_f32_16x16x32_bf16 v[184:187], a[88:91], a[212:215], v[184:187]
    v_mfma_f32_16x16x32_bf16 v[188:191], a[92:95], a[212:215], v[188:191]
    ds_read_b64_tr_b16 a[120:121], v22 offset:57344
    v_mfma_f32_16x16x32_bf16 v[180:183], a[92:95], a[208:211], v[180:183]
    ds_read_b64_tr_b16 a[122:123], v22 offset:58368
    s_waitcnt lgkmcnt(10)
    v_mfma_f32_16x16x32_bf16 v[128:131], a[96:99], a[216:219], v[128:131]
    ds_read_b64_tr_b16 a[124:125], v23 offset:57344
    ds_read_b64_tr_b16 a[126:127], v23 offset:58368
    v_mfma_f32_16x16x32_bf16 v[136:139], a[96:99], a[220:223], v[136:139]
    v_mfma_f32_16x16x32_bf16 v[140:143], a[100:103], a[220:223], v[140:143]
    v_mfma_f32_16x16x32_bf16 v[132:135], a[100:103], a[216:219], v[132:135]
    s_waitcnt lgkmcnt(8)
    v_mfma_f32_16x16x32_bf16 v[144:147], a[104:107], a[216:219], v[144:147]
    v_mfma_f32_16x16x32_bf16 v[152:155], a[104:107], a[220:223], v[152:155]
    v_mfma_f32_16x16x32_bf16 v[156:159], a[108:111], a[220:223], v[156:159]
    s_waitcnt lgkmcnt(0)
    s_barrier
    v_mfma_f32_16x16x32_bf16 v[148:151], a[108:111], a[216:219], v[148:151]
    ds_read_b64_tr_b16 a[64:65], v32 offset:16384
    ds_read_b64_tr_b16 a[66:67], v32 offset:17408
    ds_read_b64_tr_b16 a[68:69], v32 offset:24576
    ds_read_b64_tr_b16 a[70:71], v32 offset:25600
    v_mfma_f32_16x16x32_bf16 v[160:163], a[112:115], a[216:219], v[160:163]
    ds_read_b64_tr_b16 a[72:73], v33 offset:16384
    ds_read_b64_tr_b16 a[74:75], v33 offset:17408
    v_mfma_f32_16x16x32_bf16 v[168:171], a[112:115], a[220:223], v[168:171]
    ds_read_b128 a[224:227], v42 offset:8192
    v_mfma_f32_16x16x32_bf16 v[172:175], a[116:119], a[220:223], v[172:175]
    ds_read_b64_tr_b16 a[76:77], v33 offset:24576
    ds_read_b64_tr_b16 a[78:79], v33 offset:25600
    v_mfma_f32_16x16x32_bf16 v[164:167], a[116:119], a[216:219], v[164:167]
    ds_read_b128 a[228:231], v42 offset:10240
    v_mfma_f32_16x16x32_bf16 v[176:179], a[120:123], a[216:219], v[176:179]
    ds_read_b64_tr_b16 a[80:81], v34 offset:16384
    ds_read_b64_tr_b16 a[82:83], v34 offset:17408
    v_mfma_f32_16x16x32_bf16 v[184:187], a[120:123], a[220:223], v[184:187]
    ds_read_b128 a[232:235], v43 offset:8192
    v_mfma_f32_16x16x32_bf16 v[188:191], a[124:127], a[220:223], v[188:191]
    ds_read_b64_tr_b16 a[84:85], v34 offset:24576
    ds_read_b128 a[236:239], v43 offset:10240
    v_mfma_f32_16x16x32_bf16 v[180:183], a[124:127], a[216:219], v[180:183]
    s_waitcnt lgkmcnt(13)
    ds_read_b64_tr_b16 a[86:87], v34 offset:25600
    s_waitcnt lgkmcnt(1)
    v_mfma_f32_16x16x32_bf16 v[128:131], a[64:67], a[224:227], v[128:131]
    ds_read_b64_tr_b16 a[88:89], v35 offset:16384
    ds_read_b64_tr_b16 a[90:91], v35 offset:17408
    v_mfma_f32_16x16x32_bf16 v[136:139], a[64:67], a[228:231], v[136:139]
    v_mfma_f32_16x16x32_bf16 v[136:139], a[68:71], a[236:239], v[136:139]
    ds_read_b64_tr_b16 a[92:93], v35 offset:24576
    ds_read_b64_tr_b16 a[94:95], v35 offset:25600
    ds_read_b64_tr_b16 a[96:97], v36 offset:16384
    v_mfma_f32_16x16x32_bf16 v[128:131], a[68:71], a[232:235], v[128:131]
    ds_read_b64_tr_b16 a[98:99], v36 offset:17408
    v_mfma_f32_16x16x32_bf16 v[132:135], a[72:75], a[224:227], v[132:135]
    ds_read_b64_tr_b16 a[100:101], v36 offset:24576
    ds_read_b64_tr_b16 a[102:103], v36 offset:25600
    v_mfma_f32_16x16x32_bf16 v[140:143], a[72:75], a[228:231], v[140:143]
    v_mfma_f32_16x16x32_bf16 v[140:143], a[76:79], a[236:239], v[140:143]
    ds_read_b64_tr_b16 a[104:105], v37 offset:16384
    v_mfma_f32_16x16x32_bf16 v[132:135], a[76:79], a[232:235], v[132:135]
    ds_read_b64_tr_b16 a[106:107], v37 offset:17408
    v_mul_f32 v128, s60, v128
    s_waitcnt lgkmcnt(10)
    v_mfma_f32_16x16x32_bf16 v[144:147], a[80:83], a[224:227], v[144:147]
    ds_read_b64_tr_b16 a[108:109], v37 offset:24576
    ds_read_b64_tr_b16 a[110:111], v37 offset:25600
    v_mul_f32 v136, s60, v136
    v_mfma_f32_16x16x32_bf16 v[152:155], a[80:83], a[228:231], v[152:155]
    v_mul_f32 v129, s60, v129
    v_mul_f32 v137, s60, v137
    v_cvt_pk_bf16_f32 v48, v128, v129
    v_mfma_f32_16x16x32_bf16 v[152:155], a[84:87], a[236:239], v[152:155]
    ds_read_b64_tr_b16 a[112:113], v38 offset:16384
    v_cvt_pk_bf16_f32 v52, v136, v137
    v_mul_f32 v130, s60, v130
    v_mfma_f32_16x16x32_bf16 v[144:147], a[84:87], a[232:235], v[144:147]
    ds_read_b64_tr_b16 a[114:115], v38 offset:17408
    v_mul_f32 v138, s60, v138
    s_waitcnt lgkmcnt(10)
    v_mfma_f32_16x16x32_bf16 v[148:151], a[88:91], a[224:227], v[148:151]
    ds_read_b64_tr_b16 a[116:117], v38 offset:24576
    ds_read_b64_tr_b16 a[118:119], v38 offset:25600
    v_mul_f32 v131, s60, v131
    v_mfma_f32_16x16x32_bf16 v[156:159], a[88:91], a[228:231], v[156:159]
    v_mul_f32 v139, s60, v139
    v_cvt_pk_bf16_f32 v49, v130, v131
    v_cvt_pk_bf16_f32 v53, v138, v139
    v_mfma_f32_16x16x32_bf16 v[156:159], a[92:95], a[236:239], v[156:159]
    ds_read_b64_tr_b16 a[120:121], v39 offset:16384
    v_mul_f32 v132, s60, v132
    v_mul_f32 v140, s60, v140
    v_mfma_f32_16x16x32_bf16 v[148:151], a[92:95], a[232:235], v[148:151]
    ds_read_b64_tr_b16 a[122:123], v39 offset:17408
    v_mul_f32 v133, s60, v133
    s_waitcnt lgkmcnt(10)
    v_mfma_f32_16x16x32_bf16 v[160:163], a[96:99], a[224:227], v[160:163]
    ds_read_b64_tr_b16 a[124:125], v39 offset:24576
    ds_read_b64_tr_b16 a[126:127], v39 offset:25600
    v_mfma_f32_16x16x32_bf16 v[168:171], a[96:99], a[228:231], v[168:171]
    v_mul_f32 v141, s60, v141
    v_cvt_pk_bf16_f32 v50, v132, v133
    v_mfma_f32_16x16x32_bf16 v[168:171], a[100:103], a[236:239], v[168:171]
    v_cvt_pk_bf16_f32 v54, v140, v141
    v_mul_f32 v134, s60, v134
    v_mfma_f32_16x16x32_bf16 v[160:163], a[100:103], a[232:235], v[160:163]
    v_mul_f32 v142, s60, v142
    s_waitcnt lgkmcnt(8)
    v_mfma_f32_16x16x32_bf16 v[164:167], a[104:107], a[224:227], v[164:167]
    v_permlane32_swap_b32 v48, v50
    v_mfma_f32_16x16x32_bf16 v[172:175], a[104:107], a[228:231], v[172:175]
    v_permlane32_swap_b32 v52, v54
    v_mfma_f32_16x16x32_bf16 v[172:175], a[108:111], a[236:239], v[172:175]
    s_waitcnt lgkmcnt(0)
    s_barrier
    v_mfma_f32_16x16x32_bf16 v[164:167], a[108:111], a[232:235], v[164:167]
    ds_read_b64_tr_b16 a[64:65], v16 offset:32768
    ds_read_b64_tr_b16 a[66:67], v16 offset:33792
    ds_read_b64_tr_b16 a[68:69], v17 offset:32768
    ds_read_b64_tr_b16 a[70:71], v17 offset:33792
    v_mfma_f32_16x16x32_bf16 v[176:179], a[112:115], a[224:227], v[176:179]
    ds_read_b64_tr_b16 a[72:73], v18 offset:32768
    ds_read_b64_tr_b16 a[74:75], v18 offset:33792
    v_mfma_f32_16x16x32_bf16 v[184:187], a[112:115], a[228:231], v[184:187]
    v_permlane16_swap_b32 v48, v50
    v_mfma_f32_16x16x32_bf16 v[184:187], a[116:119], a[236:239], v[184:187]
    ds_read_b64_tr_b16 a[76:77], v19 offset:32768
    ds_read_b64_tr_b16 a[78:79], v19 offset:33792
    v_mfma_f32_16x16x32_bf16 v[176:179], a[116:119], a[232:235], v[176:179]
    v_permlane16_swap_b32 v52, v54
    v_mfma_f32_16x16x32_bf16 v[180:183], a[120:123], a[224:227], v[180:183]
    ds_read_b64_tr_b16 a[80:81], v20 offset:32768
    ds_read_b64_tr_b16 a[82:83], v20 offset:33792
    v_mfma_f32_16x16x32_bf16 v[188:191], a[120:123], a[228:231], v[188:191]
    v_mul_f32 v135, s60, v135
    v_mul_f32 v143, s60, v143
    v_mfma_f32_16x16x32_bf16 v[188:191], a[124:127], a[236:239], v[188:191]
    ds_read_b64_tr_b16 a[84:85], v21 offset:32768
    v_cvt_pk_bf16_f32 v51, v134, v135
    v_mfma_f32_16x16x32_bf16 v[180:183], a[124:127], a[232:235], v[180:183]
    ds_read_b64_tr_b16 a[86:87], v21 offset:33792
    s_waitcnt lgkmcnt(8)
    v_mfma_f32_16x16x32_bf16 v[192:195], a[64:67], a[128:131], 0
    ds_read_b64_tr_b16 a[88:89], v22 offset:32768
    ds_read_b64_tr_b16 a[90:91], v22 offset:33792
    v_mfma_f32_16x16x32_bf16 v[200:203], a[64:67], a[132:135], 0
    v_permlane32_swap_b32 v49, v51
    v_mfma_f32_16x16x32_bf16 v[204:207], a[68:71], a[132:135], 0
    ds_read_b64_tr_b16 a[92:93], v23 offset:32768
    ds_read_b64_tr_b16 a[94:95], v23 offset:33792
    ds_read_b64_tr_b16 a[96:97], v16 offset:40960
    v_mfma_f32_16x16x32_bf16 v[196:199], a[68:71], a[128:131], 0
    ds_read_b64_tr_b16 a[98:99], v16 offset:41984
    s_waitcnt lgkmcnt(10)
    v_mfma_f32_16x16x32_bf16 v[208:211], a[72:75], a[128:131], 0
    ds_read_b64_tr_b16 a[100:101], v17 offset:40960
    ds_read_b64_tr_b16 a[102:103], v17 offset:41984
    v_mfma_f32_16x16x32_bf16 v[216:219], a[72:75], a[132:135], 0
    v_permlane16_swap_b32 v49, v51
    v_mfma_f32_16x16x32_bf16 v[220:223], a[76:79], a[132:135], 0
    ds_read_b64_tr_b16 a[104:105], v18 offset:40960
    v_cvt_pk_bf16_f32 v55, v142, v143
    v_mfma_f32_16x16x32_bf16 v[212:215], a[76:79], a[128:131], 0
    ds_read_b64_tr_b16 a[106:107], v18 offset:41984
    s_waitcnt lgkmcnt(10)
    v_mfma_f32_16x16x32_bf16 v[224:227], a[80:83], a[128:131], 0
    ds_read_b64_tr_b16 a[108:109], v19 offset:40960
    ds_read_b64_tr_b16 a[110:111], v19 offset:41984
    v_mfma_f32_16x16x32_bf16 v[232:235], a[80:83], a[132:135], 0
    v_permlane32_swap_b32 v53, v55
    v_mfma_f32_16x16x32_bf16 v[236:239], a[84:87], a[132:135], 0
    ds_read_b64_tr_b16 a[112:113], v20 offset:40960
    v_accvgpr_write_b32 a0, v48
    v_mfma_f32_16x16x32_bf16 v[228:231], a[84:87], a[128:131], 0
    ds_read_b64_tr_b16 a[114:115], v20 offset:41984
    s_waitcnt lgkmcnt(10)
    v_mfma_f32_16x16x32_bf16 v[240:243], a[88:91], a[128:131], 0
    ds_read_b64_tr_b16 a[116:117], v21 offset:40960
    ds_read_b64_tr_b16 a[118:119], v21 offset:41984
    v_mfma_f32_16x16x32_bf16 v[248:251], a[88:91], a[132:135], 0
    v_permlane16_swap_b32 v53, v55
    v_mfma_f32_16x16x32_bf16 v[252:255], a[92:95], a[132:135], 0
    ds_read_b64_tr_b16 a[120:121], v22 offset:40960
    v_accvgpr_write_b32 a4, v52
    v_mfma_f32_16x16x32_bf16 v[244:247], a[92:95], a[128:131], 0
    ds_read_b64_tr_b16 a[122:123], v22 offset:41984
    s_waitcnt lgkmcnt(10)
    v_mfma_f32_16x16x32_bf16 v[192:195], a[96:99], a[136:139], v[192:195]
    ds_read_b64_tr_b16 a[124:125], v23 offset:40960
    ds_read_b64_tr_b16 a[126:127], v23 offset:41984
    v_mfma_f32_16x16x32_bf16 v[200:203], a[96:99], a[140:143], v[200:203]
    v_accvgpr_write_b32 a1, v49
    v_accvgpr_write_b32 a5, v53
    v_mfma_f32_16x16x32_bf16 v[204:207], a[100:103], a[140:143], v[204:207]
    v_accvgpr_write_b32 a2, v50
    v_accvgpr_write_b32 a6, v54
    v_mfma_f32_16x16x32_bf16 v[196:199], a[100:103], a[136:139], v[196:199]
    v_accvgpr_write_b32 a3, v51
    s_waitcnt lgkmcnt(8)
    v_mfma_f32_16x16x32_bf16 v[208:211], a[104:107], a[136:139], v[208:211]
    v_accvgpr_write_b32 a7, v55
    v_mul_f32 v144, s60, v144
    v_mfma_f32_16x16x32_bf16 v[216:219], a[104:107], a[140:143], v[216:219]
    v_mul_f32 v152, s60, v152
    v_mul_f32 v145, s60, v145
    v_mfma_f32_16x16x32_bf16 v[220:223], a[108:111], a[140:143], v[220:223]
    s_waitcnt lgkmcnt(0)
    s_barrier
    v_mfma_f32_16x16x32_bf16 v[212:215], a[108:111], a[136:139], v[212:215]
    ds_read_b64_tr_b16 a[64:65], v24 offset:0
    ds_read_b64_tr_b16 a[66:67], v24 offset:1024
    ds_read_b64_tr_b16 a[68:69], v25 offset:0
    ds_read_b64_tr_b16 a[70:71], v25 offset:1024
    v_mfma_f32_16x16x32_bf16 v[224:227], a[112:115], a[136:139], v[224:227]
    ds_read_b64_tr_b16 a[72:73], v26 offset:0
    ds_read_b64_tr_b16 a[74:75], v26 offset:1024
    v_mfma_f32_16x16x32_bf16 v[232:235], a[112:115], a[140:143], v[232:235]
    v_mul_f32 v153, s60, v153
    v_cvt_pk_bf16_f32 v56, v144, v145
    v_mfma_f32_16x16x32_bf16 v[236:239], a[116:119], a[140:143], v[236:239]
    ds_read_b64_tr_b16 a[76:77], v27 offset:0
    ds_read_b64_tr_b16 a[78:79], v27 offset:1024
    v_mfma_f32_16x16x32_bf16 v[228:231], a[116:119], a[136:139], v[228:231]
    v_cvt_pk_bf16_f32 v60, v152, v153
    v_mul_f32 v146, s60, v146
    v_mfma_f32_16x16x32_bf16 v[240:243], a[120:123], a[136:139], v[240:243]
    ds_read_b64_tr_b16 a[80:81], v28 offset:0
    ds_read_b64_tr_b16 a[82:83], v28 offset:1024
    v_mfma_f32_16x16x32_bf16 v[248:251], a[120:123], a[140:143], v[248:251]
    v_mul_f32 v154, s60, v154
    v_mul_f32 v147, s60, v147
    v_mfma_f32_16x16x32_bf16 v[252:255], a[124:127], a[140:143], v[252:255]
    ds_read_b64_tr_b16 a[84:85], v29 offset:0
    v_mul_f32 v155, s60, v155
    v_mfma_f32_16x16x32_bf16 v[244:247], a[124:127], a[136:139], v[244:247]
    ds_read_b64_tr_b16 a[86:87], v29 offset:1024
    s_waitcnt lgkmcnt(8)
    v_mfma_f32_16x16x32_bf16 v[192:195], a[64:67], a[144:147], v[192:195]
    ds_read_b64_tr_b16 a[88:89], v30 offset:0
    ds_read_b64_tr_b16 a[90:91], v30 offset:1024
    v_mfma_f32_16x16x32_bf16 v[200:203], a[64:67], a[148:151], v[200:203]
    v_cvt_pk_bf16_f32 v57, v146, v147
    v_cvt_pk_bf16_f32 v61, v154, v155
    v_mfma_f32_16x16x32_bf16 v[204:207], a[68:71], a[148:151], v[204:207]
    ds_read_b64_tr_b16 a[92:93], v31 offset:0
    ds_read_b64_tr_b16 a[94:95], v31 offset:1024
    ds_read_b64_tr_b16 a[96:97], v24 offset:8192
    v_mfma_f32_16x16x32_bf16 v[196:199], a[68:71], a[144:147], v[196:199]
    ds_read_b64_tr_b16 a[98:99], v24 offset:9216
    s_waitcnt lgkmcnt(10)
    v_mfma_f32_16x16x32_bf16 v[208:211], a[72:75], a[144:147], v[208:211]
    ds_read_b64_tr_b16 a[100:101], v25 offset:8192
    ds_read_b64_tr_b16 a[102:103], v25 offset:9216
    v_mfma_f32_16x16x32_bf16 v[216:219], a[72:75], a[148:151], v[216:219]
    v_mul_f32 v148, s60, v148
    v_mul_f32 v156, s60, v156
    v_mfma_f32_16x16x32_bf16 v[220:223], a[76:79], a[148:151], v[220:223]
    ds_read_b64_tr_b16 a[104:105], v26 offset:8192
    v_mul_f32 v149, s60, v149
    v_mfma_f32_16x16x32_bf16 v[212:215], a[76:79], a[144:147], v[212:215]
    ds_read_b64_tr_b16 a[106:107], v26 offset:9216
    s_waitcnt lgkmcnt(10)
    v_mfma_f32_16x16x32_bf16 v[224:227], a[80:83], a[144:147], v[224:227]
    ds_read_b64_tr_b16 a[108:109], v27 offset:8192
    ds_read_b64_tr_b16 a[110:111], v27 offset:9216
    v_mfma_f32_16x16x32_bf16 v[232:235], a[80:83], a[148:151], v[232:235]
    v_mul_f32 v157, s60, v157
    v_cvt_pk_bf16_f32 v58, v148, v149
    v_mfma_f32_16x16x32_bf16 v[236:239], a[84:87], a[148:151], v[236:239]
    ds_read_b64_tr_b16 a[112:113], v28 offset:8192
    v_cvt_pk_bf16_f32 v62, v156, v157
    v_mfma_f32_16x16x32_bf16 v[228:231], a[84:87], a[144:147], v[228:231]
    ds_read_b64_tr_b16 a[114:115], v28 offset:9216
    s_waitcnt lgkmcnt(10)
    v_mfma_f32_16x16x32_bf16 v[240:243], a[88:91], a[144:147], v[240:243]
    ds_read_b64_tr_b16 a[116:117], v29 offset:8192
    ds_read_b64_tr_b16 a[118:119], v29 offset:9216
    v_mfma_f32_16x16x32_bf16 v[248:251], a[88:91], a[148:151], v[248:251]
    v_permlane32_swap_b32 v56, v58
    v_mfma_f32_16x16x32_bf16 v[252:255], a[92:95], a[148:151], v[252:255]
    ds_read_b64_tr_b16 a[120:121], v30 offset:8192
    v_mul_f32 v150, s60, v150
    v_mfma_f32_16x16x32_bf16 v[244:247], a[92:95], a[144:147], v[244:247]
    ds_read_b64_tr_b16 a[122:123], v30 offset:9216
    s_waitcnt lgkmcnt(10)
    v_mfma_f32_16x16x32_bf16 v[192:195], a[96:99], a[152:155], v[192:195]
    ds_read_b64_tr_b16 a[124:125], v31 offset:8192
    ds_read_b64_tr_b16 a[126:127], v31 offset:9216
    v_mfma_f32_16x16x32_bf16 v[200:203], a[96:99], a[156:159], v[200:203]
    v_permlane32_swap_b32 v60, v62
    v_mfma_f32_16x16x32_bf16 v[204:207], a[100:103], a[156:159], v[204:207]
    v_permlane16_swap_b32 v56, v58
    v_mfma_f32_16x16x32_bf16 v[196:199], a[100:103], a[152:155], v[196:199]
    v_mul_f32 v158, s60, v158
    s_waitcnt lgkmcnt(8)
    v_mfma_f32_16x16x32_bf16 v[208:211], a[104:107], a[152:155], v[208:211]
    v_permlane16_swap_b32 v60, v62
    v_mfma_f32_16x16x32_bf16 v[216:219], a[104:107], a[156:159], v[216:219]
    v_mul_f32 v151, s60, v151
    v_mul_f32 v159, s60, v159
    v_mfma_f32_16x16x32_bf16 v[220:223], a[108:111], a[156:159], v[220:223]
    s_waitcnt lgkmcnt(0)
    s_barrier
    v_mfma_f32_16x16x32_bf16 v[212:215], a[108:111], a[152:155], v[212:215]
    ds_read_b64_tr_b16 a[64:65], v16 offset:0
    ds_read_b64_tr_b16 a[66:67], v16 offset:1024
    ds_read_b64_tr_b16 a[68:69], v17 offset:0
    ds_read_b64_tr_b16 a[70:71], v17 offset:1024
    v_mfma_f32_16x16x32_bf16 v[224:227], a[112:115], a[152:155], v[224:227]
    ds_read_b64_tr_b16 a[72:73], v18 offset:0
    ds_read_b64_tr_b16 a[74:75], v18 offset:1024
    v_mfma_f32_16x16x32_bf16 v[232:235], a[112:115], a[156:159], v[232:235]
    v_cvt_pk_bf16_f32 v59, v150, v151
    v_cvt_pk_bf16_f32 v63, v158, v159
    v_mfma_f32_16x16x32_bf16 v[236:239], a[116:119], a[156:159], v[236:239]
    ds_read_b64_tr_b16 a[76:77], v19 offset:0
    ds_read_b64_tr_b16 a[78:79], v19 offset:1024
    v_mfma_f32_16x16x32_bf16 v[228:231], a[116:119], a[152:155], v[228:231]
    v_permlane32_swap_b32 v57, v59
    v_mfma_f32_16x16x32_bf16 v[240:243], a[120:123], a[152:155], v[240:243]
    ds_read_b64_tr_b16 a[80:81], v20 offset:0
    ds_read_b64_tr_b16 a[82:83], v20 offset:1024
    v_mfma_f32_16x16x32_bf16 v[248:251], a[120:123], a[156:159], v[248:251]
    v_permlane32_swap_b32 v61, v63
    v_mfma_f32_16x16x32_bf16 v[252:255], a[124:127], a[156:159], v[252:255]
    ds_read_b64_tr_b16 a[84:85], v21 offset:0
    v_accvgpr_write_b32 a8, v56
    v_mfma_f32_16x16x32_bf16 v[244:247], a[124:127], a[152:155], v[244:247]
    ds_read_b64_tr_b16 a[86:87], v21 offset:1024
    s_waitcnt lgkmcnt(8)
    v_mfma_f32_16x16x32_bf16 v[192:195], a[64:67], a[160:163], v[192:195]
    ds_read_b64_tr_b16 a[88:89], v22 offset:0
    ds_read_b64_tr_b16 a[90:91], v22 offset:1024
    v_mfma_f32_16x16x32_bf16 v[200:203], a[64:67], a[164:167], v[200:203]
    v_permlane16_swap_b32 v57, v59
    v_mfma_f32_16x16x32_bf16 v[204:207], a[68:71], a[164:167], v[204:207]
    ds_read_b64_tr_b16 a[92:93], v23 offset:0
    ds_read_b64_tr_b16 a[94:95], v23 offset:1024
    ds_read_b64_tr_b16 a[96:97], v16 offset:8192
    v_mfma_f32_16x16x32_bf16 v[196:199], a[68:71], a[160:163], v[196:199]
    ds_read_b64_tr_b16 a[98:99], v16 offset:9216
    s_waitcnt lgkmcnt(10)
    v_mfma_f32_16x16x32_bf16 v[208:211], a[72:75], a[160:163], v[208:211]
    ds_read_b64_tr_b16 a[100:101], v17 offset:8192
    ds_read_b64_tr_b16 a[102:103], v17 offset:9216
    v_mfma_f32_16x16x32_bf16 v[216:219], a[72:75], a[164:167], v[216:219]
    v_permlane16_swap_b32 v61, v63
    v_mfma_f32_16x16x32_bf16 v[220:223], a[76:79], a[164:167], v[220:223]
    ds_read_b64_tr_b16 a[104:105], v18 offset:8192
    v_accvgpr_write_b32 a12, v60
    v_mfma_f32_16x16x32_bf16 v[212:215], a[76:79], a[160:163], v[212:215]
    ds_read_b64_tr_b16 a[106:107], v18 offset:9216
    s_waitcnt lgkmcnt(10)
    v_mfma_f32_16x16x32_bf16 v[224:227], a[80:83], a[160:163], v[224:227]
    ds_read_b64_tr_b16 a[108:109], v19 offset:8192
    ds_read_b64_tr_b16 a[110:111], v19 offset:9216
    v_mfma_f32_16x16x32_bf16 v[232:235], a[80:83], a[164:167], v[232:235]
    v_accvgpr_write_b32 a9, v57
    v_accvgpr_write_b32 a13, v61
    v_mfma_f32_16x16x32_bf16 v[236:239], a[84:87], a[164:167], v[236:239]
    ds_read_b64_tr_b16 a[112:113], v20 offset:8192
    v_accvgpr_write_b32 a10, v58
    v_mfma_f32_16x16x32_bf16 v[228:231], a[84:87], a[160:163], v[228:231]
    ds_read_b64_tr_b16 a[114:115], v20 offset:9216
    s_waitcnt lgkmcnt(10)
    v_mfma_f32_16x16x32_bf16 v[240:243], a[88:91], a[160:163], v[240:243]
    ds_read_b64_tr_b16 a[116:117], v21 offset:8192
    ds_read_b64_tr_b16 a[118:119], v21 offset:9216
    v_mfma_f32_16x16x32_bf16 v[248:251], a[88:91], a[164:167], v[248:251]
    v_accvgpr_write_b32 a14, v62
    v_accvgpr_write_b32 a11, v59
    v_mfma_f32_16x16x32_bf16 v[252:255], a[92:95], a[164:167], v[252:255]
    ds_read_b64_tr_b16 a[120:121], v22 offset:8192
    v_accvgpr_write_b32 a15, v63
    v_mfma_f32_16x16x32_bf16 v[244:247], a[92:95], a[160:163], v[244:247]
    ds_read_b64_tr_b16 a[122:123], v22 offset:9216
    s_waitcnt lgkmcnt(10)
    v_mfma_f32_16x16x32_bf16 v[192:195], a[96:99], a[168:171], v[192:195]
    ds_read_b64_tr_b16 a[124:125], v23 offset:8192
    ds_read_b64_tr_b16 a[126:127], v23 offset:9216
    v_mfma_f32_16x16x32_bf16 v[200:203], a[96:99], a[172:175], v[200:203]
    v_mul_f32 v160, s60, v160
    v_mul_f32 v168, s60, v168
    v_mfma_f32_16x16x32_bf16 v[204:207], a[100:103], a[172:175], v[204:207]
    v_mul_f32 v161, s60, v161
    v_mul_f32 v169, s60, v169
    v_mfma_f32_16x16x32_bf16 v[196:199], a[100:103], a[168:171], v[196:199]
    v_cvt_pk_bf16_f32 v48, v160, v161
    s_waitcnt lgkmcnt(8)
    v_mfma_f32_16x16x32_bf16 v[208:211], a[104:107], a[168:171], v[208:211]
    v_cvt_pk_bf16_f32 v52, v168, v169
    v_mul_f32 v162, s60, v162
    v_mfma_f32_16x16x32_bf16 v[216:219], a[104:107], a[172:175], v[216:219]
    v_mul_f32 v170, s60, v170
    v_mul_f32 v163, s60, v163
    v_mfma_f32_16x16x32_bf16 v[220:223], a[108:111], a[172:175], v[220:223]
    s_waitcnt lgkmcnt(0)
    s_barrier
    v_mfma_f32_16x16x32_bf16 v[212:215], a[108:111], a[168:171], v[212:215]
    ds_read_b64_tr_b16 a[64:65], v24 offset:16384
    ds_read_b64_tr_b16 a[66:67], v24 offset:17408
    ds_read_b64_tr_b16 a[68:69], v25 offset:16384
    ds_read_b64_tr_b16 a[70:71], v25 offset:17408
    v_mfma_f32_16x16x32_bf16 v[224:227], a[112:115], a[168:171], v[224:227]
    ds_read_b64_tr_b16 a[72:73], v26 offset:16384
    ds_read_b64_tr_b16 a[74:75], v26 offset:17408
    v_mfma_f32_16x16x32_bf16 v[232:235], a[112:115], a[172:175], v[232:235]
    v_mul_f32 v171, s60, v171
    v_cvt_pk_bf16_f32 v49, v162, v163
    v_mfma_f32_16x16x32_bf16 v[236:239], a[116:119], a[172:175], v[236:239]
    ds_read_b64_tr_b16 a[76:77], v27 offset:16384
    ds_read_b64_tr_b16 a[78:79], v27 offset:17408
    v_mfma_f32_16x16x32_bf16 v[228:231], a[116:119], a[168:171], v[228:231]
    v_cvt_pk_bf16_f32 v53, v170, v171
    v_mul_f32 v164, s60, v164
    v_mfma_f32_16x16x32_bf16 v[240:243], a[120:123], a[168:171], v[240:243]
    ds_read_b64_tr_b16 a[80:81], v28 offset:16384
    ds_read_b64_tr_b16 a[82:83], v28 offset:17408
    v_mfma_f32_16x16x32_bf16 v[248:251], a[120:123], a[172:175], v[248:251]
    v_mul_f32 v172, s60, v172
    v_mul_f32 v165, s60, v165
    v_mfma_f32_16x16x32_bf16 v[252:255], a[124:127], a[172:175], v[252:255]
    ds_read_b64_tr_b16 a[84:85], v29 offset:16384
    v_mul_f32 v173, s60, v173
    v_mfma_f32_16x16x32_bf16 v[244:247], a[124:127], a[168:171], v[244:247]
    ds_read_b64_tr_b16 a[86:87], v29 offset:17408
    s_waitcnt lgkmcnt(8)
    v_mfma_f32_16x16x32_bf16 v[192:195], a[64:67], a[176:179], v[192:195]
    ds_read_b64_tr_b16 a[88:89], v30 offset:16384
    ds_read_b64_tr_b16 a[90:91], v30 offset:17408
    v_mfma_f32_16x16x32_bf16 v[200:203], a[64:67], a[180:183], v[200:203]
    v_cvt_pk_bf16_f32 v50, v164, v165
    v_cvt_pk_bf16_f32 v54, v172, v173
    v_mfma_f32_16x16x32_bf16 v[204:207], a[68:71], a[180:183], v[204:207]
    ds_read_b64_tr_b16 a[92:93], v31 offset:16384
    ds_read_b64_tr_b16 a[94:95], v31 offset:17408
    ds_read_b64_tr_b16 a[96:97], v24 offset:24576
    v_mfma_f32_16x16x32_bf16 v[196:199], a[68:71], a[176:179], v[196:199]
    ds_read_b64_tr_b16 a[98:99], v24 offset:25600
    s_waitcnt lgkmcnt(10)
    v_mfma_f32_16x16x32_bf16 v[208:211], a[72:75], a[176:179], v[208:211]
    ds_read_b64_tr_b16 a[100:101], v25 offset:24576
    ds_read_b64_tr_b16 a[102:103], v25 offset:25600
    v_mfma_f32_16x16x32_bf16 v[216:219], a[72:75], a[180:183], v[216:219]
    v_permlane32_swap_b32 v48, v50
    v_mfma_f32_16x16x32_bf16 v[220:223], a[76:79], a[180:183], v[220:223]
    ds_read_b64_tr_b16 a[104:105], v26 offset:24576
    v_mul_f32 v166, s60, v166
    v_mfma_f32_16x16x32_bf16 v[212:215], a[76:79], a[176:179], v[212:215]
    ds_read_b64_tr_b16 a[106:107], v26 offset:25600
    s_waitcnt lgkmcnt(10)
    v_mfma_f32_16x16x32_bf16 v[224:227], a[80:83], a[176:179], v[224:227]
    ds_read_b64_tr_b16 a[108:109], v27 offset:24576
    ds_read_b64_tr_b16 a[110:111], v27 offset:25600
    v_mfma_f32_16x16x32_bf16 v[232:235], a[80:83], a[180:183], v[232:235]
    v_permlane32_swap_b32 v52, v54
    v_mfma_f32_16x16x32_bf16 v[236:239], a[84:87], a[180:183], v[236:239]
    ds_read_b64_tr_b16 a[112:113], v28 offset:24576
    v_mul_f32 v174, s60, v174
    v_mfma_f32_16x16x32_bf16 v[228:231], a[84:87], a[176:179], v[228:231]
    ds_read_b64_tr_b16 a[114:115], v28 offset:25600
    s_waitcnt lgkmcnt(10)
    v_mfma_f32_16x16x32_bf16 v[240:243], a[88:91], a[176:179], v[240:243]
    ds_read_b64_tr_b16 a[116:117], v29 offset:24576
    ds_read_b64_tr_b16 a[118:119], v29 offset:25600
    v_mfma_f32_16x16x32_bf16 v[248:251], a[88:91], a[180:183], v[248:251]
    v_permlane16_swap_b32 v48, v50
    v_mfma_f32_16x16x32_bf16 v[252:255], a[92:95], a[180:183], v[252:255]
    ds_read_b64_tr_b16 a[120:121], v30 offset:24576
    v_mul_f32 v167, s60, v167
    v_mfma_f32_16x16x32_bf16 v[244:247], a[92:95], a[176:179], v[244:247]
    ds_read_b64_tr_b16 a[122:123], v30 offset:25600
    s_waitcnt lgkmcnt(10)
    v_mfma_f32_16x16x32_bf16 v[192:195], a[96:99], a[184:187], v[192:195]
    ds_read_b64_tr_b16 a[124:125], v31 offset:24576
    ds_read_b64_tr_b16 a[126:127], v31 offset:25600
    v_mfma_f32_16x16x32_bf16 v[200:203], a[96:99], a[188:191], v[200:203]
    v_permlane16_swap_b32 v52, v54
    v_mfma_f32_16x16x32_bf16 v[204:207], a[100:103], a[188:191], v[204:207]
    v_mul_f32 v175, s60, v175
    v_cvt_pk_bf16_f32 v51, v166, v167
    v_mfma_f32_16x16x32_bf16 v[196:199], a[100:103], a[184:187], v[196:199]
    v_cvt_pk_bf16_f32 v55, v174, v175
    s_waitcnt lgkmcnt(8)
    v_mfma_f32_16x16x32_bf16 v[208:211], a[104:107], a[184:187], v[208:211]
    v_permlane32_swap_b32 v49, v51
    v_mfma_f32_16x16x32_bf16 v[216:219], a[104:107], a[188:191], v[216:219]
    v_permlane32_swap_b32 v53, v55
    v_mfma_f32_16x16x32_bf16 v[220:223], a[108:111], a[188:191], v[220:223]
    s_waitcnt lgkmcnt(0)
    s_barrier
    v_mfma_f32_16x16x32_bf16 v[212:215], a[108:111], a[184:187], v[212:215]
    ds_read_b64_tr_b16 a[64:65], v16 offset:16384
    ds_read_b64_tr_b16 a[66:67], v16 offset:17408
    ds_read_b64_tr_b16 a[68:69], v17 offset:16384
    ds_read_b64_tr_b16 a[70:71], v17 offset:17408
    v_mfma_f32_16x16x32_bf16 v[224:227], a[112:115], a[184:187], v[224:227]
    ds_read_b64_tr_b16 a[72:73], v18 offset:16384
    ds_read_b64_tr_b16 a[74:75], v18 offset:17408
    v_mfma_f32_16x16x32_bf16 v[232:235], a[112:115], a[188:191], v[232:235]
    v_permlane16_swap_b32 v49, v51
    v_mfma_f32_16x16x32_bf16 v[236:239], a[116:119], a[188:191], v[236:239]
    ds_read_b64_tr_b16 a[76:77], v19 offset:16384
    ds_read_b64_tr_b16 a[78:79], v19 offset:17408
    v_mfma_f32_16x16x32_bf16 v[228:231], a[116:119], a[184:187], v[228:231]
    v_permlane16_swap_b32 v53, v55
    v_mfma_f32_16x16x32_bf16 v[240:243], a[120:123], a[184:187], v[240:243]
    ds_read_b64_tr_b16 a[80:81], v20 offset:16384
    ds_read_b64_tr_b16 a[82:83], v20 offset:17408
    v_mfma_f32_16x16x32_bf16 v[248:251], a[120:123], a[188:191], v[248:251]
    v_accvgpr_write_b32 a16, v48
    v_accvgpr_write_b32 a20, v52
    v_mfma_f32_16x16x32_bf16 v[252:255], a[124:127], a[188:191], v[252:255]
    ds_read_b64_tr_b16 a[84:85], v21 offset:16384
    v_accvgpr_write_b32 a17, v49
    v_mfma_f32_16x16x32_bf16 v[244:247], a[124:127], a[184:187], v[244:247]
    ds_read_b64_tr_b16 a[86:87], v21 offset:17408
    s_waitcnt lgkmcnt(8)
    v_mfma_f32_16x16x32_bf16 v[192:195], a[64:67], a[192:195], v[192:195]
    ds_read_b64_tr_b16 a[88:89], v22 offset:16384
    ds_read_b64_tr_b16 a[90:91], v22 offset:17408
    v_mfma_f32_16x16x32_bf16 v[200:203], a[64:67], a[196:199], v[200:203]
    v_accvgpr_write_b32 a21, v53
    v_accvgpr_write_b32 a18, v50
    v_mfma_f32_16x16x32_bf16 v[204:207], a[68:71], a[196:199], v[204:207]
    ds_read_b64_tr_b16 a[92:93], v23 offset:16384
    ds_read_b64_tr_b16 a[94:95], v23 offset:17408
    ds_read_b64_tr_b16 a[96:97], v16 offset:24576
    v_mfma_f32_16x16x32_bf16 v[196:199], a[68:71], a[192:195], v[196:199]
    ds_read_b64_tr_b16 a[98:99], v16 offset:25600
    s_waitcnt lgkmcnt(10)
    v_mfma_f32_16x16x32_bf16 v[208:211], a[72:75], a[192:195], v[208:211]
    ds_read_b64_tr_b16 a[100:101], v17 offset:24576
    ds_read_b64_tr_b16 a[102:103], v17 offset:25600
    v_mfma_f32_16x16x32_bf16 v[216:219], a[72:75], a[196:199], v[216:219]
    v_accvgpr_write_b32 a22, v54
    v_accvgpr_write_b32 a19, v51
    v_mfma_f32_16x16x32_bf16 v[220:223], a[76:79], a[196:199], v[220:223]
    ds_read_b64_tr_b16 a[104:105], v18 offset:24576
    v_accvgpr_write_b32 a23, v55
    v_mfma_f32_16x16x32_bf16 v[212:215], a[76:79], a[192:195], v[212:215]
    ds_read_b64_tr_b16 a[106:107], v18 offset:25600
    s_waitcnt lgkmcnt(10)
    v_mfma_f32_16x16x32_bf16 v[224:227], a[80:83], a[192:195], v[224:227]
    ds_read_b64_tr_b16 a[108:109], v19 offset:24576
    ds_read_b64_tr_b16 a[110:111], v19 offset:25600
    v_mfma_f32_16x16x32_bf16 v[232:235], a[80:83], a[196:199], v[232:235]
    v_mul_f32 v176, s60, v176
    v_mul_f32 v184, s60, v184
    v_mfma_f32_16x16x32_bf16 v[236:239], a[84:87], a[196:199], v[236:239]
    ds_read_b64_tr_b16 a[112:113], v20 offset:24576
    v_mul_f32 v177, s60, v177
    v_mfma_f32_16x16x32_bf16 v[228:231], a[84:87], a[192:195], v[228:231]
    ds_read_b64_tr_b16 a[114:115], v20 offset:25600
    s_waitcnt lgkmcnt(10)
    v_mfma_f32_16x16x32_bf16 v[240:243], a[88:91], a[192:195], v[240:243]
    ds_read_b64_tr_b16 a[116:117], v21 offset:24576
    ds_read_b64_tr_b16 a[118:119], v21 offset:25600
    v_mfma_f32_16x16x32_bf16 v[248:251], a[88:91], a[196:199], v[248:251]
    v_mul_f32 v185, s60, v185
    v_cvt_pk_bf16_f32 v56, v176, v177
    v_mfma_f32_16x16x32_bf16 v[252:255], a[92:95], a[196:199], v[252:255]
    ds_read_b64_tr_b16 a[120:121], v22 offset:24576
    v_cvt_pk_bf16_f32 v60, v184, v185
    v_mfma_f32_16x16x32_bf16 v[244:247], a[92:95], a[192:195], v[244:247]
    ds_read_b64_tr_b16 a[122:123], v22 offset:25600
    s_waitcnt lgkmcnt(10)
    v_mfma_f32_16x16x32_bf16 v[192:195], a[96:99], a[200:203], v[192:195]
    ds_read_b64_tr_b16 a[124:125], v23 offset:24576
    ds_read_b64_tr_b16 a[126:127], v23 offset:25600
    v_mfma_f32_16x16x32_bf16 v[200:203], a[96:99], a[204:207], v[200:203]
    v_mul_f32 v178, s60, v178
    v_mul_f32 v186, s60, v186
    v_mfma_f32_16x16x32_bf16 v[204:207], a[100:103], a[204:207], v[204:207]
    v_mul_f32 v179, s60, v179
    v_mul_f32 v187, s60, v187
    v_mfma_f32_16x16x32_bf16 v[196:199], a[100:103], a[200:203], v[196:199]
    v_cvt_pk_bf16_f32 v57, v178, v179
    s_waitcnt lgkmcnt(8)
    v_mfma_f32_16x16x32_bf16 v[208:211], a[104:107], a[200:203], v[208:211]
    v_cvt_pk_bf16_f32 v61, v186, v187
    v_mul_f32 v180, s60, v180
    v_mfma_f32_16x16x32_bf16 v[216:219], a[104:107], a[204:207], v[216:219]
    v_mul_f32 v188, s60, v188
    v_mul_f32 v181, s60, v181
    v_mfma_f32_16x16x32_bf16 v[220:223], a[108:111], a[204:207], v[220:223]
    s_waitcnt lgkmcnt(0)
    s_barrier
    v_mfma_f32_16x16x32_bf16 v[212:215], a[108:111], a[200:203], v[212:215]
    ds_read_b64_tr_b16 a[64:65], v16 offset:49152
    ds_read_b64_tr_b16 a[66:67], v16 offset:50176
    ds_read_b64_tr_b16 a[68:69], v17 offset:49152
    ds_read_b64_tr_b16 a[70:71], v17 offset:50176
    v_mfma_f32_16x16x32_bf16 v[224:227], a[112:115], a[200:203], v[224:227]
    ds_read_b64_tr_b16 a[72:73], v18 offset:49152
    ds_read_b64_tr_b16 a[74:75], v18 offset:50176
    v_mfma_f32_16x16x32_bf16 v[232:235], a[112:115], a[204:207], v[232:235]
    v_mul_f32 v189, s60, v189
    v_cvt_pk_bf16_f32 v58, v180, v181
    v_mfma_f32_16x16x32_bf16 v[236:239], a[116:119], a[204:207], v[236:239]
    ds_read_b64_tr_b16 a[76:77], v19 offset:49152
    ds_read_b64_tr_b16 a[78:79], v19 offset:50176
    v_mfma_f32_16x16x32_bf16 v[228:231], a[116:119], a[200:203], v[228:231]
    v_permlane32_swap_b32 v56, v58
    v_mfma_f32_16x16x32_bf16 v[240:243], a[120:123], a[200:203], v[240:243]
    ds_read_b64_tr_b16 a[80:81], v20 offset:49152
    ds_read_b64_tr_b16 a[82:83], v20 offset:50176
    v_mfma_f32_16x16x32_bf16 v[248:251], a[120:123], a[204:207], v[248:251]
    v_cvt_pk_bf16_f32 v62, v188, v189
    v_mul_f32 v182, s60, v182
    v_mfma_f32_16x16x32_bf16 v[252:255], a[124:127], a[204:207], v[252:255]
    ds_read_b64_tr_b16 a[84:85], v21 offset:49152
    v_mul_f32 v190, s60, v190
    v_mfma_f32_16x16x32_bf16 v[244:247], a[124:127], a[200:203], v[244:247]
    ds_read_b64_tr_b16 a[86:87], v21 offset:50176
    s_waitcnt lgkmcnt(8)
    v_mfma_f32_16x16x32_bf16 v[192:195], a[64:67], a[208:211], v[192:195]
    ds_read_b64_tr_b16 a[88:89], v22 offset:49152
    ds_read_b64_tr_b16 a[90:91], v22 offset:50176
    v_mfma_f32_16x16x32_bf16 v[200:203], a[64:67], a[212:215], v[200:203]
    s_cbranch_scc1 L_announce
L_announced:
    v_mul_f32 v183, s60, v183
    v_mfma_f32_16x16x32_bf16 v[204:207], a[68:71], a[212:215], v[204:207]
    ds_read_b64_tr_b16 a[92:93], v23 offset:49152
    ds_read_b64_tr_b16 a[94:95], v23 offset:50176
    ds_read_b64_tr_b16 a[96:97], v16 offset:57344
    v_mfma_f32_16x16x32_bf16 v[196:199], a[68:71], a[208:211], v[196:199]
    ds_read_b64_tr_b16 a[98:99], v16 offset:58368
    s_waitcnt lgkmcnt(10)
    v_mfma_f32_16x16x32_bf16 v[208:211], a[72:75], a[208:211], v[208:211]
    ds_read_b64_tr_b16 a[100:101], v17 offset:57344
    ds_read_b64_tr_b16 a[102:103], v17 offset:58368
    v_mfma_f32_16x16x32_bf16 v[216:219], a[72:75], a[212:215], v[216:219]
    v_permlane32_swap_b32 v60, v62
    v_mfma_f32_16x16x32_bf16 v[220:223], a[76:79], a[212:215], v[220:223]
    ds_read_b64_tr_b16 a[104:105], v18 offset:57344
    v_mul_f32 v191, s60, v191
    v_mfma_f32_16x16x32_bf16 v[212:215], a[76:79], a[208:211], v[212:215]
    ds_read_b64_tr_b16 a[106:107], v18 offset:58368
    s_waitcnt lgkmcnt(10)
    v_mfma_f32_16x16x32_bf16 v[224:227], a[80:83], a[208:211], v[224:227]
    ds_read_b64_tr_b16 a[108:109], v19 offset:57344
    ds_read_b64_tr_b16 a[110:111], v19 offset:58368
    v_mfma_f32_16x16x32_bf16 v[232:235], a[80:83], a[212:215], v[232:235]
    v_permlane16_swap_b32 v56, v58
    v_mfma_f32_16x16x32_bf16 v[236:239], a[84:87], a[212:215], v[236:239]
    ds_read_b64_tr_b16 a[112:113], v20 offset:57344
    v_cvt_pk_bf16_f32 v59, v182, v183
    v_mfma_f32_16x16x32_bf16 v[228:231], a[84:87], a[208:211], v[228:231]
    ds_read_b64_tr_b16 a[114:115], v20 offset:58368
    s_waitcnt lgkmcnt(10)
    v_mfma_f32_16x16x32_bf16 v[240:243], a[88:91], a[208:211], v[240:243]
    ds_read_b64_tr_b16 a[116:117], v21 offset:57344
    ds_read_b64_tr_b16 a[118:119], v21 offset:58368
    v_mfma_f32_16x16x32_bf16 v[248:251], a[88:91], a[212:215], v[248:251]
    v_permlane32_swap_b32 v57, v59
    v_mfma_f32_16x16x32_bf16 v[252:255], a[92:95], a[212:215], v[252:255]
    ds_read_b64_tr_b16 a[120:121], v22 offset:57344
    v_cvt_pk_bf16_f32 v63, v190, v191
    v_mfma_f32_16x16x32_bf16 v[244:247], a[92:95], a[208:211], v[244:247]
    ds_read_b64_tr_b16 a[122:123], v22 offset:58368
    s_waitcnt lgkmcnt(10)
    v_mfma_f32_16x16x32_bf16 v[192:195], a[96:99], a[216:219], v[192:195]
    ds_read_b64_tr_b16 a[124:125], v23 offset:57344
    ds_read_b64_tr_b16 a[126:127], v23 offset:58368
    v_mfma_f32_16x16x32_bf16 v[200:203], a[96:99], a[220:223], v[200:203]
    v_permlane32_swap_b32 v61, v63
    v_mfma_f32_16x16x32_bf16 v[204:207], a[100:103], a[220:223], v[204:207]
    v_permlane16_swap_b32 v60, v62
    v_mfma_f32_16x16x32_bf16 v[196:199], a[100:103], a[216:219], v[196:199]
    v_accvgpr_write_b32 a24, v56
    s_waitcnt lgkmcnt(8)
    v_mfma_f32_16x16x32_bf16 v[208:211], a[104:107], a[216:219], v[208:211]
    v_permlane16_swap_b32 v57, v59
    v_mfma_f32_16x16x32_bf16 v[216:219], a[104:107], a[220:223], v[216:219]
    v_permlane16_swap_b32 v61, v63
    v_mfma_f32_16x16x32_bf16 v[220:223], a[108:111], a[220:223], v[220:223]
    s_waitcnt lgkmcnt(0)
    s_barrier
    v_mfma_f32_16x16x32_bf16 v[212:215], a[108:111], a[216:219], v[212:215]
    ds_read_b64_tr_b16 a[64:65], v32 offset:16384
    ds_read_b64_tr_b16 a[66:67], v32 offset:17408
    ds_read_b64_tr_b16 a[68:69], v32 offset:24576
    ds_read_b64_tr_b16 a[70:71], v32 offset:25600
    v_mfma_f32_16x16x32_bf16 v[224:227], a[112:115], a[216:219], v[224:227]
    ds_read_b64_tr_b16 a[72:73], v33 offset:16384
    ds_read_b64_tr_b16 a[74:75], v33 offset:17408
    v_mfma_f32_16x16x32_bf16 v[232:235], a[112:115], a[220:223], v[232:235]
    v_accvgpr_write_b32 a28, v60
    v_accvgpr_write_b32 a25, v57
    v_mfma_f32_16x16x32_bf16 v[236:239], a[116:119], a[220:223], v[236:239]
    ds_read_b64_tr_b16 a[76:77], v33 offset:24576
    ds_read_b64_tr_b16 a[78:79], v33 offset:25600
    v_mfma_f32_16x16x32_bf16 v[228:231], a[116:119], a[216:219], v[228:231]
    v_accvgpr_write_b32 a29, v61
    v_accvgpr_write_b32 a26, v58
    v_mfma_f32_16x16x32_bf16 v[240:243], a[120:123], a[216:219], v[240:243]
    ds_read_b64_tr_b16 a[80:81], v34 offset:16384
    ds_read_b64_tr_b16 a[82:83], v34 offset:17408
    v_mfma_f32_16x16x32_bf16 v[248:251], a[120:123], a[220:223], v[248:251]
    v_accvgpr_write_b32 a30, v62
    v_accvgpr_write_b32 a27, v59
    v_mfma_f32_16x16x32_bf16 v[252:255], a[124:127], a[220:223], v[252:255]
    ds_read_b64_tr_b16 a[84:85], v34 offset:24576
    v_accvgpr_write_b32 a31, v63
    v_mfma_f32_16x16x32_bf16 v[244:247], a[124:127], a[216:219], v[244:247]
    ds_read_b64_tr_b16 a[86:87], v34 offset:25600
    s_waitcnt lgkmcnt(8)
    v_mfma_f32_16x16x32_bf16 v[192:195], a[64:67], a[224:227], v[192:195]
    ds_read_b64_tr_b16 a[88:89], v35 offset:16384
    ds_read_b64_tr_b16 a[90:91], v35 offset:17408
    v_mfma_f32_16x16x32_bf16 v[200:203], a[64:67], a[228:231], v[200:203]
    v_mfma_f32_16x16x32_bf16 v[200:203], a[68:71], a[236:239], v[200:203]
    ds_read_b64_tr_b16 a[92:93], v35 offset:24576
    ds_read_b64_tr_b16 a[94:95], v35 offset:25600
    ds_read_b64_tr_b16 a[96:97], v36 offset:16384
    v_mfma_f32_16x16x32_bf16 v[192:195], a[68:71], a[232:235], v[192:195]
    ds_read_b64_tr_b16 a[98:99], v36 offset:17408
    s_waitcnt lgkmcnt(10)
    v_mfma_f32_16x16x32_bf16 v[196:199], a[72:75], a[224:227], v[196:199]
    ds_read_b64_tr_b16 a[100:101], v36 offset:24576
    ds_read_b64_tr_b16 a[102:103], v36 offset:25600
    v_mfma_f32_16x16x32_bf16 v[204:207], a[72:75], a[228:231], v[204:207]
    v_mfma_f32_16x16x32_bf16 v[204:207], a[76:79], a[236:239], v[204:207]
    ds_read_b64_tr_b16 a[104:105], v37 offset:16384
    v_mfma_f32_16x16x32_bf16 v[196:199], a[76:79], a[232:235], v[196:199]
    ds_read_b64_tr_b16 a[106:107], v37 offset:17408
    v_mul_f32 v192, s60, v192
    s_waitcnt lgkmcnt(10)
    v_mfma_f32_16x16x32_bf16 v[208:211], a[80:83], a[224:227], v[208:211]
    ds_read_b64_tr_b16 a[108:109], v37 offset:24576
    ds_read_b64_tr_b16 a[110:111], v37 offset:25600
    v_mul_f32 v200, s60, v200
    v_mfma_f32_16x16x32_bf16 v[216:219], a[80:83], a[228:231], v[216:219]
    v_mul_f32 v193, s60, v193
    v_mul_f32 v201, s60, v201
    v_mfma_f32_16x16x32_bf16 v[216:219], a[84:87], a[236:239], v[216:219]
    ds_read_b64_tr_b16 a[112:113], v38 offset:16384
    v_cvt_pk_bf16_f32 v48, v192, v193
    v_mfma_f32_16x16x32_bf16 v[208:211], a[84:87], a[232:235], v[208:211]
    ds_read_b64_tr_b16 a[114:115], v38 offset:17408
    s_waitcnt lgkmcnt(10)
    v_mfma_f32_16x16x32_bf16 v[212:215], a[88:91], a[224:227], v[212:215]
    ds_read_b64_tr_b16 a[116:117], v38 offset:24576
    ds_read_b64_tr_b16 a[118:119], v38 offset:25600
    v_mfma_f32_16x16x32_bf16 v[220:223], a[88:91], a[228:231], v[220:223]
    v_cvt_pk_bf16_f32 v52, v200, v201
    v_mul_f32 v194, s60, v194
    v_mfma_f32_16x16x32_bf16 v[220:223], a[92:95], a[236:239], v[220:223]
    ds_read_b64_tr_b16 a[120:121], v39 offset:16384
    v_mul_f32 v202, s60, v202
    v_mfma_f32_16x16x32_bf16 v[212:215], a[92:95], a[232:235], v[212:215]
    ds_read_b64_tr_b16 a[122:123], v39 offset:17408
    s_waitcnt lgkmcnt(10)
    v_mfma_f32_16x16x32_bf16 v[224:227], a[96:99], a[224:227], v[224:227]
    ds_read_b64_tr_b16 a[124:125], v39 offset:24576
    ds_read_b64_tr_b16 a[126:127], v39 offset:25600
    v_mfma_f32_16x16x32_bf16 v[232:235], a[96:99], a[228:231], v[232:235]
    v_mul_f32 v195, s60, v195
    v_mul_f32 v203, s60, v203
    v_mfma_f32_16x16x32_bf16 v[232:235], a[100:103], a[236:239], v[232:235]
    v_cvt_pk_bf16_f32 v49, v194, v195
    v_cvt_pk_bf16_f32 v53, v202, v203
    v_mfma_f32_16x16x32_bf16 v[224:227], a[100:103], a[232:235], v[224:227]
    v_mul_f32 v196, s60, v196
    s_waitcnt lgkmcnt(8)
    v_mfma_f32_16x16x32_bf16 v[228:231], a[104:107], a[224:227], v[228:231]
    v_mul_f32 v204, s60, v204
    v_mul_f32 v197, s60, v197
    v_mfma_f32_16x16x32_bf16 v[236:239], a[104:107], a[228:231], v[236:239]
    v_mul_f32 v205, s60, v205
    v_cvt_pk_bf16_f32 v50, v196, v197
    v_mfma_f32_16x16x32_bf16 v[236:239], a[108:111], a[236:239], v[236:239]
    s_waitcnt lgkmcnt(0)
    s_barrier
    v_mfma_f32_16x16x32_bf16 v[228:231], a[108:111], a[232:235], v[228:231]
    ds_read_b128 a[64:67], v84 offset:0
    ds_read_b128 a[68:71], v84 offset:8192
    v_mfma_f32_16x16x32_bf16 v[240:243], a[112:115], a[224:227], v[240:243]
    ds_read_b128 a[72:75], v85 offset:0
    v_cvt_pk_bf16_f32 v54, v204, v205
    v_mfma_f32_16x16x32_bf16 v[248:251], a[112:115], a[228:231], v[248:251]
    v_permlane32_swap_b32 v48, v50
    v_mfma_f32_16x16x32_bf16 v[248:251], a[116:119], a[236:239], v[248:251]
    ds_read_b128 a[76:79], v85 offset:8192
    v_mul_f32 v198, s60, v198
    v_mfma_f32_16x16x32_bf16 v[240:243], a[116:119], a[232:235], v[240:243]
    v_permlane32_swap_b32 v52, v54
    v_mfma_f32_16x16x32_bf16 v[244:247], a[120:123], a[224:227], v[244:247]
    ds_read_b128 a[80:83], v86 offset:0
    ds_read_b128 a[84:87], v86 offset:8192
    v_mfma_f32_16x16x32_bf16 v[252:255], a[120:123], a[228:231], v[252:255]
    v_permlane16_swap_b32 v48, v50
    v_mfma_f32_16x16x32_bf16 v[252:255], a[124:127], a[236:239], v[252:255]
    v_permlane16_swap_b32 v52, v54
    v_mfma_f32_16x16x32_bf16 v[244:247], a[124:127], a[232:235], v[244:247]
    ds_read_b128 a[88:91], v87 offset:0
    s_waitcnt lgkmcnt(3)
    v_mfma_f32_16x16x32_bf16 v[16:19], a[64:67], a[0:3], 0
    ds_read_b128 a[92:95], v87 offset:8192
    v_mul_f32 v206, s60, v206
    v_mfma_f32_16x16x32_bf16 v[24:27], a[64:67], a[4:7], 0
    v_mul_f32 v199, s60, v199
    v_mul_f32 v207, s60, v207
    v_mfma_f32_16x16x32_bf16 v[28:31], a[68:71], a[4:7], 0
    ds_read_b128 a[96:99], v84 offset:256
    ds_read_b128 a[100:103], v84 offset:8448
    v_mfma_f32_16x16x32_bf16 v[20:23], a[68:71], a[0:3], 0
    v_cvt_pk_bf16_f32 v51, v198, v199
    v_cvt_pk_bf16_f32 v55, v206, v207
    v_mfma_f32_16x16x32_bf16 v[16:19], a[72:75], a[8:11], v[16:19]
    ds_read_b128 a[104:107], v85 offset:256
    v_accvgpr_write_b32 a32, v48
    v_mfma_f32_16x16x32_bf16 v[24:27], a[72:75], a[12:15], v[24:27]
    v_permlane32_swap_b32 v49, v51
    v_mfma_f32_16x16x32_bf16 v[28:31], a[76:79], a[12:15], v[28:31]
    v_permlane32_swap_b32 v53, v55
    v_mfma_f32_16x16x32_bf16 v[20:23], a[76:79], a[8:11], v[20:23]
    ds_read_b128 a[108:111], v85 offset:8448
    s_waitcnt lgkmcnt(4)
    v_mfma_f32_16x16x32_bf16 v[16:19], a[80:83], a[16:19], v[16:19]
    ds_read_b128 a[112:115], v86 offset:256
    ds_read_b128 a[116:119], v86 offset:8448
    v_mfma_f32_16x16x32_bf16 v[24:27], a[80:83], a[20:23], v[24:27]
    v_permlane16_swap_b32 v49, v51
    v_mfma_f32_16x16x32_bf16 v[28:31], a[84:87], a[20:23], v[28:31]
    ds_read_b128 a[120:123], v87 offset:256
    v_accvgpr_write_b32 a36, v52
    v_mfma_f32_16x16x32_bf16 v[20:23], a[84:87], a[16:19], v[20:23]
    v_permlane16_swap_b32 v53, v55
    v_mfma_f32_16x16x32_bf16 v[16:19], a[88:91], a[24:27], v[16:19]
    ds_read_b128 a[124:127], v87 offset:8448
    v_accvgpr_write_b32 a33, v49
    v_mfma_f32_16x16x32_bf16 v[24:27], a[88:91], a[28:31], v[24:27]
    v_accvgpr_write_b32 a37, v53
    v_accvgpr_write_b32 a34, v50
    v_mfma_f32_16x16x32_bf16 v[28:31], a[92:95], a[28:31], v[28:31]
    v_accvgpr_write_b32 a38, v54
    v_accvgpr_write_b32 a35, v51
    v_mfma_f32_16x16x32_bf16 v[20:23], a[92:95], a[24:27], v[20:23]
    v_accvgpr_write_b32 a39, v55
    v_mul_f32 v208, s60, v208
    s_waitcnt lgkmcnt(4)
    v_mfma_f32_16x16x32_bf16 v[16:19], a[96:99], a[32:35], v[16:19]
    v_mul_f32 v216, s60, v216
    v_mul_f32 v209, s60, v209
    v_mul_f32 v217, s60, v217
    v_mfma_f32_16x16x32_bf16 v[24:27], a[96:99], a[36:39], v[24:27]
    v_cvt_pk_bf16_f32 v56, v208, v209
    v_cvt_pk_bf16_f32 v60, v216, v217
    v_mul_f32 v210, s60, v210
    v_mfma_f32_16x16x32_bf16 v[28:31], a[100:103], a[36:39], v[28:31]
    v_mul_f32 v218, s60, v218
    v_mul_f32 v211, s60, v211
    v_mul_f32 v219, s60, v219
    v_mfma_f32_16x16x32_bf16 v[20:23], a[100:103], a[32:35], v[20:23]
    v_cvt_pk_bf16_f32 v57, v210, v211
    v_cvt_pk_bf16_f32 v61, v218, v219
    v_mul_f32 v212, s60, v212
    v_mul_f32 v220, s60, v220
    v_mul_f32 v213, s60, v213
    v_mul_f32 v221, s60, v221
    v_cvt_pk_bf16_f32 v58, v212, v213
    v_cvt_pk_bf16_f32 v62, v220, v221
    v_mul_f32 v214, s60, v214
    v_mul_f32 v222, s60, v222
    v_mul_f32 v215, s60, v215
    v_mul_f32 v223, s60, v223
    v_cvt_pk_bf16_f32 v59, v214, v215
    v_cvt_pk_bf16_f32 v63, v222, v223
    v_permlane32_swap_b32 v56, v58
    v_permlane32_swap_b32 v60, v62
    v_permlane32_swap_b32 v57, v59
    v_permlane32_swap_b32 v61, v63
    v_permlane16_swap_b32 v56, v58
    v_permlane16_swap_b32 v60, v62
    v_permlane16_swap_b32 v57, v59
    v_permlane16_swap_b32 v61, v63
    v_accvgpr_write_b32 a40, v56
    v_accvgpr_write_b32 a44, v60
    v_accvgpr_write_b32 a41, v57
    v_accvgpr_write_b32 a45, v61
    v_accvgpr_write_b32 a42, v58
    v_accvgpr_write_b32 a46, v62
    v_accvgpr_write_b32 a43, v59
    v_accvgpr_write_b32 a47, v63
    v_mul_f32 v224, s60, v224
    v_mul_f32 v232, s60, v232
    v_mul_f32 v225, s60, v225
    v_mfma_f32_16x16x32_bf16 v[16:19], a[104:107], a[40:43], v[16:19]
    v_mul_f32 v233, s60, v233
    v_cvt_pk_bf16_f32 v48, v224, v225
    v_cvt_pk_bf16_f32 v52, v232, v233
    v_mfma_f32_16x16x32_bf16 v[24:27], a[104:107], a[44:47], v[24:27]
    v_mul_f32 v226, s60, v226
    v_mul_f32 v234, s60, v234
    v_mul_f32 v227, s60, v227
    v_mfma_f32_16x16x32_bf16 v[28:31], a[108:111], a[44:47], v[28:31]
    s_waitcnt lgkmcnt(0)
    s_barrier
    v_mul_f32 v235, s60, v235
    v_mfma_f32_16x16x32_bf16 v[20:23], a[108:111], a[40:43], v[20:23]
    ds_read_b128 a[64:67], v84 offset:16384
    ds_read_b128 a[68:71], v84 offset:24576
    v_cvt_pk_bf16_f32 v49, v226, v227
    v_cvt_pk_bf16_f32 v53, v234, v235
    v_mul_f32 v228, s60, v228
    v_mul_f32 v236, s60, v236
    v_mul_f32 v229, s60, v229
    v_mul_f32 v237, s60, v237
    v_cvt_pk_bf16_f32 v50, v228, v229
    v_cvt_pk_bf16_f32 v54, v236, v237
    v_mul_f32 v230, s60, v230
    v_mul_f32 v238, s60, v238
    v_mul_f32 v231, s60, v231
    v_mul_f32 v239, s60, v239
    v_cvt_pk_bf16_f32 v51, v230, v231
    v_cvt_pk_bf16_f32 v55, v238, v239
    v_permlane32_swap_b32 v48, v50
    v_permlane32_swap_b32 v52, v54
    v_permlane32_swap_b32 v49, v51
    v_permlane32_swap_b32 v53, v55
    v_permlane16_swap_b32 v48, v50
    v_permlane16_swap_b32 v52, v54
    v_permlane16_swap_b32 v49, v51
    v_permlane16_swap_b32 v53, v55
    v_accvgpr_write_b32 a48, v48
    v_accvgpr_write_b32 a52, v52
    v_accvgpr_write_b32 a49, v49
    v_accvgpr_write_b32 a53, v53
    v_accvgpr_write_b32 a50, v50
    v_accvgpr_write_b32 a54, v54
    v_accvgpr_write_b32 a51, v51
    v_accvgpr_write_b32 a55, v55
    v_mul_f32 v240, s60, v240
    v_mfma_f32_16x16x32_bf16 v[16:19], a[112:115], a[48:51], v[16:19]
    ds_read_b128 a[72:75], v85 offset:16384
    v_mul_f32 v248, s60, v248
    v_mul_f32 v241, s60, v241
    v_mfma_f32_16x16x32_bf16 v[24:27], a[112:115], a[52:55], v[24:27]
    v_mul_f32 v249, s60, v249
    v_cvt_pk_bf16_f32 v56, v240, v241
    v_cvt_pk_bf16_f32 v60, v248, v249
    v_mfma_f32_16x16x32_bf16 v[28:31], a[116:119], a[52:55], v[28:31]
    ds_read_b128 a[76:79], v85 offset:24576
    v_mul_f32 v242, s60, v242
    v_mul_f32 v250, s60, v250
    v_mfma_f32_16x16x32_bf16 v[20:23], a[116:119], a[48:51], v[20:23]
    v_mul_f32 v243, s60, v243
    v_mul_f32 v251, s60, v251
    v_cvt_pk_bf16_f32 v57, v242, v243
    v_cvt_pk_bf16_f32 v61, v250, v251
    v_mul_f32 v244, s60, v244
    v_mul_f32 v252, s60, v252
    v_mul_f32 v245, s60, v245
    v_mul_f32 v253, s60, v253
    v_cvt_pk_bf16_f32 v58, v244, v245
    v_cvt_pk_bf16_f32 v62, v252, v253
    v_mul_f32 v246, s60, v246
    v_mul_f32 v254, s60, v254
    v_mul_f32 v247, s60, v247
    v_mul_f32 v255, s60, v255
    v_cvt_pk_bf16_f32 v59, v246, v247
    v_cvt_pk_bf16_f32 v63, v254, v255
    v_permlane32_swap_b32 v56, v58
    v_permlane32_swap_b32 v60, v62
    v_permlane32_swap_b32 v57, v59
    v_permlane32_swap_b32 v61, v63
    v_permlane16_swap_b32 v56, v58
    v_permlane16_swap_b32 v60, v62
    v_permlane16_swap_b32 v57, v59
    v_permlane16_swap_b32 v61, v63
    v_accvgpr_write_b32 a56, v56
    v_accvgpr_write_b32 a60, v60
    v_accvgpr_write_b32 a57, v57
    v_accvgpr_write_b32 a61, v61
    v_accvgpr_write_b32 a58, v58
    v_accvgpr_write_b32 a62, v62
    v_accvgpr_write_b32 a59, v59
    v_accvgpr_write_b32 a63, v63
    s_nop 0
    v_mfma_f32_16x16x32_bf16 v[16:19], a[120:123], a[56:59], v[16:19]
    ds_read_b128 a[80:83], v86 offset:16384
    ds_read_b128 a[84:87], v86 offset:24576
    v_mfma_f32_16x16x32_bf16 v[24:27], a[120:123], a[60:63], v[24:27]
    v_mfma_f32_16x16x32_bf16 v[28:31], a[124:127], a[60:63], v[28:31]
    v_mfma_f32_16x16x32_bf16 v[20:23], a[124:127], a[56:59], v[20:23]
    ds_read_b128 a[88:91], v87 offset:16384
    s_waitcnt lgkmcnt(3)
    v_mfma_f32_16x16x32_bf16 v[32:35], a[64:67], a[0:3], 0
    ds_read_b128 a[92:95], v87 offset:24576
    v_max3_f32 v1, v16, v17, v18
    v_mfma_f32_16x16x32_bf16 v[40:43], a[64:67], a[4:7], 0
    v_max3_f32 v2, v24, v25, v26
    v_max3_f32 v2, v2, v27, v28
    v_max3_f32 v1, v1, v19, v20
    v_mfma_f32_16x16x32_bf16 v[44:47], a[68:71], a[4:7], 0
    ds_read_b128 a[96:99], v84 offset:16640
    ds_read_b128 a[100:103], v84 offset:24832
    v_max3_f32 v1, v1, v21, v22
    v_mfma_f32_16x16x32_bf16 v[36:39], a[68:71], a[0:3], 0
    v_max3_f32 v2, v2, v29, v30
    v_max_f32 v1, v1, v23
    v_max_f32 v2, v2, v31
    v_mfma_f32_16x16x32_bf16 v[32:35], a[72:75], a[8:11], v[32:35]
    ds_read_b128 a[104:107], v85 offset:16640
    v_mov_b32 v3, v1
    v_mov_b32 v4, v2
    v_mfma_f32_16x16x32_bf16 v[40:43], a[72:75], a[12:15], v[40:43]
    v_permlane16_swap_b32 v1, v3
    v_max_f32 v1, v1, v3
    v_mfma_f32_16x16x32_bf16 v[44:47], a[76:79], a[12:15], v[44:47]
    v_permlane16_swap_b32 v2, v4
    v_max_f32 v2, v2, v4
    v_mfma_f32_16x16x32_bf16 v[36:39], a[76:79], a[8:11], v[36:39]
    ds_read_b128 a[108:111], v85 offset:24832
    v_mov_b32 v3, v1
    s_waitcnt lgkmcnt(4)
    v_mfma_f32_16x16x32_bf16 v[32:35], a[80:83], a[16:19], v[32:35]
    ds_read_b128 a[112:115], v86 offset:16640
    ds_read_b128 a[116:119], v86 offset:24832
    v_mov_b32 v4, v2
    v_mfma_f32_16x16x32_bf16 v[40:43], a[80:83], a[20:23], v[40:43]
    v_permlane32_swap_b32 v1, v3
    v_max_f32 v1, v1, v3
    v_mfma_f32_16x16x32_bf16 v[44:47], a[84:87], a[20:23], v[44:47]
    ds_read_b128 a[120:123], v87 offset:16640
    v_permlane32_swap_b32 v2, v4
    v_mfma_f32_16x16x32_bf16 v[36:39], a[84:87], a[16:19], v[36:39]
    v_max_f32 v2, v2, v4
    v_sub_f32 v96, 0, v1
    v_sub_f32 v100, 0, v2
    v_mfma_f32_16x16x32_bf16 v[32:35], a[88:91], a[24:27], v[32:35]
    ds_read_b128 a[124:127], v87 offset:24832
    v_sub_f32 v97, 0, v1
    v_sub_f32 v101, 0, v2
    v_mfma_f32_16x16x32_bf16 v[40:43], a[88:91], a[28:31], v[40:43]
    v_sub_f32 v98, 0, v1
    v_sub_f32 v102, 0, v2
    v_sub_f32 v99, 0, v1
    v_mfma_f32_16x16x32_bf16 v[44:47], a[92:95], a[28:31], v[44:47]
    v_sub_f32 v103, 0, v2
    v_add_f32 v16, v16, v96
    v_add_f32 v17, v17, v96
    v_mfma_f32_16x16x32_bf16 v[36:39], a[92:95], a[24:27], v[36:39]
    v_add_f32 v18, v18, v96
    v_add_f32 v19, v19, v96
    s_waitcnt lgkmcnt(4)
    v_mfma_f32_16x16x32_bf16 v[32:35], a[96:99], a[32:35], v[32:35]
    v_add_f32 v20, v20, v96
    v_add_f32 v21, v21, v96
    v_add_f32 v22, v22, v96
    v_mfma_f32_16x16x32_bf16 v[40:43], a[96:99], a[36:39], v[40:43]
    v_exp_f32 v48, v16
    v_add_f32 v23, v23, v96
    v_mfma_f32_16x16x32_bf16 v[44:47], a[100:103], a[36:39], v[44:47]
    ds_read_b64_tr_b16 a[64:65], v88 offset:49152
    ds_read_b64_tr_b16 a[66:67], v88 offset:57344
    v_add_f32 v24, v24, v100
    v_mfma_f32_16x16x32_bf16 v[36:39], a[100:103], a[32:35], v[36:39]
    v_exp_f32 v49, v17
    v_add_f32 v25, v25, v100
    v_mfma_f32_16x16x32_bf16 v[32:35], a[104:107], a[40:43], v[32:35]
    ds_read_b64_tr_b16 a[68:69], v89 offset:49152
    ds_read_b64_tr_b16 a[70:71], v89 offset:57344
    v_add_f32 v26, v26, v100
    v_mfma_f32_16x16x32_bf16 v[40:43], a[104:107], a[44:47], v[40:43]
    v_exp_f32 v50, v18
    v_add_f32 v27, v27, v100
    v_mfma_f32_16x16x32_bf16 v[44:47], a[108:111], a[44:47], v[44:47]
    ds_read_b64_tr_b16 a[72:73], v90 offset:49152
    v_exp_f32 v51, v19
    v_mfma_f32_16x16x32_bf16 v[36:39], a[108:111], a[40:43], v[36:39]
    ds_read_b64_tr_b16 a[74:75], v90 offset:57344
    v_add_f32 v28, v28, v100
    s_waitcnt lgkmcnt(6)
    v_mfma_f32_16x16x32_bf16 v[32:35], a[112:115], a[48:51], v[32:35]
    ds_read_b64_tr_b16 a[76:77], v91 offset:49152
    ds_read_b64_tr_b16 a[78:79], v91 offset:57344
    v_add_f32 v29, v29, v100
    v_mfma_f32_16x16x32_bf16 v[40:43], a[112:115], a[52:55], v[40:43]
    v_exp_f32 v52, v20
    v_add_f32 v30, v30, v100
    v_mfma_f32_16x16x32_bf16 v[44:47], a[116:119], a[52:55], v[44:47]
    ds_read_b64_tr_b16 a[80:81], v92 offset:49152
    ds_read_b64_tr_b16 a[82:83], v92 offset:57344
    v_add_f32 v31, v31, v100
    v_mfma_f32_16x16x32_bf16 v[36:39], a[116:119], a[48:51], v[36:39]
    v_exp_f32 v53, v21
    v_cvt_pk_bf16_f32 v64, v48, v49
    v_mfma_f32_16x16x32_bf16 v[32:35], a[120:123], a[56:59], v[32:35]
    ds_read_b64_tr_b16 a[84:85], v93 offset:49152
    ds_read_b64_tr_b16 a[86:87], v93 offset:57344
    v_cvt_pk_bf16_f32 v65, v50, v51
    v_mfma_f32_16x16x32_bf16 v[40:43], a[120:123], a[60:63], v[40:43]
    v_exp_f32 v54, v22
    v_cvt_pk_bf16_f32 v66, v52, v53
    v_mfma_f32_16x16x32_bf16 v[44:47], a[124:127], a[60:63], v[44:47]
    ds_read_b64_tr_b16 a[88:89], v94 offset:49152
    v_exp_f32 v55, v23
    v_mfma_f32_16x16x32_bf16 v[36:39], a[124:127], a[56:59], v[36:39]
    ds_read_b64_tr_b16 a[90:91], v94 offset:57344
    v_exp_f32 v56, v24
    v_cvt_pk_bf16_f32 v67, v54, v55
    s_nop 1
    v_mfma_f32_16x16x32_bf16 v[116:119], a[240:243], v[64:67], 0
    v_exp_f32 v57, v25
    v_exp_f32 v58, v26
    v_cvt_pk_bf16_f32 v68, v56, v57
    v_exp_f32 v59, v27
    v_exp_f32 v60, v28
    v_cvt_pk_bf16_f32 v69, v58, v59
    v_exp_f32 v61, v29
    v_exp_f32 v62, v30
    v_cvt_pk_bf16_f32 v70, v60, v61
    v_exp_f32 v63, v31
    s_nop 0
    v_cvt_pk_bf16_f32 v71, v62, v63
    s_nop 1
    v_mfma_f32_16x16x32_bf16 v[120:123], a[240:243], v[68:71], 0
    s_waitcnt lgkmcnt(6)
    v_mfma_f32_16x16x32_bf16 v[128:131], a[64:67], v[64:67], 0
    ds_read_b64_tr_b16 a[92:93], v95 offset:49152
    ds_read_b64_tr_b16 a[94:95], v95 offset:57344
    v_mfma_f32_16x16x32_bf16 v[136:139], a[64:67], v[68:71], 0
    v_mfma_f32_16x16x32_bf16 v[140:143], a[68:71], v[68:71], 0
    ds_read_b64_tr_b16 a[96:97], v88 offset:49408
    ds_read_b64_tr_b16 a[98:99], v88 offset:57600
    v_add_f32 v32, v32, v96
    v_add_f32 v33, v33, v96
    v_add_f32 v34, v34, v96
    v_add_f32 v35, v35, v96
    v_add_f32 v36, v36, v96
    v_add_f32 v37, v37, v96
    v_add_f32 v38, v38, v96
    v_add_f32 v39, v39, v96
    v_add_f32 v40, v40, v100
    v_add_f32 v41, v41, v100
    v_add_f32 v42, v42, v100
    v_add_f32 v43, v43, v100
    v_add_f32 v44, v44, v100
    v_add_f32 v45, v45, v100
    v_add_f32 v46, v46, v100
    v_add_f32 v47, v47, v100
    v_mfma_f32_16x16x32_bf16 v[132:135], a[68:71], v[64:67], 0
    v_exp_f32 v48, v32
    v_mfma_f32_16x16x32_bf16 v[144:147], a[72:75], v[64:67], 0
    ds_read_b64_tr_b16 a[100:101], v89 offset:49408
    ds_read_b64_tr_b16 a[102:103], v89 offset:57600
    v_mfma_f32_16x16x32_bf16 v[152:155], a[72:75], v[68:71], 0
    v_exp_f32 v49, v33
    v_mfma_f32_16x16x32_bf16 v[156:159], a[76:79], v[68:71], 0
    ds_read_b64_tr_b16 a[104:105], v90 offset:49408
    v_cvt_pk_bf16_f32 v72, v48, v49
    v_mfma_f32_16x16x32_bf16 v[148:151], a[76:79], v[64:67], 0
    ds_read_b64_tr_b16 a[106:107], v90 offset:57600
    s_waitcnt lgkmcnt(6)
    v_mfma_f32_16x16x32_bf16 v[160:163], a[80:83], v[64:67], 0
    ds_read_b64_tr_b16 a[108:109], v91 offset:49408
    ds_read_b64_tr_b16 a[110:111], v91 offset:57600
    v_mfma_f32_16x16x32_bf16 v[168:171], a[80:83], v[68:71], 0
    v_exp_f32 v50, v34
    v_mfma_f32_16x16x32_bf16 v[172:175], a[84:87], v[68:71], 0
    ds_read_b64_tr_b16 a[112:113], v92 offset:49408
    ds_read_b64_tr_b16 a[114:115], v92 offset:57600
    v_mfma_f32_16x16x32_bf16 v[164:167], a[84:87], v[64:67], 0
    v_exp_f32 v51, v35
    v_mfma_f32_16x16x32_bf16 v[176:179], a[88:91], v[64:67], 0
    ds_read_b64_tr_b16 a[116:117], v93 offset:49408
    ds_read_b64_tr_b16 a[118:119], v93 offset:57600
    v_mfma_f32_16x16x32_bf16 v[184:187], a[88:91], v[68:71], 0
    v_exp_f32 v52, v36
    v_mfma_f32_16x16x32_bf16 v[188:191], a[92:95], v[68:71], 0
    ds_read_b64_tr_b16 a[120:121], v94 offset:49408
    v_cvt_pk_bf16_f32 v73, v50, v51
    v_mfma_f32_16x16x32_bf16 v[180:183], a[92:95], v[64:67], 0
    ds_read_b64_tr_b16 a[122:123], v94 offset:57600
    s_waitcnt lgkmcnt(6)
    v_mfma_f32_16x16x32_bf16 v[192:195], a[96:99], v[64:67], 0
    ds_read_b64_tr_b16 a[124:125], v95 offset:49408
    ds_read_b64_tr_b16 a[126:127], v95 offset:57600
    v_mfma_f32_16x16x32_bf16 v[200:203], a[96:99], v[68:71], 0
    v_exp_f32 v53, v37
    v_mfma_f32_16x16x32_bf16 v[204:207], a[100:103], v[68:71], 0
    v_exp_f32 v54, v38
    v_mfma_f32_16x16x32_bf16 v[196:199], a[100:103], v[64:67], 0
    v_exp_f32 v55, v39
    v_mfma_f32_16x16x32_bf16 v[208:211], a[104:107], v[64:67], 0
    v_exp_f32 v56, v40
    v_mfma_f32_16x16x32_bf16 v[216:219], a[104:107], v[68:71], 0
    v_exp_f32 v57, v41
    v_mfma_f32_16x16x32_bf16 v[220:223], a[108:111], v[68:71], 0
    s_waitcnt lgkmcnt(0)
    s_barrier
    v_mfma_f32_16x16x32_bf16 v[212:215], a[108:111], v[64:67], 0
    ds_read_b128 a[64:67], v80 offset:32768
    ds_read_b128 a[68:71], v80 offset:40960
    v_mfma_f32_16x16x32_bf16 v[224:227], a[112:115], v[64:67], 0
    ds_read_b128 a[72:75], v81 offset:32768
    v_cvt_pk_bf16_f32 v74, v52, v53
    v_mfma_f32_16x16x32_bf16 v[232:235], a[112:115], v[68:71], 0
    v_exp_f32 v58, v42
    v_mfma_f32_16x16x32_bf16 v[236:239], a[116:119], v[68:71], 0
    ds_read_b128 a[76:79], v81 offset:40960
    v_cvt_pk_bf16_f32 v75, v54, v55
    v_mfma_f32_16x16x32_bf16 v[228:231], a[116:119], v[64:67], 0
    v_exp_f32 v59, v43
    v_mfma_f32_16x16x32_bf16 v[240:243], a[120:123], v[64:67], 0
    ds_read_b128 a[80:83], v82 offset:32768
    ds_read_b128 a[84:87], v82 offset:40960
    v_mfma_f32_16x16x32_bf16 v[248:251], a[120:123], v[68:71], 0
    v_mfma_f32_16x16x32_bf16 v[6:9], a[240:243], v[72:75], v[116:119]
    v_mfma_f32_16x16x32_bf16 v[252:255], a[124:127], v[68:71], 0
    v_exp_f32 v60, v44
    v_mfma_f32_16x16x32_bf16 v[244:247], a[124:127], v[64:67], 0
    ds_read_b128 a[88:91], v83 offset:32768
    s_branch L_enter
L_loop:
    s_waitcnt lgkmcnt(3)
    v_mfma_f32_16x16x32_bf16 v[32:35], a[64:67], a[0:3], v[96:99]
    ds_read_b128 a[92:95], v83 offset:24576
    v_cvt_pk_bf16_f32 v69, v58, v59
    v_mfma_f32_16x16x32_bf16 v[40:43], a[64:67], a[4:7], v[100:103]
    v_exp_f32 v60, v28
    v_mfma_f32_16x16x32_bf16 v[44:47], a[68:71], a[4:7], v[100:103]
    ds_read_b128 a[96:99], v80 offset:16640
    ds_read_b128 a[100:103], v80 offset:24832
    v_mfma_f32_16x16x32_bf16 v[36:39], a[68:71], a[0:3], v[96:99]
    v_exp_f32 v61, v29
    v_mfma_f32_16x16x32_bf16 v[32:35], a[72:75], a[8:11], v[32:35]
    ds_read_b128 a[104:107], v81 offset:16640
    v_cvt_pk_bf16_f32 v70, v60, v61
    v_mfma_f32_16x16x32_bf16 v[40:43], a[72:75], a[12:15], v[40:43]
    v_exp_f32 v62, v30
    v_mfma_f32_16x16x32_bf16 v[44:47], a[76:79], a[12:15], v[44:47]
    v_exp_f32 v63, v31
    v_mfma_f32_16x16x32_bf16 v[36:39], a[76:79], a[8:11], v[36:39]
    ds_read_b128 a[108:111], v81 offset:24832
    s_waitcnt lgkmcnt(4)
    v_mfma_f32_16x16x32_bf16 v[32:35], a[80:83], a[16:19], v[32:35]
    ds_read_b128 a[112:115], v82 offset:16640
    ds_read_b128 a[116:119], v82 offset:24832
    v_mfma_f32_16x16x32_bf16 v[40:43], a[80:83], a[20:23], v[40:43]
    v_cvt_pk_bf16_f32 v71, v62, v63
    v_mfma_f32_16x16x32_bf16 v[44:47], a[84:87], a[20:23], v[44:47]
    ds_read_b128 a[120:123], v83 offset:16640
    v_mfma_f32_16x16x32_bf16 v[36:39], a[84:87], a[16:19], v[36:39]
    v_mfma_f32_16x16x32_bf16 v[120:123], a[240:243], v[68:71], v[84:87]
    v_mfma_f32_16x16x32_bf16 v[32:35], a[88:91], a[24:27], v[32:35]
    ds_read_b128 a[124:127], v83 offset:24832
    v_mfma_f32_16x16x32_bf16 v[40:43], a[88:91], a[28:31], v[40:43]
    v_mfma_f32_16x16x32_bf16 v[44:47], a[92:95], a[28:31], v[44:47]
    v_mfma_f32_16x16x32_bf16 v[36:39], a[92:95], a[24:27], v[36:39]
    s_waitcnt lgkmcnt(4)
    v_mfma_f32_16x16x32_bf16 v[32:35], a[96:99], a[32:35], v[32:35]
    v_mfma_f32_16x16x32_bf16 v[40:43], a[96:99], a[36:39], v[40:43]
    v_max_f32 v1, v116, v120
    v_cmp_nge_f32 vcc, s61, v1
    v_mfma_f32_16x16x32_bf16 v[44:47], a[100:103], a[36:39], v[44:47]
    ds_read_b64_tr_b16 a[64:65], v88 offset:0
    ds_read_b64_tr_b16 a[66:67], v88 offset:8192
    v_mfma_f32_16x16x32_bf16 v[36:39], a[100:103], a[32:35], v[36:39]
    v_mfma_f32_16x16x32_bf16 v[32:35], a[104:107], a[40:43], v[32:35]
    ds_read_b64_tr_b16 a[68:69], v89 offset:0
    ds_read_b64_tr_b16 a[70:71], v89 offset:8192
    v_mfma_f32_16x16x32_bf16 v[40:43], a[104:107], a[44:47], v[40:43]
    v_mfma_f32_16x16x32_bf16 v[44:47], a[108:111], a[44:47], v[44:47]
    ds_read_b64_tr_b16 a[72:73], v90 offset:0
    v_mfma_f32_16x16x32_bf16 v[36:39], a[108:111], a[40:43], v[36:39]
    ds_read_b64_tr_b16 a[74:75], v90 offset:8192
    s_waitcnt lgkmcnt(6)
    v_mfma_f32_16x16x32_bf16 v[32:35], a[112:115], a[48:51], v[32:35]
    ds_read_b64_tr_b16 a[76:77], v91 offset:0
    ds_read_b64_tr_b16 a[78:79], v91 offset:8192
    v_mfma_f32_16x16x32_bf16 v[40:43], a[112:115], a[52:55], v[40:43]
    v_mfma_f32_16x16x32_bf16 v[44:47], a[116:119], a[52:55], v[44:47]
    ds_read_b64_tr_b16 a[80:81], v92 offset:0
    ds_read_b64_tr_b16 a[82:83], v92 offset:8192
    v_mfma_f32_16x16x32_bf16 v[36:39], a[116:119], a[48:51], v[36:39]
    v_mfma_f32_16x16x32_bf16 v[32:35], a[120:123], a[56:59], v[32:35]
    ds_read_b64_tr_b16 a[84:85], v93 offset:0
    ds_read_b64_tr_b16 a[86:87], v93 offset:8192
    v_mfma_f32_16x16x32_bf16 v[40:43], a[120:123], a[60:63], v[40:43]
    v_mfma_f32_16x16x32_bf16 v[44:47], a[124:127], a[60:63], v[44:47]
    ds_read_b64_tr_b16 a[88:89], v94 offset:0
    v_mfma_f32_16x16x32_bf16 v[36:39], a[124:127], a[56:59], v[36:39]
    ds_read_b64_tr_b16 a[90:91], v94 offset:8192
    s_cbranch_vccnz L_tr_L0
L_bk_L0:
    s_waitcnt lgkmcnt(6)
    v_mfma_f32_16x16x32_bf16 v[128:131], a[64:67], v[64:67], v[128:131]
    ds_read_b64_tr_b16 a[92:93], v95 offset:0
    ds_read_b64_tr_b16 a[94:95], v95 offset:8192
    v_mfma_f32_16x16x32_bf16 v[136:139], a[64:67], v[68:71], v[136:139]
    v_mfma_f32_16x16x32_bf16 v[140:143], a[68:71], v[68:71], v[140:143]
    ds_read_b64_tr_b16 a[96:97], v88 offset:256
    ds_read_b64_tr_b16 a[98:99], v88 offset:8448
    v_mfma_f32_16x16x32_bf16 v[132:135], a[68:71], v[64:67], v[132:135]
    v_exp_f32 v48, v32
    v_mfma_f32_16x16x32_bf16 v[144:147], a[72:75], v[64:67], v[144:147]
    ds_read_b64_tr_b16 a[100:101], v89 offset:256
    ds_read_b64_tr_b16 a[102:103], v89 offset:8448
    v_mfma_f32_16x16x32_bf16 v[152:155], a[72:75], v[68:71], v[152:155]
    v_exp_f32 v49, v33
    v_mfma_f32_16x16x32_bf16 v[156:159], a[76:79], v[68:71], v[156:159]
    ds_read_b64_tr_b16 a[104:105], v90 offset:256
    v_cvt_pk_bf16_f32 v72, v48, v49
    v_mfma_f32_16x16x32_bf16 v[148:151], a[76:79], v[64:67], v[148:151]
    ds_read_b64_tr_b16 a[106:107], v90 offset:8448
    s_waitcnt lgkmcnt(6)
    v_mfma_f32_16x16x32_bf16 v[160:163], a[80:83], v[64:67], v[160:163]
    ds_read_b64_tr_b16 a[108:109], v91 offset:256
    ds_read_b64_tr_b16 a[110:111], v91 offset:8448
    v_mfma_f32_16x16x32_bf16 v[168:171], a[80:83], v[68:71], v[168:171]
    v_exp_f32 v50, v34
    v_mfma_f32_16x16x32_bf16 v[172:175], a[84:87], v[68:71], v[172:175]
    ds_read_b64_tr_b16 a[112:113], v92 offset:256
    ds_read_b64_tr_b16 a[114:115], v92 offset:8448
    v_mfma_f32_16x16x32_bf16 v[164:167], a[84:87], v[64:67], v[164:167]
    v_exp_f32 v51, v35
    v_mfma_f32_16x16x32_bf16 v[176:179], a[88:91], v[64:67], v[176:179]
    ds_read_b64_tr_b16 a[116:117], v93 offset:256
    ds_read_b64_tr_b16 a[118:119], v93 offset:8448
    v_mfma_f32_16x16x32_bf16 v[184:187], a[88:91], v[68:71], v[184:187]
    v_exp_f32 v52, v36
    v_mfma_f32_16x16x32_bf16 v[188:191], a[92:95], v[68:71], v[188:191]
    ds_read_b64_tr_b16 a[120:121], v94 offset:256
    v_cvt_pk_bf16_f32 v73, v50, v51
    v_mfma_f32_16x16x32_bf16 v[180:183], a[92:95], v[64:67], v[180:183]
    ds_read_b64_tr_b16 a[122:123], v94 offset:8448
    s_waitcnt lgkmcnt(6)
    v_mfma_f32_16x16x32_bf16 v[192:195], a[96:99], v[64:67], v[192:195]
    ds_read_b64_tr_b16 a[124:125], v95 offset:256
    ds_read_b64_tr_b16 a[126:127], v95 offset:8448
    v_mfma_f32_16x16x32_bf16 v[200:203], a[96:99], v[68:71], v[200:203]
    v_exp_f32 v53, v37
    v_mfma_f32_16x16x32_bf16 v[204:207], a[100:103], v[68:71], v[204:207]
    v_exp_f32 v54, v38
    v_mfma_f32_16x16x32_bf16 v[196:199], a[100:103], v[64:67], v[196:199]
    v_exp_f32 v55, v39
    v_mfma_f32_16x16x32_bf16 v[208:211], a[104:107], v[64:67], v[208:211]
    v_exp_f32 v56, v40
    v_mfma_f32_16x16x32_bf16 v[216:219], a[104:107], v[68:71], v[216:219]
    v_exp_f32 v57, v41
    v_mfma_f32_16x16x32_bf16 v[220:223], a[108:111], v[68:71], v[220:223]
    s_waitcnt lgkmcnt(0)
    s_barrier
    v_mfma_f32_16x16x32_bf16 v[212:215], a[108:111], v[64:67], v[212:215]
    ds_read_b128 a[64:67], v80 offset:32768
    ds_read_b128 a[68:71], v80 offset:40960
    v_mfma_f32_16x16x32_bf16 v[224:227], a[112:115], v[64:67], v[224:227]
    ds_read_b128 a[72:75], v81 offset:32768
    v_cvt_pk_bf16_f32 v74, v52, v53
    v_mfma_f32_16x16x32_bf16 v[232:235], a[112:115], v[68:71], v[232:235]
    v_exp_f32 v58, v42
    v_mfma_f32_16x16x32_bf16 v[236:239], a[116:119], v[68:71], v[236:239]
    ds_read_b128 a[76:79], v81 offset:40960
    v_cvt_pk_bf16_f32 v75, v54, v55
    v_mfma_f32_16x16x32_bf16 v[228:231], a[116:119], v[64:67], v[228:231]
    v_exp_f32 v59, v43
    v_mfma_f32_16x16x32_bf16 v[240:243], a[120:123], v[64:67], v[240:243]
    ds_read_b128 a[80:83], v82 offset:32768
    ds_read_b128 a[84:87], v82 offset:40960
    v_mfma_f32_16x16x32_bf16 v[248:251], a[120:123], v[68:71], v[248:251]
    v_mfma_f32_16x16x32_bf16 v[6:9], a[240:243], v[72:75], v[116:119]
    v_mfma_f32_16x16x32_bf16 v[252:255], a[124:127], v[68:71], v[252:255]
    v_exp_f32 v60, v44
    v_mfma_f32_16x16x32_bf16 v[244:247], a[124:127], v[64:67], v[244:247]
    ds_read_b128 a[88:91], v83 offset:32768
L_enter:
    s_waitcnt lgkmcnt(3)
    v_mfma_f32_16x16x32_bf16 v[16:19], a[64:67], a[0:3], v[96:99]
    ds_read_b128 a[92:95], v83 offset:40960
    v_cvt_pk_bf16_f32 v76, v56, v57
    v_mfma_f32_16x16x32_bf16 v[24:27], a[64:67], a[4:7], v[100:103]
    v_exp_f32 v61, v45
    v_mfma_f32_16x16x32_bf16 v[28:31], a[68:71], a[4:7], v[100:103]
    ds_read_b128 a[96:99], v80 offset:33024
    ds_read_b128 a[100:103], v80 offset:41216
    v_mfma_f32_16x16x32_bf16 v[20:23], a[68:71], a[0:3], v[96:99]
    v_exp_f32 v62, v46
    v_mfma_f32_16x16x32_bf16 v[16:19], a[72:75], a[8:11], v[16:19]
    ds_read_b128 a[104:107], v81 offset:33024
    v_cvt_pk_bf16_f32 v77, v58, v59
    v_mfma_f32_16x16x32_bf16 v[24:27], a[72:75], a[12:15], v[24:27]
    v_exp_f32 v63, v47
    v_mfma_f32_16x16x32_bf16 v[28:31], a[76:79], a[12:15], v[28:31]
    v_cvt_pk_bf16_f32 v78, v60, v61
    v_cvt_pk_bf16_f32 v79, v62, v63
    v_mfma_f32_16x16x32_bf16 v[20:23], a[76:79], a[8:11], v[20:23]
    ds_read_b128 a[108:111], v81 offset:41216
    s_waitcnt lgkmcnt(4)
    v_mfma_f32_16x16x32_bf16 v[16:19], a[80:83], a[16:19], v[16:19]
    ds_read_b128 a[112:115], v82 offset:33024
    ds_read_b128 a[116:119], v82 offset:41216
    v_mfma_f32_16x16x32_bf16 v[24:27], a[80:83], a[20:23], v[24:27]
    v_mfma_f32_16x16x32_bf16 v[84:87], a[240:243], v[76:79], v[120:123]
    v_mfma_f32_16x16x32_bf16 v[28:31], a[84:87], a[20:23], v[28:31]
    ds_read_b128 a[120:123], v83 offset:33024
    v_mfma_f32_16x16x32_bf16 v[20:23], a[84:87], a[16:19], v[20:23]
    v_mfma_f32_16x16x32_bf16 v[16:19], a[88:91], a[24:27], v[16:19]
    ds_read_b128 a[124:127], v83 offset:41216
    v_mfma_f32_16x16x32_bf16 v[24:27], a[88:91], a[28:31], v[24:27]
    v_mfma_f32_16x16x32_bf16 v[28:31], a[92:95], a[28:31], v[28:31]
    v_mfma_f32_16x16x32_bf16 v[20:23], a[92:95], a[24:27], v[20:23]
    v_max_f32 v1, v6, v84
    s_waitcnt lgkmcnt(4)
    v_mfma_f32_16x16x32_bf16 v[16:19], a[96:99], a[32:35], v[16:19]
    v_cmp_nge_f32 vcc, s61, v1
    v_mfma_f32_16x16x32_bf16 v[24:27], a[96:99], a[36:39], v[24:27]
    v_mfma_f32_16x16x32_bf16 v[28:31], a[100:103], a[36:39], v[28:31]
    ds_read_b64_tr_b16 a[64:65], v88 offset:16384
    ds_read_b64_tr_b16 a[66:67], v88 offset:24576
    v_mfma_f32_16x16x32_bf16 v[20:23], a[100:103], a[32:35], v[20:23]
    v_mfma_f32_16x16x32_bf16 v[16:19], a[104:107], a[40:43], v[16:19]
    ds_read_b64_tr_b16 a[68:69], v89 offset:16384
    ds_read_b64_tr_b16 a[70:71], v89 offset:24576
    v_mfma_f32_16x16x32_bf16 v[24:27], a[104:107], a[44:47], v[24:27]
    v_mfma_f32_16x16x32_bf16 v[28:31], a[108:111], a[44:47], v[28:31]
    ds_read_b64_tr_b16 a[72:73], v90 offset:16384
    v_mfma_f32_16x16x32_bf16 v[20:23], a[108:111], a[40:43], v[20:23]
    ds_read_b64_tr_b16 a[74:75], v90 offset:24576
    s_waitcnt lgkmcnt(6)
    v_mfma_f32_16x16x32_bf16 v[16:19], a[112:115], a[48:51], v[16:19]
    ds_read_b64_tr_b16 a[76:77], v91 offset:16384
    ds_read_b64_tr_b16 a[78:79], v91 offset:24576
    v_mfma_f32_16x16x32_bf16 v[24:27], a[112:115], a[52:55], v[24:27]
    v_mfma_f32_16x16x32_bf16 v[28:31], a[116:119], a[52:55], v[28:31]
    ds_read_b64_tr_b16 a[80:81], v92 offset:16384
    ds_read_b64_tr_b16 a[82:83], v92 offset:24576
    v_mfma_f32_16x16x32_bf16 v[20:23], a[116:119], a[48:51], v[20:23]
    v_mfma_f32_16x16x32_bf16 v[16:19], a[120:123], a[56:59], v[16:19]
    ds_read_b64_tr_b16 a[84:85], v93 offset:16384
    ds_read_b64_tr_b16 a[86:87], v93 offset:24576
    v_mfma_f32_16x16x32_bf16 v[24:27], a[120:123], a[60:63], v[24:27]
    v_mfma_f32_16x16x32_bf16 v[28:31], a[124:127], a[60:63], v[28:31]
    ds_read_b64_tr_b16 a[88:89], v94 offset:16384
    v_mfma_f32_16x16x32_bf16 v[20:23], a[124:127], a[56:59], v[20:23]
    ds_read_b64_tr_b16 a[90:91], v94 offset:24576
    s_cbranch_vccnz L_tr_L1
L_bk_L1:
    s_waitcnt lgkmcnt(6)
    v_mfma_f32_16x16x32_bf16 v[128:131], a[64:67], v[72:75], v[128:131]
    ds_read_b64_tr_b16 a[92:93], v95 offset:16384
    ds_read_b64_tr_b16 a[94:95], v95 offset:24576
    v_mfma_f32_16x16x32_bf16 v[136:139], a[64:67], v[76:79], v[136:139]
    v_mfma_f32_16x16x32_bf16 v[140:143], a[68:71], v[76:79], v[140:143]
    ds_read_b64_tr_b16 a[96:97], v88 offset:16640
    ds_read_b64_tr_b16 a[98:99], v88 offset:24832
    v_mfma_f32_16x16x32_bf16 v[132:135], a[68:71], v[72:75], v[132:135]
    v_exp_f32 v48, v16
    v_mfma_f32_16x16x32_bf16 v[144:147], a[72:75], v[72:75], v[144:147]
    ds_read_b64_tr_b16 a[100:101], v89 offset:16640
    ds_read_b64_tr_b16 a[102:103], v89 offset:24832
    v_mfma_f32_16x16x32_bf16 v[152:155], a[72:75], v[76:79], v[152:155]
    v_exp_f32 v49, v17
    v_mfma_f32_16x16x32_bf16 v[156:159], a[76:79], v[76:79], v[156:159]
    ds_read_b64_tr_b16 a[104:105], v90 offset:16640
    v_cvt_pk_bf16_f32 v64, v48, v49
    v_mfma_f32_16x16x32_bf16 v[148:151], a[76:79], v[72:75], v[148:151]
    ds_read_b64_tr_b16 a[106:107], v90 offset:24832
    s_waitcnt lgkmcnt(6)
    v_mfma_f32_16x16x32_bf16 v[160:163], a[80:83], v[72:75], v[160:163]
    ds_read_b64_tr_b16 a[108:109], v91 offset:16640
    ds_read_b64_tr_b16 a[110:111], v91 offset:24832
    v_mfma_f32_16x16x32_bf16 v[168:171], a[80:83], v[76:79], v[168:171]
    v_exp_f32 v50, v18
    v_mfma_f32_16x16x32_bf16 v[172:175], a[84:87], v[76:79], v[172:175]
    ds_read_b64_tr_b16 a[112:113], v92 offset:16640
    ds_read_b64_tr_b16 a[114:115], v92 offset:24832
    v_mfma_f32_16x16x32_bf16 v[164:167], a[84:87], v[72:75], v[164:167]
    v_exp_f32 v51, v19
    v_mfma_f32_16x16x32_bf16 v[176:179], a[88:91], v[72:75], v[176:179]
    ds_read_b64_tr_b16 a[116:117], v93 offset:16640
    ds_read_b64_tr_b16 a[118:119], v93 offset:24832
    v_mfma_f32_16x16x32_bf16 v[184:187], a[88:91], v[76:79], v[184:187]
    v_exp_f32 v52, v20
    v_mfma_f32_16x16x32_bf16 v[188:191], a[92:95], v[76:79], v[188:191]
    ds_read_b64_tr_b16 a[120:121], v94 offset:16640
    v_cvt_pk_bf16_f32 v65, v50, v51
    v_mfma_f32_16x16x32_bf16 v[180:183], a[92:95], v[72:75], v[180:183]
    ds_read_b64_tr_b16 a[122:123], v94 offset:24832
    s_waitcnt lgkmcnt(6)
    v_mfma_f32_16x16x32_bf16 v[192:195], a[96:99], v[72:75], v[192:195]
    ds_read_b64_tr_b16 a[124:125], v95 offset:16640
    ds_read_b64_tr_b16 a[126:127], v95 offset:24832
    v_mfma_f32_16x16x32_bf16 v[200:203], a[96:99], v[76:79], v[200:203]
    v_exp_f32 v53, v21
    v_mfma_f32_16x16x32_bf16 v[204:207], a[100:103], v[76:79], v[204:207]
    v_exp_f32 v54, v22
    v_mfma_f32_16x16x32_bf16 v[196:199], a[100:103], v[72:75], v[196:199]
    v_exp_f32 v55, v23
    v_mfma_f32_16x16x32_bf16 v[208:211], a[104:107], v[72:75], v[208:211]
    v_exp_f32 v56, v24
    v_mfma_f32_16x16x32_bf16 v[216:219], a[104:107], v[76:79], v[216:219]
    v_exp_f32 v57, v25
    v_mfma_f32_16x16x32_bf16 v[220:223], a[108:111], v[76:79], v[220:223]
    s_waitcnt lgkmcnt(0)
    s_barrier
    v_mfma_f32_16x16x32_bf16 v[212:215], a[108:111], v[72:75], v[212:215]
    ds_read_b128 a[64:67], v80 offset:0
    ds_read_b128 a[68:71], v80 offset:8192
    v_mfma_f32_16x16x32_bf16 v[224:227], a[112:115], v[72:75], v[224:227]
    ds_read_b128 a[72:75], v81 offset:0
    v_cvt_pk_bf16_f32 v66, v52, v53
    v_mfma_f32_16x16x32_bf16 v[232:235], a[112:115], v[76:79], v[232:235]
    v_exp_f32 v58, v26
    v_mfma_f32_16x16x32_bf16 v[236:239], a[116:119], v[76:79], v[236:239]
    ds_read_b128 a[76:79], v81 offset:8192
    v_cvt_pk_bf16_f32 v67, v54, v55
    v_mfma_f32_16x16x32_bf16 v[228:231], a[116:119], v[72:75], v[228:231]
    v_exp_f32 v59, v27
    v_mfma_f32_16x16x32_bf16 v[240:243], a[120:123], v[72:75], v[240:243]
    ds_read_b128 a[80:83], v82 offset:0
    ds_read_b128 a[84:87], v82 offset:8192
    v_mfma_f32_16x16x32_bf16 v[248:251], a[120:123], v[76:79], v[248:251]
    v_mfma_f32_16x16x32_bf16 v[116:119], a[240:243], v[64:67], v[6:9]
    v_mfma_f32_16x16x32_bf16 v[252:255], a[124:127], v[76:79], v[252:255]
    v_exp_f32 v60, v28
    v_mfma_f32_16x16x32_bf16 v[244:247], a[124:127], v[72:75], v[244:247]
    ds_read_b128 a[88:91], v83 offset:0
    s_waitcnt lgkmcnt(3)
    v_mfma_f32_16x16x32_bf16 v[32:35], a[64:67], a[0:3], v[96:99]
    ds_read_b128 a[92:95], v83 offset:8192
    v_cvt_pk_bf16_f32 v68, v56, v57
    v_mfma_f32_16x16x32_bf16 v[40:43], a[64:67], a[4:7], v[100:103]
    v_exp_f32 v61, v29
    v_mfma_f32_16x16x32_bf16 v[44:47], a[68:71], a[4:7], v[100:103]
    ds_read_b128 a[96:99], v80 offset:256
    ds_read_b128 a[100:103], v80 offset:8448
    v_mfma_f32_16x16x32_bf16 v[36:39], a[68:71], a[0:3], v[96:99]
    v_exp_f32 v62, v30
    v_mfma_f32_16x16x32_bf16 v[32:35], a[72:75], a[8:11], v[32:35]
    ds_read_b128 a[104:107], v81 offset:256
    v_cvt_pk_bf16_f32 v69, v58, v59
    v_mfma_f32_16x16x32_bf16 v[40:43], a[72:75], a[12:15], v[40:43]
    v_exp_f32 v63, v31
    v_mfma_f32_16x16x32_bf16 v[44:47], a[76:79], a[12:15], v[44:47]
    v_cvt_pk_bf16_f32 v70, v60, v61
    v_cvt_pk_bf16_f32 v71, v62, v63
    v_mfma_f32_16x16x32_bf16 v[36:39], a[76:79], a[8:11], v[36:39]
    ds_read_b128 a[108:111], v81 offset:8448
    s_waitcnt lgkmcnt(4)
    v_mfma_f32_16x16x32_bf16 v[32:35], a[80:83], a[16:19], v[32:35]
    ds_read_b128 a[112:115], v82 offset:256
    ds_read_b128 a[116:119], v82 offset:8448
    v_mfma_f32_16x16x32_bf16 v[40:43], a[80:83], a[20:23], v[40:43]
    v_mfma_f32_16x16x32_bf16 v[120:123], a[240:243], v[68:71], v[84:87]
    v_mfma_f32_16x16x32_bf16 v[44:47], a[84:87], a[20:23], v[44:47]
    ds_read_b128 a[120:123], v83 offset:256
    v_mfma_f32_16x16x32_bf16 v[36:39], a[84:87], a[16:19], v[36:39]
    v_mfma_f32_16x16x32_bf16 v[32:35], a[88:91], a[24:27], v[32:35]
    ds_read_b128 a[124:127], v83 offset:8448
    v_mfma_f32_16x16x32_bf16 v[40:43], a[88:91], a[28:31], v[40:43]
    v_mfma_f32_16x16x32_bf16 v[44:47], a[92:95], a[28:31], v[44:47]
    v_mfma_f32_16x16x32_bf16 v[36:39], a[92:95], a[24:27], v[36:39]
    v_max_f32 v1, v116, v120
    s_waitcnt lgkmcnt(4)
    v_mfma_f32_16x16x32_bf16 v[32:35], a[96:99], a[32:35], v[32:35]
    v_cmp_nge_f32 vcc, s61, v1
    v_mfma_f32_16x16x32_bf16 v[40:43], a[96:99], a[36:39], v[40:43]
    v_mfma_f32_16x16x32_bf16 v[44:47], a[100:103], a[36:39], v[44:47]
    ds_read_b64_tr_b16 a[64:65], v88 offset:32768
    ds_read_b64_tr_b16 a[66:67], v88 offset:40960
    v_mfma_f32_16x16x32_bf16 v[36:39], a[100:103], a[32:35], v[36:39]
    v_mfma_f32_16x16x32_bf16 v[32:35], a[104:107], a[40:43], v[32:35]
    ds_read_b64_tr_b16 a[68:69], v89 offset:32768
    ds_read_b64_tr_b16 a[70:71], v89 offset:40960
    v_mfma_f32_16x16x32_bf16 v[40:43], a[104:107], a[44:47], v[40:43]
    v_mfma_f32_16x16x32_bf16 v[44:47], a[108:111], a[44:47], v[44:47]
    ds_read_b64_tr_b16 a[72:73], v90 offset:32768
    v_mfma_f32_16x16x32_bf16 v[36:39], a[108:111], a[40:43], v[36:39]
    ds_read_b64_tr_b16 a[74:75], v90 offset:40960
    s_waitcnt lgkmcnt(6)
    v_mfma_f32_16x16x32_bf16 v[32:35], a[112:115], a[48:51], v[32:35]
    ds_read_b64_tr_b16 a[76:77], v91 offset:32768
    ds_read_b64_tr_b16 a[78:79], v91 offset:40960
    v_mfma_f32_16x16x32_bf16 v[40:43], a[112:115], a[52:55], v[40:43]
    v_mfma_f32_16x16x32_bf16 v[44:47], a[116:119], a[52:55], v[44:47]
    ds_read_b64_tr_b16 a[80:81], v92 offset:32768
    ds_read_b64_tr_b16 a[82:83], v92 offset:40960
    v_mfma_f32_16x16x32_bf16 v[36:39], a[116:119], a[48:51], v[36:39]
    v_mfma_f32_16x16x32_bf16 v[32:35], a[120:123], a[56:59], v[32:35]
    ds_read_b64_tr_b16 a[84:85], v93 offset:32768
    ds_read_b64_tr_b16 a[86:87], v93 offset:40960
    v_mfma_f32_16x16x32_bf16 v[40:43], a[120:123], a[60:63], v[40:43]
    v_mfma_f32_16x16x32_bf16 v[44:47], a[124:127], a[60:63], v[44:47]
    ds_read_b64_tr_b16 a[88:89], v94 offset:32768
    v_mfma_f32_16x16x32_bf16 v[36:39], a[124:127], a[56:59], v[36:39]
    ds_read_b64_tr_b16 a[90:91], v94 offset:40960
    s_cbranch_vccnz L_tr_L2
L_bk_L2:
    s_waitcnt lgkmcnt(6)
    v_mfma_f32_16x16x32_bf16 v[128:131], a[64:67], v[64:67], v[128:131]
    ds_read_b64_tr_b16 a[92:93], v95 offset:32768
    ds_read_b64_tr_b16 a[94:95], v95 offset:40960
    v_mfma_f32_16x16x32_bf16 v[136:139], a[64:67], v[68:71], v[136:139]
    v_mfma_f32_16x16x32_bf16 v[140:143], a[68:71], v[68:71], v[140:143]
    ds_read_b64_tr_b16 a[96:97], v88 offset:33024
    ds_read_b64_tr_b16 a[98:99], v88 offset:41216
    v_mfma_f32_16x16x32_bf16 v[132:135], a[68:71], v[64:67], v[132:135]
    v_exp_f32 v48, v32
    v_mfma_f32_16x16x32_bf16 v[144:147], a[72:75], v[64:67], v[144:147]
    ds_read_b64_tr_b16 a[100:101], v89 offset:33024
    ds_read_b64_tr_b16 a[102:103], v89 offset:41216
    v_mfma_f32_16x16x32_bf16 v[152:155], a[72:75], v[68:71], v[152:155]
    v_exp_f32 v49, v33
    v_mfma_f32_16x16x32_bf16 v[156:159], a[76:79], v[68:71], v[156:159]
    ds_read_b64_tr_b16 a[104:105], v90 offset:33024
    v_cvt_pk_bf16_f32 v72, v48, v49
    v_mfma_f32_16x16x32_bf16 v[148:151], a[76:79], v[64:67], v[148:151]
    ds_read_b64_tr_b16 a[106:107], v90 offset:41216
    s_waitcnt lgkmcnt(6)
    v_mfma_f32_16x16x32_bf16 v[160:163], a[80:83], v[64:67], v[160:163]
    ds_read_b64_tr_b16 a[108:109], v91 offset:33024
    ds_read_b64_tr_b16 a[110:111], v91 offset:41216
    v_mfma_f32_16x16x32_bf16 v[168:171], a[80:83], v[68:71], v[168:171]
    v_exp_f32 v50, v34
    v_mfma_f32_16x16x32_bf16 v[172:175], a[84:87], v[68:71], v[172:175]
    ds_read_b64_tr_b16 a[112:113], v92 offset:33024
    ds_read_b64_tr_b16 a[114:115], v92 offset:41216
    v_mfma_f32_16x16x32_bf16 v[164:167], a[84:87], v[64:67], v[164:167]
    v_exp_f32 v51, v35
    v_mfma_f32_16x16x32_bf16 v[176:179], a[88:91], v[64:67], v[176:179]
    ds_read_b64_tr_b16 a[116:117], v93 offset:33024
    ds_read_b64_tr_b16 a[118:119], v93 offset:41216
    v_mfma_f32_16x16x32_bf16 v[184:187], a[88:91], v[68:71], v[184:187]
    v_exp_f32 v52, v36
    v_mfma_f32_16x16x32_bf16 v[188:191], a[92:95], v[68:71], v[188:191]
    ds_read_b64_tr_b16 a[120:121], v94 offset:33024
    v_cvt_pk_bf16_f32 v73, v50, v51
    v_mfma_f32_16x16x32_bf16 v[180:183], a[92:95], v[64:67], v[180:183]
    ds_read_b64_tr_b16 a[122:123], v94 offset:41216
    s_waitcnt lgkmcnt(6)
    v_mfma_f32_16x16x32_bf16 v[192:195], a[96:99], v[64:67], v[192:195]
    ds_read_b64_tr_b16 a[124:125], v95 offset:33024
    ds_read_b64_tr_b16 a[126:127], v95 offset:41216
    v_mfma_f32_16x16x32_bf16 v[200:203], a[96:99], v[68:71], v[200:203]
    v_exp_f32 v53, v37
    v_mfma_f32_16x16x32_bf16 v[204:207], a[100:103], v[68:71], v[204:207]
    v_exp_f32 v54, v38
    v_mfma_f32_16x16x32_bf16 v[196:199], a[100:103], v[64:67], v[196:199]
    v_exp_f32 v55, v39
    v_mfma_f32_16x16x32_bf16 v[208:211], a[104:107], v[64:67], v[208:211]
    v_exp_f32 v56, v40
    v_mfma_f32_16x16x32_bf16 v[216:219], a[104:107], v[68:71], v[216:219]
    v_exp_f32 v57, v41
    v_mfma_f32_16x16x32_bf16 v[220:223], a[108:111], v[68:71], v[220:223]
    s_waitcnt lgkmcnt(0)
    s_barrier
    v_mfma_f32_16x16x32_bf16 v[212:215], a[108:111], v[64:67], v[212:215]
    ds_read_b128 a[64:67], v80 offset:16384
    ds_read_b128 a[68:71], v80 offset:24576
    v_mfma_f32_16x16x32_bf16 v[224:227], a[112:115], v[64:67], v[224:227]
    ds_read_b128 a[72:75], v81 offset:16384
    v_cvt_pk_bf16_f32 v74, v52, v53
    v_mfma_f32_16x16x32_bf16 v[232:235], a[112:115], v[68:71], v[232:235]
    v_exp_f32 v58, v42
    v_mfma_f32_16x16x32_bf16 v[236:239], a[116:119], v[68:71], v[236:239]
    ds_read_b128 a[76:79], v81 offset:24576
    v_cvt_pk_bf16_f32 v75, v54, v55
    v_mfma_f32_16x16x32_bf16 v[228:231], a[116:119], v[64:67], v[228:231]
    v_exp_f32 v59, v43
    v_mfma_f32_16x16x32_bf16 v[240:243], a[120:123], v[64:67], v[240:243]
    ds_read_b128 a[80:83], v82 offset:16384
    ds_read_b128 a[84:87], v82 offset:24576
    v_mfma_f32_16x16x32_bf16 v[248:251], a[120:123], v[68:71], v[248:251]
    v_mfma_f32_16x16x32_bf16 v[6:9], a[240:243], v[72:75], v[116:119]
    v_mfma_f32_16x16x32_bf16 v[252:255], a[124:127], v[68:71], v[252:255]
    v_exp_f32 v60, v44
    v_mfma_f32_16x16x32_bf16 v[244:247], a[124:127], v[64:67], v[244:247]
    ds_read_b128 a[88:91], v83 offset:16384
    s_waitcnt lgkmcnt(3)
    v_mfma_f32_16x16x32_bf16 v[16:19], a[64:67], a[0:3], v[96:99]
    ds_read_b128 a[92:95], v83 offset:24576
    v_cvt_pk_bf16_f32 v76, v56, v57
    v_mfma_f32_16x16x32_bf16 v[24:27], a[64:67], a[4:7], v[100:103]
    v_exp_f32 v61, v45
    v_mfma_f32_16x16x32_bf16 v[28:31], a[68:71], a[4:7], v[100:103]
    ds_read_b128 a[96:99], v80 offset:16640
    ds_read_b128 a[100:103], v80 offset:24832
    v_mfma_f32_16x16x32_bf16 v[20:23], a[68:71], a[0:3], v[96:99]
    v_exp_f32 v62, v46
    v_mfma_f32_16x16x32_bf16 v[16:19], a[72:75], a[8:11], v[16:19]
    ds_read_b128 a[104:107], v81 offset:16640
    v_cvt_pk_bf16_f32 v77, v58, v59
    v_mfma_f32_16x16x32_bf16 v[24:27], a[72:75], a[12:15], v[24:27]
    v_exp_f32 v63, v47
    v_mfma_f32_16x16x32_bf16 v[28:31], a[76:79], a[12:15], v[28:31]
    v_cvt_pk_bf16_f32 v78, v60, v61
    v_cvt_pk_bf16_f32 v79, v62, v63
    v_mfma_f32_16x16x32_bf16 v[20:23], a[76:79], a[8:11], v[20:23]
    ds_read_b128 a[108:111], v81 offset:24832
    s_waitcnt lgkmcnt(4)
    v_mfma_f32_16x16x32_bf16 v[16:19], a[80:83], a[16:19], v[16:19]
    ds_read_b128 a[112:115], v82 offset:16640
    ds_read_b128 a[116:119], v82 offset:24832
    v_mfma_f32_16x16x32_bf16 v[24:27], a[80:83], a[20:23], v[24:27]
    v_mfma_f32_16x16x32_bf16 v[84:87], a[240:243], v[76:79], v[120:123]
    v_mfma_f32_16x16x32_bf16 v[28:31], a[84:87], a[20:23], v[28:31]
    ds_read_b128 a[120:123], v83 offset:16640
    v_mfma_f32_16x16x32_bf16 v[20:23], a[84:87], a[16:19], v[20:23]
    v_mfma_f32_16x16x32_bf16 v[16:19], a[88:91], a[24:27], v[16:19]
    ds_read_b128 a[124:127], v83 offset:24832
    v_mfma_f32_16x16x32_bf16 v[24:27], a[88:91], a[28:31], v[24:27]
    v_mfma_f32_16x16x32_bf16 v[28:31], a[92:95], a[28:31], v[28:31]
    v_mfma_f32_16x16x32_bf16 v[20:23], a[92:95], a[24:27], v[20:23]
    v_max_f32 v1, v6, v84
    s_waitcnt lgkmcnt(4)
    v_mfma_f32_16x16x32_bf16 v[16:19], a[96:99], a[32:35], v[16:19]
    v_cmp_nge_f32 vcc, s61, v1
    v_mfma_f32_16x16x32_bf16 v[24:27], a[96:99], a[36:39], v[24:27]
    v_mfma_f32_16x16x32_bf16 v[28:31], a[100:103], a[36:39], v[28:31]
    ds_read_b64_tr_b16 a[64:65], v88 offset:0
    ds_read_b64_tr_b16 a[66:67], v88 offset:8192
    v_mfma_f32_16x16x32_bf16 v[20:23], a[100:103], a[32:35], v[20:23]
    v_mfma_f32_16x16x32_bf16 v[16:19], a[104:107], a[40:43], v[16:19]
    ds_read_b64_tr_b16 a[68:69], v89 offset:0
    ds_read_b64_tr_b16 a[70:71], v89 offset:8192
    v_mfma_f32_16x16x32_bf16 v[24:27], a[104:107], a[44:47], v[24:27]
    v_mfma_f32_16x16x32_bf16 v[28:31], a[108:111], a[44:47], v[28:31]
    ds_read_b64_tr_b16 a[72:73], v90 offset:0
    v_mfma_f32_16x16x32_bf16 v[20:23], a[108:111], a[40:43], v[20:23]
    ds_read_b64_tr_b16 a[74:75], v90 offset:8192
    s_waitcnt lgkmcnt(6)
    v_mfma_f32_16x16x32_bf16 v[16:19], a[112:115], a[48:51], v[16:19]
    ds_read_b64_tr_b16 a[76:77], v91 offset:0
    ds_read_b64_tr_b16 a[78:79], v91 offset:8192
    v_mfma_f32_16x16x32_bf16 v[24:27], a[112:115], a[52:55], v[24:27]
    v_mfma_f32_16x16x32_bf16 v[28:31], a[116:119], a[52:55], v[28:31]
    ds_read_b64_tr_b16 a[80:81], v92 offset:0
    ds_read_b64_tr_b16 a[82:83], v92 offset:8192
    v_mfma_f32_16x16x32_bf16 v[20:23], a[116:119], a[48:51], v[20:23]
    v_mfma_f32_16x16x32_bf16 v[16:19], a[120:123], a[56:59], v[16:19]
    ds_read_b64_tr_b16 a[84:85], v93 offset:0
    ds_read_b64_tr_b16 a[86:87], v93 offset:8192
    v_mfma_f32_16x16x32_bf16 v[24:27], a[120:123], a[60:63], v[24:27]
    v_mfma_f32_16x16x32_bf16 v[28:31], a[124:127], a[60:63], v[28:31]
    ds_read_b64_tr_b16 a[88:89], v94 offset:0
    v_mfma_f32_16x16x32_bf16 v[20:23], a[124:127], a[56:59], v[20:23]
    ds_read_b64_tr_b16 a[90:91], v94 offset:8192
    s_cbranch_vccnz L_tr_L3
L_bk_L3:
    s_waitcnt lgkmcnt(6)
    v_mfma_f32_16x16x32_bf16 v[128:131], a[64:67], v[72:75], v[128:131]
    ds_read_b64_tr_b16 a[92:93], v95 offset:0
    ds_read_b64_tr_b16 a[94:95], v95 offset:8192
    v_mfma_f32_16x16x32_bf16 v[136:139], a[64:67], v[76:79], v[136:139]
    v_mfma_f32_16x16x32_bf16 v[140:143], a[68:71], v[76:79], v[140:143]
    ds_read_b64_tr_b16 a[96:97], v88 offset:256
    ds_read_b64_tr_b16 a[98:99], v88 offset:8448
    v_mfma_f32_16x16x32_bf16 v[132:135], a[68:71], v[72:75], v[132:135]
    v_exp_f32 v48, v16
    v_mfma_f32_16x16x32_bf16 v[144:147], a[72:75], v[72:75], v[144:147]
    ds_read_b64_tr_b16 a[100:101], v89 offset:256
    ds_read_b64_tr_b16 a[102:103], v89 offset:8448
    v_mfma_f32_16x16x32_bf16 v[152:155], a[72:75], v[76:79], v[152:155]
    v_exp_f32 v49, v17
    v_mfma_f32_16x16x32_bf16 v[156:159], a[76:79], v[76:79], v[156:159]
    ds_read_b64_tr_b16 a[104:105], v90 offset:256
    v_cvt_pk_bf16_f32 v64, v48, v49
    v_mfma_f32_16x16x32_bf16 v[148:151], a[76:79], v[72:75], v[148:151]
    ds_read_b64_tr_b16 a[106:107], v90 offset:8448
    s_waitcnt lgkmcnt(6)
    v_mfma_f32_16x16x32_bf16 v[160:163], a[80:83], v[72:75], v[160:163]
    ds_read_b64_tr_b16 a[108:109], v91 offset:256
    ds_read_b64_tr_b16 a[110:111], v91 offset:8448
    v_mfma_f32_16x16x32_bf16 v[168:171], a[80:83], v[76:79], v[168:171]
    v_exp_f32 v50, v18
    v_mfma_f32_16x16x32_bf16 v[172:175], a[84:87], v[76:79], v[172:175]
    ds_read_b64_tr_b16 a[112:113], v92 offset:256
    ds_read_b64_tr_b16 a[114:115], v92 offset:8448
    v_mfma_f32_16x16x32_bf16 v[164:167], a[84:87], v[72:75], v[164:167]
    v_exp_f32 v51, v19
    v_mfma_f32_16x16x32_bf16 v[176:179], a[88:91], v[72:75], v[176:179]
    ds_read_b64_tr_b16 a[116:117], v93 offset:256
    ds_read_b64_tr_b16 a[118:119], v93 offset:8448
    v_mfma_f32_16x16x32_bf16 v[184:187], a[88:91], v[76:79], v[184:187]
    v_exp_f32 v52, v20
    v_mfma_f32_16x16x32_bf16 v[188:191], a[92:95], v[76:79], v[188:191]
    ds_read_b64_tr_b16 a[120:121], v94 offset:256
    v_cvt_pk_bf16_f32 v65, v50, v51
    v_mfma_f32_16x16x32_bf16 v[180:183], a[92:95], v[72:75], v[180:183]
    ds_read_b64_tr_b16 a[122:123], v94 offset:8448
    s_waitcnt lgkmcnt(6)
    v_mfma_f32_16x16x32_bf16 v[192:195], a[96:99], v[72:75], v[192:195]
    ds_read_b64_tr_b16 a[124:125], v95 offset:256
    ds_read_b64_tr_b16 a[126:127], v95 offset:8448
    v_mfma_f32_16x16x32_bf16 v[200:203], a[96:99], v[76:79], v[200:203]
    v_exp_f32 v53, v21
    v_mfma_f32_16x16x32_bf16 v[204:207], a[100:103], v[76:79], v[204:207]
    v_exp_f32 v54, v22
    v_mfma_f32_16x16x32_bf16 v[196:199], a[100:103], v[72:75], v[196:199]
    v_exp_f32 v55, v23
    v_mfma_f32_16x16x32_bf16 v[208:211], a[104:107], v[72:75], v[208:211]
    v_exp_f32 v56, v24
    v_mfma_f32_16x16x32_bf16 v[216:219], a[104:107], v[76:79], v[216:219]
    v_exp_f32 v57, v25
    v_mfma_f32_16x16x32_bf16 v[220:223], a[108:111], v[76:79], v[220:223]
    s_waitcnt lgkmcnt(0)
    s_barrier
    v_mfma_f32_16x16x32_bf16 v[212:215], a[108:111], v[72:75], v[212:215]
    ds_read_b128 a[64:67], v80 offset:32768
    ds_read_b128 a[68:71], v80 offset:40960
    v_mfma_f32_16x16x32_bf16 v[224:227], a[112:115], v[72:75], v[224:227]
    ds_read_b128 a[72:75], v81 offset:32768
    v_cvt_pk_bf16_f32 v66, v52, v53
    v_mfma_f32_16x16x32_bf16 v[232:235], a[112:115], v[76:79], v[232:235]
    v_exp_f32 v58, v26
    v_mfma_f32_16x16x32_bf16 v[236:239], a[116:119], v[76:79], v[236:239]
    ds_read_b128 a[76:79], v81 offset:40960
    v_cvt_pk_bf16_f32 v67, v54, v55
    v_mfma_f32_16x16x32_bf16 v[228:231], a[116:119], v[72:75], v[228:231]
    v_exp_f32 v59, v27
    v_mfma_f32_16x16x32_bf16 v[240:243], a[120:123], v[72:75], v[240:243]
    ds_read_b128 a[80:83], v82 offset:32768
    ds_read_b128 a[84:87], v82 offset:40960
    v_mfma_f32_16x16x32_bf16 v[248:251], a[120:123], v[76:79], v[248:251]
    v_mfma_f32_16x16x32_bf16 v[116:119], a[240:243], v[64:67], v[6:9]
    v_mfma_f32_16x16x32_bf16 v[252:255], a[124:127], v[76:79], v[252:255]
    v_exp_f32 v60, v28
    v_mfma_f32_16x16x32_bf16 v[244:247], a[124:127], v[72:75], v[244:247]
    ds_read_b128 a[88:91], v83 offset:32768
    s_waitcnt lgkmcnt(3)
    v_mfma_f32_16x16x32_bf16 v[32:35], a[64:67], a[0:3], v[96:99]
    ds_read_b128 a[92:95], v83 offset:40960
    v_cvt_pk_bf16_f32 v68, v56, v57
    v_mfma_f32_16x16x32_bf16 v[40:43], a[64:67], a[4:7], v[100:103]
    v_exp_f32 v61, v29
    v_mfma_f32_16x16x32_bf16 v[44:47], a[68:71], a[4:7], v[100:103]
    ds_read_b128 a[96:99], v80 offset:33024
    ds_read_b128 a[100:103], v80 offset:41216
    v_mfma_f32_16x16x32_bf16 v[36:39], a[68:71], a[0:3], v[96:99]
    v_exp_f32 v62, v30
    v_mfma_f32_16x16x32_bf16 v[32:35], a[72:75], a[8:11], v[32:35]
    ds_read_b128 a[104:107], v81 offset:33024
    v_cvt_pk_bf16_f32 v69, v58, v59
    v_mfma_f32_16x16x32_bf16 v[40:43], a[72:75], a[12:15], v[40:43]
    v_exp_f32 v63, v31
    v_mfma_f32_16x16x32_bf16 v[44:47], a[76:79], a[12:15], v[44:47]
    v_cvt_pk_bf16_f32 v70, v60, v61
    v_cvt_pk_bf16_f32 v71, v62, v63
    v_mfma_f32_16x16x32_bf16 v[36:39], a[76:79], a[8:11], v[36:39]
    ds_read_b128 a[108:111], v81 offset:41216
    s_waitcnt lgkmcnt(4)
    v_mfma_f32_16x16x32_bf16 v[32:35], a[80:83], a[16:19], v[32:35]
    ds_read_b128 a[112:115], v82 offset:33024
    ds_read_b128 a[116:119], v82 offset:41216
    v_mfma_f32_16x16x32_bf16 v[40:43], a[80:83], a[20:23], v[40:43]
    v_mfma_f32_16x16x32_bf16 v[120:123], a[240:243], v[68:71], v[84:87]
    v_mfma_f32_16x16x32_bf16 v[44:47], a[84:87], a[20:23], v[44:47]
    ds_read_b128 a[120:123], v83 offset:33024
    v_mfma_f32_16x16x32_bf16 v[36:39], a[84:87], a[16:19], v[36:39]
    v_mfma_f32_16x16x32_bf16 v[32:35], a[88:91], a[24:27], v[32:35]
    ds_read_b128 a[124:127], v83 offset:41216
    v_mfma_f32_16x16x32_bf16 v[40:43], a[88:91], a[28:31], v[40:43]
    v_mfma_f32_16x16x32_bf16 v[44:47], a[92:95], a[28:31], v[44:47]
    v_mfma_f32_16x16x32_bf16 v[36:39], a[92:95], a[24:27], v[36:39]
    v_max_f32 v1, v116, v120
    s_waitcnt lgkmcnt(4)
    v_mfma_f32_16x16x32_bf16 v[32:35], a[96:99], a[32:35], v[32:35]
    v_cmp_nge_f32 vcc, s61, v1
    v_mfma_f32_16x16x32_bf16 v[40:43], a[96:99], a[36:39], v[40:43]
    v_mfma_f32_16x16x32_bf16 v[44:47], a[100:103], a[36:39], v[44:47]
    ds_read_b64_tr_b16 a[64:65], v88 offset:16384
    ds_read_b64_tr_b16 a[66:67], v88 offset:24576
    v_mfma_f32_16x16x32_bf16 v[36:39], a[100:103], a[32:35], v[36:39]
    v_mfma_f32_16x16x32_bf16 v[32:35], a[104:107], a[40:43], v[32:35]
    ds_read_b64_tr_b16 a[68:69], v89 offset:16384
    ds_read_b64_tr_b16 a[70:71], v89 offset:24576
    v_mfma_f32_16x16x32_bf16 v[40:43], a[104:107], a[44:47], v[40:43]
    v_mfma_f32_16x16x32_bf16 v[44:47], a[108:111], a[44:47], v[44:47]
    ds_read_b64_tr_b16 a[72:73], v90 offset:16384
    v_mfma_f32_16x16x32_bf16 v[36:39], a[108:111], a[40:43], v[36:39]
    ds_read_b64_tr_b16 a[74:75], v90 offset:24576
    s_waitcnt lgkmcnt(6)
    v_mfma_f32_16x16x32_bf16 v[32:35], a[112:115], a[48:51], v[32:35]
    ds_read_b64_tr_b16 a[76:77], v91 offset:16384
    ds_read_b64_tr_b16 a[78:79], v91 offset:24576
    v_mfma_f32_16x16x32_bf16 v[40:43], a[112:115], a[52:55], v[40:43]
    v_mfma_f32_16x16x32_bf16 v[44:47], a[116:119], a[52:55], v[44:47]
    ds_read_b64_tr_b16 a[80:81], v92 offset:16384
    ds_read_b64_tr_b16 a[82:83], v92 offset:24576
    v_mfma_f32_16x16x32_bf16 v[36:39], a[116:119], a[48:51], v[36:39]
    v_mfma_f32_16x16x32_bf16 v[32:35], a[120:123], a[56:59], v[32:35]
    ds_read_b64_tr_b16 a[84:85], v93 offset:16384
    ds_read_b64_tr_b16 a[86:87], v93 offset:24576
    v_mfma_f32_16x16x32_bf16 v[40:43], a[120:123], a[60:63], v[40:43]
    v_mfma_f32_16x16x32_bf16 v[44:47], a[124:127], a[60:63], v[44:47]
    ds_read_b64_tr_b16 a[88:89], v94 offset:16384
    v_mfma_f32_16x16x32_bf16 v[36:39], a[124:127], a[56:59], v[36:39]
    ds_read_b64_tr_b16 a[90:91], v94 offset:24576
    s_cbranch_vccnz L_tr_L4
L_bk_L4:
    s_waitcnt lgkmcnt(6)
    v_mfma_f32_16x16x32_bf16 v[128:131], a[64:67], v[64:67], v[128:131]
    ds_read_b64_tr_b16 a[92:93], v95 offset:16384
    ds_read_b64_tr_b16 a[94:95], v95 offset:24576
    v_mfma_f32_16x16x32_bf16 v[136:139], a[64:67], v[68:71], v[136:139]
    v_mfma_f32_16x16x32_bf16 v[140:143], a[68:71], v[68:71], v[140:143]
    ds_read_b64_tr_b16 a[96:97], v88 offset:16640
    ds_read_b64_tr_b16 a[98:99], v88 offset:24832
    v_mfma_f32_16x16x32_bf16 v[132:135], a[68:71], v[64:67], v[132:135]
    v_exp_f32 v48, v32
    v_mfma_f32_16x16x32_bf16 v[144:147], a[72:75], v[64:67], v[144:147]
    ds_read_b64_tr_b16 a[100:101], v89 offset:16640
    ds_read_b64_tr_b16 a[102:103], v89 offset:24832
    v_mfma_f32_16x16x32_bf16 v[152:155], a[72:75], v[68:71], v[152:155]
    v_exp_f32 v49, v33
    v_mfma_f32_16x16x32_bf16 v[156:159], a[76:79], v[68:71], v[156:159]
    ds_read_b64_tr_b16 a[104:105], v90 offset:16640
    v_cvt_pk_bf16_f32 v72, v48, v49
    v_mfma_f32_16x16x32_bf16 v[148:151], a[76:79], v[64:67], v[148:151]
    ds_read_b64_tr_b16 a[106:107], v90 offset:24832
    s_waitcnt lgkmcnt(6)
    v_mfma_f32_16x16x32_bf16 v[160:163], a[80:83], v[64:67], v[160:163]
    ds_read_b64_tr_b16 a[108:109], v91 offset:16640
    ds_read_b64_tr_b16 a[110:111], v91 offset:24832
    v_mfma_f32_16x16x32_bf16 v[168:171], a[80:83], v[68:71], v[168:171]
    v_exp_f32 v50, v34
    v_mfma_f32_16x16x32_bf16 v[172:175], a[84:87], v[68:71], v[172:175]
    ds_read_b64_tr_b16 a[112:113], v92 offset:16640
    ds_read_b64_tr_b16 a[114:115], v92 offset:24832
    v_mfma_f32_16x16x32_bf16 v[164:167], a[84:87], v[64:67], v[164:167]
    v_exp_f32 v51, v35
    v_mfma_f32_16x16x32_bf16 v[176:179], a[88:91], v[64:67], v[176:179]
    ds_read_b64_tr_b16 a[116:117], v93 offset:16640
    ds_read_b64_tr_b16 a[118:119], v93 offset:24832
    v_mfma_f32_16x16x32_bf16 v[184:187], a[88:91], v[68:71], v[184:187]
    v_exp_f32 v52, v36
    v_mfma_f32_16x16x32_bf16 v[188:191], a[92:95], v[68:71], v[188:191]
    ds_read_b64_tr_b16 a[120:121], v94 offset:16640
    v_cvt_pk_bf16_f32 v73, v50, v51
    v_mfma_f32_16x16x32_bf16 v[180:183], a[92:95], v[64:67], v[180:183]
    ds_read_b64_tr_b16 a[122:123], v94 offset:24832
    s_waitcnt lgkmcnt(6)
    v_mfma_f32_16x16x32_bf16 v[192:195], a[96:99], v[64:67], v[192:195]
    ds_read_b64_tr_b16 a[124:125], v95 offset:16640
    ds_read_b64_tr_b16 a[126:127], v95 offset:24832
    v_mfma_f32_16x16x32_bf16 v[200:203], a[96:99], v[68:71], v[200:203]
    v_exp_f32 v53, v37
    v_mfma_f32_16x16x32_bf16 v[204:207], a[100:103], v[68:71], v[204:207]
    v_exp_f32 v54, v38
    v_mfma_f32_16x16x32_bf16 v[196:199], a[100:103], v[64:67], v[196:199]
    v_exp_f32 v55, v39
    v_mfma_f32_16x16x32_bf16 v[208:211], a[104:107], v[64:67], v[208:211]
    v_exp_f32 v56, v40
    v_mfma_f32_16x16x32_bf16 v[216:219], a[104:107], v[68:71], v[216:219]
    v_exp_f32 v57, v41
    v_mfma_f32_16x16x32_bf16 v[220:223], a[108:111], v[68:71], v[220:223]
    s_waitcnt lgkmcnt(0)
    s_barrier
    v_mfma_f32_16x16x32_bf16 v[212:215], a[108:111], v[64:67], v[212:215]
    ds_read_b128 a[64:67], v80 offset:0
    ds_read_b128 a[68:71], v80 offset:8192
    v_mfma_f32_16x16x32_bf16 v[224:227], a[112:115], v[64:67], v[224:227]
    ds_read_b128 a[72:75], v81 offset:0
    v_cvt_pk_bf16_f32 v74, v52, v53
    v_mfma_f32_16x16x32_bf16 v[232:235], a[112:115], v[68:71], v[232:235]
    v_exp_f32 v58, v42
    v_mfma_f32_16x16x32_bf16 v[236:239], a[116:119], v[68:71], v[236:239]
    ds_read_b128 a[76:79], v81 offset:8192
    v_cvt_pk_bf16_f32 v75, v54, v55
    v_mfma_f32_16x16x32_bf16 v[228:231], a[116:119], v[64:67], v[228:231]
    v_exp_f32 v59, v43
    v_mfma_f32_16x16x32_bf16 v[240:243], a[120:123], v[64:67], v[240:243]
    ds_read_b128 a[80:83], v82 offset:0
    ds_read_b128 a[84:87], v82 offset:8192
    v_mfma_f32_16x16x32_bf16 v[248:251], a[120:123], v[68:71], v[248:251]
    v_mfma_f32_16x16x32_bf16 v[6:9], a[240:243], v[72:75], v[116:119]
    v_mfma_f32_16x16x32_bf16 v[252:255], a[124:127], v[68:71], v[252:255]
    v_exp_f32 v60, v44
    v_mfma_f32_16x16x32_bf16 v[244:247], a[124:127], v[64:67], v[244:247]
    ds_read_b128 a[88:91], v83 offset:0
    s_waitcnt lgkmcnt(3)
    v_mfma_f32_16x16x32_bf16 v[16:19], a[64:67], a[0:3], v[96:99]
    ds_read_b128 a[92:95], v83 offset:8192
    v_cvt_pk_bf16_f32 v76, v56, v57
    v_mfma_f32_16x16x32_bf16 v[24:27], a[64:67], a[4:7], v[100:103]
    v_exp_f32 v61, v45
    v_mfma_f32_16x16x32_bf16 v[28:31], a[68:71], a[4:7], v[100:103]
    ds_read_b128 a[96:99], v80 offset:256
    ds_read_b128 a[100:103], v80 offset:8448
    v_mfma_f32_16x16x32_bf16 v[20:23], a[68:71], a[0:3], v[96:99]
    v_exp_f32 v62, v46
    v_mfma_f32_16x16x32_bf16 v[16:19], a[72:75], a[8:11], v[16:19]
    ds_read_b128 a[104:107], v81 offset:256
    v_cvt_pk_bf16_f32 v77, v58, v59
    v_mfma_f32_16x16x32_bf16 v[24:27], a[72:75], a[12:15], v[24:27]
    v_exp_f32 v63, v47
    v_mfma_f32_16x16x32_bf16 v[28:31], a[76:79], a[12:15], v[28:31]
    v_cvt_pk_bf16_f32 v78, v60, v61
    v_cvt_pk_bf16_f32 v79, v62, v63
    v_mfma_f32_16x16x32_bf16 v[20:23], a[76:79], a[8:11], v[20:23]
    ds_read_b128 a[108:111], v81 offset:8448
    s_waitcnt lgkmcnt(4)
    v_mfma_f32_16x16x32_bf16 v[16:19], a[80:83], a[16:19], v[16:19]
    ds_read_b128 a[112:115], v82 offset:256
    ds_read_b128 a[116:119], v82 offset:8448
    v_mfma_f32_16x16x32_bf16 v[24:27], a[80:83], a[20:23], v[24:27]
    v_mfma_f32_16x16x32_bf16 v[84:87], a[240:243], v[76:79], v[120:123]
    v_mfma_f32_16x16x32_bf16 v[28:31], a[84:87], a[20:23], v[28:31]
    ds_read_b128 a[120:123], v83 offset:256
    v_mfma_f32_16x16x32_bf16 v[20:23], a[84:87], a[16:19], v[20:23]
    v_mfma_f32_16x16x32_bf16 v[16:19], a[88:91], a[24:27], v[16:19]
    ds_read_b128 a[124:127], v83 offset:8448
    v_mfma_f32_16x16x32_bf16 v[24:27], a[88:91], a[28:31], v[24:27]
    v_mfma_f32_16x16x32_bf16 v[28:31], a[92:95], a[28:31], v[28:31]
    v_mfma_f32_16x16x32_bf16 v[20:23], a[92:95], a[24:27], v[20:23]
    v_max_f32 v1, v6, v84
    s_waitcnt lgkmcnt(4)
    v_mfma_f32_16x16x32_bf16 v[16:19], a[96:99], a[32:35], v[16:19]
    v_cmp_nge_f32 vcc, s61, v1
    v_mfma_f32_16x16x32_bf16 v[24:27], a[96:99], a[36:39], v[24:27]
    v_mfma_f32_16x16x32_bf16 v[28:31], a[100:103], a[36:39], v[28:31]
    ds_read_b64_tr_b16 a[64:65], v88 offset:32768
    ds_read_b64_tr_b16 a[66:67], v88 offset:40960
    v_mfma_f32_16x16x32_bf16 v[20:23], a[100:103], a[32:35], v[20:23]
    v_mfma_f32_16x16x32_bf16 v[16:19], a[104:107], a[40:43], v[16:19]
    ds_read_b64_tr_b16 a[68:69], v89 offset:32768
    ds_read_b64_tr_b16 a[70:71], v89 offset:40960
    v_mfma_f32_16x16x32_bf16 v[24:27], a[104:107], a[44:47], v[24:27]
    v_mfma_f32_16x16x32_bf16 v[28:31], a[108:111], a[44:47], v[28:31]
    ds_read_b64_tr_b16 a[72:73], v90 offset:32768
    v_mfma_f32_16x16x32_bf16 v[20:23], a[108:111], a[40:43], v[20:23]
    ds_read_b64_tr_b16 a[74:75], v90 offset:40960
    s_waitcnt lgkmcnt(6)
    v_mfma_f32_16x16x32_bf16 v[16:19], a[112:115], a[48:51], v[16:19]
    ds_read_b64_tr_b16 a[76:77], v91 offset:32768
    ds_read_b64_tr_b16 a[78:79], v91 offset:40960
    v_mfma_f32_16x16x32_bf16 v[24:27], a[112:115], a[52:55], v[24:27]
    v_mfma_f32_16x16x32_bf16 v[28:31], a[116:119], a[52:55], v[28:31]
    ds_read_b64_tr_b16 a[80:81], v92 offset:32768
    ds_read_b64_tr_b16 a[82:83], v92 offset:40960
    v_mfma_f32_16x16x32_bf16 v[20:23], a[116:119], a[48:51], v[20:23]
    v_mfma_f32_16x16x32_bf16 v[16:19], a[120:123], a[56:59], v[16:19]
    ds_read_b64_tr_b16 a[84:85], v93 offset:32768
    ds_read_b64_tr_b16 a[86:87], v93 offset:40960
    v_mfma_f32_16x16x32_bf16 v[24:27], a[120:123], a[60:63], v[24:27]
    v_mfma_f32_16x16x32_bf16 v[28:31], a[124:127], a[60:63], v[28:31]
    ds_read_b64_tr_b16 a[88:89], v94 offset:32768
    v_mfma_f32_16x16x32_bf16 v[20:23], a[124:127], a[56:59], v[20:23]
    ds_read_b64_tr_b16 a[90:91], v94 offset:40960
    s_cbranch_vccnz L_tr_L5
L_bk_L5:
    s_waitcnt lgkmcnt(6)
    v_mfma_f32_16x16x32_bf16 v[128:131], a[64:67], v[72:75], v[128:131]
    ds_read_b64_tr_b16 a[92:93], v95 offset:32768
    ds_read_b64_tr_b16 a[94:95], v95 offset:40960
    v_mfma_f32_16x16x32_bf16 v[136:139], a[64:67], v[76:79], v[136:139]
    v_mfma_f32_16x16x32_bf16 v[140:143], a[68:71], v[76:79], v[140:143]
    ds_read_b64_tr_b16 a[96:97], v88 offset:33024
    ds_read_b64_tr_b16 a[98:99], v88 offset:41216
    v_mfma_f32_16x16x32_bf16 v[132:135], a[68:71], v[72:75], v[132:135]
    v_exp_f32 v48, v16
    v_mfma_f32_16x16x32_bf16 v[144:147], a[72:75], v[72:75], v[144:147]
    ds_read_b64_tr_b16 a[100:101], v89 offset:33024
    ds_read_b64_tr_b16 a[102:103], v89 offset:41216
    v_mfma_f32_16x16x32_bf16 v[152:155], a[72:75], v[76:79], v[152:155]
    v_exp_f32 v49, v17
    v_mfma_f32_16x16x32_bf16 v[156:159], a[76:79], v[76:79], v[156:159]
    ds_read_b64_tr_b16 a[104:105], v90 offset:33024
    v_cvt_pk_bf16_f32 v64, v48, v49
    v_mfma_f32_16x16x32_bf16 v[148:151], a[76:79], v[72:75], v[148:151]
    ds_read_b64_tr_b16 a[106:107], v90 offset:41216
    s_waitcnt lgkmcnt(6)
    v_mfma_f32_16x16x32_bf16 v[160:163], a[80:83], v[72:75], v[160:163]
    ds_read_b64_tr_b16 a[108:109], v91 offset:33024
    ds_read_b64_tr_b16 a[110:111], v91 offset:41216
    v_mfma_f32_16x16x32_bf16 v[168:171], a[80:83], v[76:79], v[168:171]
    v_exp_f32 v50, v18
    v_mfma_f32_16x16x32_bf16 v[172:175], a[84:87], v[76:79], v[172:175]
    ds_read_b64_tr_b16 a[112:113], v92 offset:33024
    ds_read_b64_tr_b16 a[114:115], v92 offset:41216
    v_mfma_f32_16x16x32_bf16 v[164:167], a[84:87], v[72:75], v[164:167]
    v_exp_f32 v51, v19
    v_mfma_f32_16x16x32_bf16 v[176:179], a[88:91], v[72:75], v[176:179]
    ds_read_b64_tr_b16 a[116:117], v93 offset:33024
    ds_read_b64_tr_b16 a[118:119], v93 offset:41216
    v_mfma_f32_16x16x32_bf16 v[184:187], a[88:91], v[76:79], v[184:187]
    v_exp_f32 v52, v20
    v_mfma_f32_16x16x32_bf16 v[188:191], a[92:95], v[76:79], v[188:191]
    ds_read_b64_tr_b16 a[120:121], v94 offset:33024
    v_cvt_pk_bf16_f32 v65, v50, v51
    v_mfma_f32_16x16x32_bf16 v[180:183], a[92:95], v[72:75], v[180:183]
    ds_read_b64_tr_b16 a[122:123], v94 offset:41216
    s_waitcnt lgkmcnt(6)
    v_mfma_f32_16x16x32_bf16 v[192:195], a[96:99], v[72:75], v[192:195]
    ds_read_b64_tr_b16 a[124:125], v95 offset:33024
    ds_read_b64_tr_b16 a[126:127], v95 offset:41216
    v_mfma_f32_16x16x32_bf16 v[200:203], a[96:99], v[76:79], v[200:203]
    v_exp_f32 v53, v21
    v_mfma_f32_16x16x32_bf16 v[204:207], a[100:103], v[76:79], v[204:207]
    v_exp_f32 v54, v22
    v_mfma_f32_16x16x32_bf16 v[196:199], a[100:103], v[72:75], v[196:199]
    s_sub_u32 s62, s62, 1
    v_cvt_pk_bf16_f32 v66, v52, v53
    v_mfma_f32_16x16x32_bf16 v[208:211], a[104:107], v[72:75], v[208:211]
    v_exp_f32 v55, v23
    v_mfma_f32_16x16x32_bf16 v[216:219], a[104:107], v[76:79], v[216:219]
    v_exp_f32 v56, v24
    v_mfma_f32_16x16x32_bf16 v[220:223], a[108:111], v[76:79], v[220:223]
    s_waitcnt lgkmcnt(0)
    s_barrier
    v_mfma_f32_16x16x32_bf16 v[212:215], a[108:111], v[72:75], v[212:215]
    ds_read_b128 a[64:67], v80 offset:16384
    ds_read_b128 a[68:71], v80 offset:24576
    v_mfma_f32_16x16x32_bf16 v[224:227], a[112:115], v[72:75], v[224:227]
    ds_read_b128 a[72:75], v81 offset:16384
    v_cvt_pk_bf16_f32 v67, v54, v55
    v_mfma_f32_16x16x32_bf16 v[232:235], a[112:115], v[76:79], v[232:235]
    v_exp_f32 v57, v25
    v_mfma_f32_16x16x32_bf16 v[236:239], a[116:119], v[76:79], v[236:239]
    ds_read_b128 a[76:79], v81 offset:24576
    v_cvt_pk_bf16_f32 v68, v56, v57
    v_mfma_f32_16x16x32_bf16 v[228:231], a[116:119], v[72:75], v[228:231]
    v_mfma_f32_16x16x32_bf16 v[116:119], a[240:243], v[64:67], v[6:9]
    v_mfma_f32_16x16x32_bf16 v[240:243], a[120:123], v[72:75], v[240:243]
    ds_read_b128 a[80:83], v82 offset:16384
    ds_read_b128 a[84:87], v82 offset:24576
    v_mfma_f32_16x16x32_bf16 v[248:251], a[120:123], v[76:79], v[248:251]
    v_exp_f32 v58, v26
    v_mfma_f32_16x16x32_bf16 v[252:255], a[124:127], v[76:79], v[252:255]
    v_exp_f32 v59, v27
    v_mfma_f32_16x16x32_bf16 v[244:247], a[124:127], v[72:75], v[244:247]
    ds_read_b128 a[88:91], v83 offset:16384
    s_cbranch_scc0 L_loop
    s_waitcnt lgkmcnt(3)
    v_mfma_f32_16x16x32_bf16 v[32:35], a[64:67], a[0:3], v[96:99]
    ds_read_b128 a[92:95], v83 offset:24576
    v_cvt_pk_bf16_f32 v69, v58, v59
    v_mfma_f32_16x16x32_bf16 v[40:43], a[64:67], a[4:7], v[100:103]
    v_exp_f32 v60, v28
    v_mfma_f32_16x16x32_bf16 v[44:47], a[68:71], a[4:7], v[100:103]
    ds_read_b128 a[96:99], v80 offset:16640
    ds_read_b128 a[100:103], v80 offset:24832
    v_mfma_f32_16x16x32_bf16 v[36:39], a[68:71], a[0:3], v[96:99]
    v_exp_f32 v61, v29
    v_mfma_f32_16x16x32_bf16 v[32:35], a[72:75], a[8:11], v[32:35]
    ds_read_b128 a[104:107], v81 offset:16640
    v_cvt_pk_bf16_f32 v70, v60, v61
    v_mfma_f32_16x16x32_bf16 v[40:43], a[72:75], a[12:15], v[40:43]
    v_exp_f32 v62, v30
    v_mfma_f32_16x16x32_bf16 v[44:47], a[76:79], a[12:15], v[44:47]
    v_exp_f32 v63, v31
    v_mfma_f32_16x16x32_bf16 v[36:39], a[76:79], a[8:11], v[36:39]
    ds_read_b128 a[108:111], v81 offset:24832
    s_waitcnt lgkmcnt(4)
    v_mfma_f32_16x16x32_bf16 v[32:35], a[80:83], a[16:19], v[32:35]
    ds_read_b128 a[112:115], v82 offset:16640
    ds_read_b128 a[116:119], v82 offset:24832
    v_mfma_f32_16x16x32_bf16 v[40:43], a[80:83], a[20:23], v[40:43]
    v_cvt_pk_bf16_f32 v71, v62, v63
    v_mfma_f32_16x16x32_bf16 v[44:47], a[84:87], a[20:23], v[44:47]
    ds_read_b128 a[120:123], v83 offset:16640
    v_mfma_f32_16x16x32_bf16 v[36:39], a[84:87], a[16:19], v[36:39]
    v_mfma_f32_16x16x32_bf16 v[120:123], a[240:243], v[68:71], v[84:87]
    v_mfma_f32_16x16x32_bf16 v[32:35], a[88:91], a[24:27], v[32:35]
    ds_read_b128 a[124:127], v83 offset:24832
    v_mfma_f32_16x16x32_bf16 v[40:43], a[88:91], a[28:31], v[40:43]
    v_mfma_f32_16x16x32_bf16 v[44:47], a[92:95], a[28:31], v[44:47]
    v_mfma_f32_16x16x32_bf16 v[36:39], a[92:95], a[24:27], v[36:39]
    s_waitcnt lgkmcnt(4)
    v_mfma_f32_16x16x32_bf16 v[32:35], a[96:99], a[32:35], v[32:35]
    v_mfma_f32_16x16x32_bf16 v[40:43], a[96:99], a[36:39], v[40:43]
    v_max_f32 v1, v116, v120
    v_cmp_nge_f32 vcc, s61, v1
    v_mfma_f32_16x16x32_bf16 v[44:47], a[100:103], a[36:39], v[44:47]
    ds_read_b64_tr_b16 a[64:65], v88 offset:0
    ds_read_b64_tr_b16 a[66:67], v88 offset:8192
    v_mfma_f32_16x16x32_bf16 v[36:39], a[100:103], a[32:35], v[36:39]
    v_mfma_f32_16x16x32_bf16 v[32:35], a[104:107], a[40:43], v[32:35]
    ds_read_b64_tr_b16 a[68:69], v89 offset:0
    ds_read_b64_tr_b16 a[70:71], v89 offset:8192
    v_mfma_f32_16x16x32_bf16 v[40:43], a[104:107], a[44:47], v[40:43]
    v_mfma_f32_16x16x32_bf16 v[44:47], a[108:111], a[44:47], v[44:47]
    ds_read_b64_tr_b16 a[72:73], v90 offset:0
    v_mfma_f32_16x16x32_bf16 v[36:39], a[108:111], a[40:43], v[36:39]
    ds_read_b64_tr_b16 a[74:75], v90 offset:8192
    s_waitcnt lgkmcnt(6)
    v_mfma_f32_16x16x32_bf16 v[32:35], a[112:115], a[48:51], v[32:35]
    ds_read_b64_tr_b16 a[76:77], v91 offset:0
    ds_read_b64_tr_b16 a[78:79], v91 offset:8192
    v_mfma_f32_16x16x32_bf16 v[40:43], a[112:115], a[52:55], v[40:43]
    v_mfma_f32_16x16x32_bf16 v[44:47], a[116:119], a[52:55], v[44:47]
    ds_read_b64_tr_b16 a[80:81], v92 offset:0
    ds_read_b64_tr_b16 a[82:83], v92 offset:8192
    v_mfma_f32_16x16x32_bf16 v[36:39], a[116:119], a[48:51], v[36:39]
    v_mfma_f32_16x16x32_bf16 v[32:35], a[120:123], a[56:59], v[32:35]
    ds_read_b64_tr_b16 a[84:85], v93 offset:0
    ds_read_b64_tr_b16 a[86:87], v93 offset:8192
    v_mfma_f32_16x16x32_bf16 v[40:43], a[120:123], a[60:63], v[40:43]
    v_mfma_f32_16x16x32_bf16 v[44:47], a[124:127], a[60:63], v[44:47]
    ds_read_b64_tr_b16 a[88:89], v94 offset:0
    v_mfma_f32_16x16x32_bf16 v[36:39], a[124:127], a[56:59], v[36:39]
    ds_read_b64_tr_b16 a[90:91], v94 offset:8192
    s_cbranch_vccnz L_tr_P30
L_bk_P30:
    s_waitcnt lgkmcnt(6)
    v_mfma_f32_16x16x32_bf16 v[128:131], a[64:67], v[64:67], v[128:131]
    ds_read_b64_tr_b16 a[92:93], v95 offset:0
    ds_read_b64_tr_b16 a[94:95], v95 offset:8192
    v_mfma_f32_16x16x32_bf16 v[136:139], a[64:67], v[68:71], v[136:139]
    v_exp_f32 v48, v32
    v_mfma_f32_16x16x32_bf16 v[140:143], a[68:71], v[68:71], v[140:143]
    ds_read_b64_tr_b16 a[96:97], v88 offset:256
    ds_read_b64_tr_b16 a[98:99], v88 offset:8448
    v_mfma_f32_16x16x32_bf16 v[132:135], a[68:71], v[64:67], v[132:135]
    v_exp_f32 v49, v33
    v_mfma_f32_16x16x32_bf16 v[144:147], a[72:75], v[64:67], v[144:147]
    ds_read_b64_tr_b16 a[100:101], v89 offset:256
    ds_read_b64_tr_b16 a[102:103], v89 offset:8448
    v_cvt_pk_bf16_f32 v72, v48, v49
    v_mfma_f32_16x16x32_bf16 v[152:155], a[72:75], v[68:71], v[152:155]
    v_exp_f32 v50, v34
    v_mfma_f32_16x16x32_bf16 v[156:159], a[76:79], v[68:71], v[156:159]
    ds_read_b64_tr_b16 a[104:105], v90 offset:256
    v_exp_f32 v51, v35
    v_mfma_f32_16x16x32_bf16 v[148:151], a[76:79], v[64:67], v[148:151]
    ds_read_b64_tr_b16 a[106:107], v90 offset:8448
    v_cvt_pk_bf16_f32 v73, v50, v51
    s_waitcnt lgkmcnt(6)
    v_mfma_f32_16x16x32_bf16 v[160:163], a[80:83], v[64:67], v[160:163]
    ds_read_b64_tr_b16 a[108:109], v91 offset:256
    ds_read_b64_tr_b16 a[110:111], v91 offset:8448
    v_mfma_f32_16x16x32_bf16 v[168:171], a[80:83], v[68:71], v[168:171]
    v_exp_f32 v52, v36
    v_mfma_f32_16x16x32_bf16 v[172:175], a[84:87], v[68:71], v[172:175]
    ds_read_b64_tr_b16 a[112:113], v92 offset:256
    ds_read_b64_tr_b16 a[114:115], v92 offset:8448
    v_mfma_f32_16x16x32_bf16 v[164:167], a[84:87], v[64:67], v[164:167]
    v_exp_f32 v53, v37
    v_mfma_f32_16x16x32_bf16 v[176:179], a[88:91], v[64:67], v[176:179]
    ds_read_b64_tr_b16 a[116:117], v93 offset:256
    ds_read_b64_tr_b16 a[118:119], v93 offset:8448
    v_cvt_pk_bf16_f32 v74, v52, v53
    v_mfma_f32_16x16x32_bf16 v[184:187], a[88:91], v[68:71], v[184:187]
    v_exp_f32 v54, v38
    v_mfma_f32_16x16x32_bf16 v[188:191], a[92:95], v[68:71], v[188:191]
    ds_read_b64_tr_b16 a[120:121], v94 offset:256
    v_exp_f32 v55, v39
    v_mfma_f32_16x16x32_bf16 v[180:183], a[92:95], v[64:67], v[180:183]
    ds_read_b64_tr_b16 a[122:123], v94 offset:8448
    v_cvt_pk_bf16_f32 v75, v54, v55
    s_waitcnt lgkmcnt(6)
    v_mfma_f32_16x16x32_bf16 v[192:195], a[96:99], v[64:67], v[192:195]
    ds_read_b64_tr_b16 a[124:125], v95 offset:256
    ds_read_b64_tr_b16 a[126:127], v95 offset:8448
    v_mfma_f32_16x16x32_bf16 v[200:203], a[96:99], v[68:71], v[200:203]
    v_exp_f32 v56, v40
    v_mfma_f32_16x16x32_bf16 v[204:207], a[100:103], v[68:71], v[204:207]
    v_mfma_f32_16x16x32_bf16 v[6:9], a[240:243], v[72:75], v[116:119]
    v_mfma_f32_16x16x32_bf16 v[196:199], a[100:103], v[64:67], v[196:199]
    v_exp_f32 v57, v41
    v_mfma_f32_16x16x32_bf16 v[208:211], a[104:107], v[64:67], v[208:211]
    v_exp_f32 v58, v42
    v_cvt_pk_bf16_f32 v76, v56, v57
    v_mfma_f32_16x16x32_bf16 v[216:219], a[104:107], v[68:71], v[216:219]
    v_exp_f32 v59, v43
    v_mfma_f32_16x16x32_bf16 v[220:223], a[108:111], v[68:71], v[220:223]
    s_waitcnt lgkmcnt(0)
    s_barrier
    v_cvt_pk_bf16_f32 v77, v58, v59
    v_mfma_f32_16x16x32_bf16 v[212:215], a[108:111], v[64:67], v[212:215]
    ds_read_b64_tr_b16 a[64:65], v88 offset:16384
    ds_read_b64_tr_b16 a[66:67], v88 offset:24576
    ds_read_b64_tr_b16 a[68:69], v89 offset:16384
    ds_read_b64_tr_b16 a[70:71], v89 offset:24576
    v_mfma_f32_16x16x32_bf16 v[224:227], a[112:115], v[64:67], v[224:227]
    ds_read_b64_tr_b16 a[72:73], v90 offset:16384
    ds_read_b64_tr_b16 a[74:75], v90 offset:24576
    v_mfma_f32_16x16x32_bf16 v[232:235], a[112:115], v[68:71], v[232:235]
    v_exp_f32 v60, v44
    v_mfma_f32_16x16x32_bf16 v[236:239], a[116:119], v[68:71], v[236:239]
    ds_read_b64_tr_b16 a[76:77], v91 offset:16384
    ds_read_b64_tr_b16 a[78:79], v91 offset:24576
    v_mfma_f32_16x16x32_bf16 v[228:231], a[116:119], v[64:67], v[228:231]
    v_exp_f32 v61, v45
    v_mfma_f32_16x16x32_bf16 v[240:243], a[120:123], v[64:67], v[240:243]
    ds_read_b64_tr_b16 a[80:81], v92 offset:16384
    ds_read_b64_tr_b16 a[82:83], v92 offset:24576
    v_cvt_pk_bf16_f32 v78, v60, v61
    v_mfma_f32_16x16x32_bf16 v[248:251], a[120:123], v[68:71], v[248:251]
    v_exp_f32 v62, v46
    v_mfma_f32_16x16x32_bf16 v[252:255], a[124:127], v[68:71], v[252:255]
    ds_read_b64_tr_b16 a[84:85], v93 offset:16384
    v_exp_f32 v63, v47
    v_mfma_f32_16x16x32_bf16 v[244:247], a[124:127], v[64:67], v[244:247]
    ds_read_b64_tr_b16 a[86:87], v93 offset:24576
    v_cvt_pk_bf16_f32 v79, v62, v63
    s_nop 1
    v_mfma_f32_16x16x32_bf16 v[84:87], a[240:243], v[76:79], v[120:123]
    s_nop 7
    v_max_f32 v1, v6, v84
    v_cmp_nge_f32 vcc, s61, v1
    s_cbranch_vccnz L_tr_P31
L_bk_P31:
    s_waitcnt lgkmcnt(8)
    v_mfma_f32_16x16x32_bf16 v[128:131], a[64:67], v[72:75], v[128:131]
    ds_read_b64_tr_b16 a[88:89], v94 offset:16384
    ds_read_b64_tr_b16 a[90:91], v94 offset:24576
    v_mfma_f32_16x16x32_bf16 v[136:139], a[64:67], v[76:79], v[136:139]
    v_mfma_f32_16x16x32_bf16 v[140:143], a[68:71], v[76:79], v[140:143]
    ds_read_b64_tr_b16 a[92:93], v95 offset:16384
    ds_read_b64_tr_b16 a[94:95], v95 offset:24576
    ds_read_b64_tr_b16 a[96:97], v88 offset:16640
    v_mfma_f32_16x16x32_bf16 v[132:135], a[68:71], v[72:75], v[132:135]
    ds_read_b64_tr_b16 a[98:99], v88 offset:24832
    s_waitcnt lgkmcnt(10)
    v_mfma_f32_16x16x32_bf16 v[144:147], a[72:75], v[72:75], v[144:147]
    ds_read_b64_tr_b16 a[100:101], v89 offset:16640
    ds_read_b64_tr_b16 a[102:103], v89 offset:24832
    v_mfma_f32_16x16x32_bf16 v[152:155], a[72:75], v[76:79], v[152:155]
    v_cvt_pk_bf16_f32 v128, v128, v129
    v_cvt_pk_bf16_f32 v129, v130, v131
    v_mfma_f32_16x16x32_bf16 v[156:159], a[76:79], v[76:79], v[156:159]
    ds_read_b64_tr_b16 a[104:105], v90 offset:16640
    v_cvt_pk_bf16_f32 v130, v132, v133
    v_mfma_f32_16x16x32_bf16 v[148:151], a[76:79], v[72:75], v[148:151]
    ds_read_b64_tr_b16 a[106:107], v90 offset:24832
    s_waitcnt lgkmcnt(10)
    v_mfma_f32_16x16x32_bf16 v[160:163], a[80:83], v[72:75], v[160:163]
    ds_read_b64_tr_b16 a[108:109], v91 offset:16640
    ds_read_b64_tr_b16 a[110:111], v91 offset:24832
    v_mfma_f32_16x16x32_bf16 v[168:171], a[80:83], v[76:79], v[168:171]
    v_cvt_pk_bf16_f32 v131, v134, v135
    v_cvt_pk_bf16_f32 v136, v136, v137
    v_mfma_f32_16x16x32_bf16 v[172:175], a[84:87], v[76:79], v[172:175]
    ds_read_b64_tr_b16 a[112:113], v92 offset:16640
    v_cvt_pk_bf16_f32 v137, v138, v139
    v_mfma_f32_16x16x32_bf16 v[164:167], a[84:87], v[72:75], v[164:167]
    ds_read_b64_tr_b16 a[114:115], v92 offset:24832
    s_waitcnt lgkmcnt(10)
    v_mfma_f32_16x16x32_bf16 v[176:179], a[88:91], v[72:75], v[176:179]
    ds_read_b64_tr_b16 a[116:117], v93 offset:16640
    ds_read_b64_tr_b16 a[118:119], v93 offset:24832
    v_mfma_f32_16x16x32_bf16 v[184:187], a[88:91], v[76:79], v[184:187]
    v_cvt_pk_bf16_f32 v138, v140, v141
    v_cvt_pk_bf16_f32 v139, v142, v143
    v_mfma_f32_16x16x32_bf16 v[188:191], a[92:95], v[76:79], v[188:191]
    ds_read_b64_tr_b16 a[120:121], v94 offset:16640
    v_cvt_pk_bf16_f32 v144, v144, v145
    v_mfma_f32_16x16x32_bf16 v[180:183], a[92:95], v[72:75], v[180:183]
    ds_read_b64_tr_b16 a[122:123], v94 offset:24832
    s_waitcnt lgkmcnt(10)
    v_mfma_f32_16x16x32_bf16 v[192:195], a[96:99], v[72:75], v[192:195]
    ds_read_b64_tr_b16 a[124:125], v95 offset:16640
    ds_read_b64_tr_b16 a[126:127], v95 offset:24832
    v_mfma_f32_16x16x32_bf16 v[200:203], a[96:99], v[76:79], v[200:203]
    v_cvt_pk_bf16_f32 v145, v146, v147
    v_cvt_pk_bf16_f32 v146, v148, v149
    v_mfma_f32_16x16x32_bf16 v[204:207], a[100:103], v[76:79], v[204:207]
    ds_read_b64_tr_b16 a[64:65], v108 offset:32768
    v_cvt_pk_bf16_f32 v147, v150, v151
    v_mfma_f32_16x16x32_bf16 v[196:199], a[100:103], v[72:75], v[196:199]
    ds_read_b64_tr_b16 a[66:67], v108 offset:34816
    s_waitcnt lgkmcnt(10)
    v_mfma_f32_16x16x32_bf16 v[208:211], a[104:107], v[72:75], v[208:211]
    ds_read_b64_tr_b16 a[68:69], v109 offset:32768
    ds_read_b64_tr_b16 a[70:71], v109 offset:34816
    v_mfma_f32_16x16x32_bf16 v[216:219], a[104:107], v[76:79], v[216:219]
    v_cvt_pk_bf16_f32 v152, v152, v153
    v_cvt_pk_bf16_f32 v153, v154, v155
    v_mfma_f32_16x16x32_bf16 v[220:223], a[108:111], v[76:79], v[220:223]
    ds_read_b64_tr_b16 a[72:73], v108 offset:36864
    v_cvt_pk_bf16_f32 v154, v156, v157
    v_mfma_f32_16x16x32_bf16 v[212:215], a[108:111], v[72:75], v[212:215]
    ds_read_b64_tr_b16 a[74:75], v108 offset:38912
    s_waitcnt lgkmcnt(10)
    v_mfma_f32_16x16x32_bf16 v[224:227], a[112:115], v[72:75], v[224:227]
    ds_read_b64_tr_b16 a[76:77], v109 offset:36864
    ds_read_b64_tr_b16 a[78:79], v109 offset:38912
    v_mfma_f32_16x16x32_bf16 v[232:235], a[112:115], v[76:79], v[232:235]
    v_cvt_pk_bf16_f32 v155, v158, v159
    v_cvt_pk_bf16_f32 v160, v160, v161
    v_mfma_f32_16x16x32_bf16 v[236:239], a[116:119], v[76:79], v[236:239]
    ds_read_b64_tr_b16 a[80:81], v108 offset:40960
    v_cvt_pk_bf16_f32 v161, v162, v163
    v_mfma_f32_16x16x32_bf16 v[228:231], a[116:119], v[72:75], v[228:231]
    ds_read_b64_tr_b16 a[82:83], v108 offset:43008
    s_waitcnt lgkmcnt(10)
    v_mfma_f32_16x16x32_bf16 v[240:243], a[120:123], v[72:75], v[240:243]
    ds_read_b64_tr_b16 a[84:85], v109 offset:40960
    ds_read_b64_tr_b16 a[86:87], v109 offset:43008
    v_mfma_f32_16x16x32_bf16 v[248:251], a[120:123], v[76:79], v[248:251]
    v_cvt_pk_bf16_f32 v162, v164, v165
    v_cvt_pk_bf16_f32 v163, v166, v167
    v_mfma_f32_16x16x32_bf16 v[252:255], a[124:127], v[76:79], v[252:255]
    ds_read_b64_tr_b16 a[88:89], v108 offset:45056
    v_cvt_pk_bf16_f32 v168, v168, v169
    v_mfma_f32_16x16x32_bf16 v[244:247], a[124:127], v[72:75], v[244:247]
    ds_read_b64_tr_b16 a[90:91], v108 offset:47104
    s_waitcnt lgkmcnt(6)
    v_mfma_f32_16x16x32_bf16 v[16:19], a[64:67], v[128:131], 0
    ds_read_b64_tr_b16 a[92:93], v109 offset:45056
    ds_read_b64_tr_b16 a[94:95], v109 offset:47104
    v_mfma_f32_16x16x32_bf16 v[24:27], a[64:67], v[136:139], 0
    v_cvt_pk_bf16_f32 v169, v170, v171
    v_cvt_pk_bf16_f32 v170, v172, v173
    v_mfma_f32_16x16x32_bf16 v[28:31], a[68:71], v[136:139], 0
    ds_read_b64_tr_b16 a[96:97], v108 offset:49152
    ds_read_b64_tr_b16 a[98:99], v108 offset:51200
    v_mfma_f32_16x16x32_bf16 v[20:23], a[68:71], v[128:131], 0
    v_cvt_pk_bf16_f32 v171, v174, v175
    v_cvt_pk_bf16_f32 v176, v176, v177
    v_mfma_f32_16x16x32_bf16 v[16:19], a[72:75], v[144:147], v[16:19]
    ds_read_b64_tr_b16 a[100:101], v109 offset:49152
    ds_read_b64_tr_b16 a[102:103], v109 offset:51200
    v_mfma_f32_16x16x32_bf16 v[24:27], a[72:75], v[152:155], v[24:27]
    v_cvt_pk_bf16_f32 v177, v178, v179
    v_cvt_pk_bf16_f32 v178, v180, v181
    v_mfma_f32_16x16x32_bf16 v[28:31], a[76:79], v[152:155], v[28:31]
    ds_read_b64_tr_b16 a[104:105], v108 offset:53248
    v_cvt_pk_bf16_f32 v179, v182, v183
    v_mfma_f32_16x16x32_bf16 v[20:23], a[76:79], v[144:147], v[20:23]
    ds_read_b64_tr_b16 a[106:107], v108 offset:55296
    s_waitcnt lgkmcnt(6)
    v_mfma_f32_16x16x32_bf16 v[16:19], a[80:83], v[160:163], v[16:19]
    ds_read_b64_tr_b16 a[108:109], v109 offset:53248
    ds_read_b64_tr_b16 a[110:111], v109 offset:55296
    v_mfma_f32_16x16x32_bf16 v[24:27], a[80:83], v[168:171], v[24:27]
    v_cvt_pk_bf16_f32 v184, v184, v185
    v_cvt_pk_bf16_f32 v185, v186, v187
    v_mfma_f32_16x16x32_bf16 v[28:31], a[84:87], v[168:171], v[28:31]
    ds_read_b64_tr_b16 a[112:113], v108 offset:57344
    ds_read_b64_tr_b16 a[114:115], v108 offset:59392
    v_mfma_f32_16x16x32_bf16 v[20:23], a[84:87], v[160:163], v[20:23]
    v_cvt_pk_bf16_f32 v186, v188, v189
    v_cvt_pk_bf16_f32 v187, v190, v191
    v_cvt_pk_bf16_f32 v192, v192, v193
    v_cvt_pk_bf16_f32 v193, v194, v195
    v_mfma_f32_16x16x32_bf16 v[16:19], a[88:91], v[176:179], v[16:19]
    ds_read_b64_tr_b16 a[116:117], v109 offset:57344
    ds_read_b64_tr_b16 a[118:119], v109 offset:59392
    v_cvt_pk_bf16_f32 v194, v196, v197
    v_mfma_f32_16x16x32_bf16 v[24:27], a[88:91], v[184:187], v[24:27]
    v_cvt_pk_bf16_f32 v195, v198, v199
    v_cvt_pk_bf16_f32 v200, v200, v201
    v_cvt_pk_bf16_f32 v201, v202, v203
    v_mfma_f32_16x16x32_bf16 v[28:31], a[92:95], v[184:187], v[28:31]
    ds_read_b64_tr_b16 a[120:121], v108 offset:61440
    v_cvt_pk_bf16_f32 v202, v204, v205
    v_cvt_pk_bf16_f32 v203, v206, v207
    v_mfma_f32_16x16x32_bf16 v[20:23], a[92:95], v[176:179], v[20:23]
    ds_read_b64_tr_b16 a[122:123], v108 offset:63488
    v_cvt_pk_bf16_f32 v208, v208, v209
    s_waitcnt lgkmcnt(6)
    v_mfma_f32_16x16x32_bf16 v[16:19], a[96:99], v[192:195], v[16:19]
    ds_read_b64_tr_b16 a[124:125], v109 offset:61440
    ds_read_b64_tr_b16 a[126:127], v109 offset:63488
    v_cvt_pk_bf16_f32 v209, v210, v211
    v_mfma_f32_16x16x32_bf16 v[24:27], a[96:99], v[200:203], v[24:27]
    v_cvt_pk_bf16_f32 v210, v212, v213
    v_cvt_pk_bf16_f32 v211, v214, v215
    v_cvt_pk_bf16_f32 v216, v216, v217
    v_mfma_f32_16x16x32_bf16 v[28:31], a[100:103], v[200:203], v[28:31]
    ds_read_b64_tr_b16 a[64:65], v110 offset:32768
    ds_read_b64_tr_b16 a[66:67], v110 offset:34816
    v_cvt_pk_bf16_f32 v217, v218, v219
    v_mfma_f32_16x16x32_bf16 v[20:23], a[100:103], v[192:195], v[20:23]
    v_cvt_pk_bf16_f32 v218, v220, v221
    v_cvt_pk_bf16_f32 v219, v222, v223
    v_cvt_pk_bf16_f32 v224, v224, v225
    v_cvt_pk_bf16_f32 v225, v226, v227
    v_mfma_f32_16x16x32_bf16 v[16:19], a[104:107], v[208:211], v[16:19]
    ds_read_b64_tr_b16 a[68:69], v111 offset:32768
    ds_read_b64_tr_b16 a[70:71], v111 offset:34816
    v_cvt_pk_bf16_f32 v226, v228, v229
    v_mfma_f32_16x16x32_bf16 v[24:27], a[104:107], v[216:219], v[24:27]
    v_cvt_pk_bf16_f32 v227, v230, v231
    v_cvt_pk_bf16_f32 v232, v232, v233
    v_cvt_pk_bf16_f32 v233, v234, v235
    v_mfma_f32_16x16x32_bf16 v[28:31], a[108:111], v[216:219], v[28:31]
    ds_read_b64_tr_b16 a[72:73], v110 offset:36864
    v_cvt_pk_bf16_f32 v234, v236, v237
    v_cvt_pk_bf16_f32 v235, v238, v239
    v_mfma_f32_16x16x32_bf16 v[20:23], a[108:111], v[208:211], v[20:23]
    ds_read_b64_tr_b16 a[74:75], v110 offset:38912
    v_cvt_pk_bf16_f32 v240, v240, v241
    s_waitcnt lgkmcnt(6)
    v_mfma_f32_16x16x32_bf16 v[16:19], a[112:115], v[224:227], v[16:19]
    ds_read_b64_tr_b16 a[76:77], v111 offset:36864
    ds_read_b64_tr_b16 a[78:79], v111 offset:38912
    v_cvt_pk_bf16_f32 v241, v242, v243
    v_mfma_f32_16x16x32_bf16 v[24:27], a[112:115], v[232:235], v[24:27]
    v_rcp_f32 v14, v6
    v_cvt_pk_bf16_f32 v242, v244, v245
    v_mfma_f32_16x16x32_bf16 v[28:31], a[116:119], v[232:235], v[28:31]
    ds_read_b64_tr_b16 a[80:81], v110 offset:40960
    ds_read_b64_tr_b16 a[82:83], v110 offset:43008
    v_cvt_pk_bf16_f32 v243, v246, v247
    v_mfma_f32_16x16x32_bf16 v[20:23], a[116:119], v[224:227], v[20:23]
    v_cvt_pk_bf16_f32 v248, v248, v249
    v_cvt_pk_bf16_f32 v249, v250, v251
    v_cvt_pk_bf16_f32 v250, v252, v253
    v_cvt_pk_bf16_f32 v251, v254, v255
    v_rcp_f32 v15, v84
    v_mfma_f32_16x16x32_bf16 v[16:19], a[120:123], v[240:243], v[16:19]
    ds_read_b64_tr_b16 a[84:85], v111 offset:40960
    ds_read_b64_tr_b16 a[86:87], v111 offset:43008
    v_mfma_f32_16x16x32_bf16 v[24:27], a[120:123], v[248:251], v[24:27]
    v_mfma_f32_16x16x32_bf16 v[28:31], a[124:127], v[248:251], v[28:31]
    ds_read_b64_tr_b16 a[88:89], v110 offset:45056
    v_mfma_f32_16x16x32_bf16 v[20:23], a[124:127], v[240:243], v[20:23]
    ds_read_b64_tr_b16 a[90:91], v110 offset:47104
    s_waitcnt lgkmcnt(6)
    v_mfma_f32_16x16x32_bf16 v[32:35], a[64:67], v[128:131], 0
    ds_read_b64_tr_b16 a[92:93], v111 offset:45056
    ds_read_b64_tr_b16 a[94:95], v111 offset:47104
    v_mfma_f32_16x16x32_bf16 v[40:43], a[64:67], v[136:139], 0
    v_mul_f32 v48, v16, v14
    v_mul_f32 v49, v17, v14
    v_mfma_f32_16x16x32_bf16 v[44:47], a[68:71], v[136:139], 0
    ds_read_b64_tr_b16 a[96:97], v110 offset:49152
    ds_read_b64_tr_b16 a[98:99], v110 offset:51200
    v_mfma_f32_16x16x32_bf16 v[36:39], a[68:71], v[128:131], 0
    v_cvt_pk_bf16_f32 v64, v48, v49
    v_mul_f32 v50, v18, v14
    v_mfma_f32_16x16x32_bf16 v[32:35], a[72:75], v[144:147], v[32:35]
    ds_read_b64_tr_b16 a[100:101], v111 offset:49152
    ds_read_b64_tr_b16 a[102:103], v111 offset:51200
    v_mfma_f32_16x16x32_bf16 v[40:43], a[72:75], v[152:155], v[40:43]
    v_mul_f32 v51, v19, v14
    v_cvt_pk_bf16_f32 v65, v50, v51
    v_mfma_f32_16x16x32_bf16 v[44:47], a[76:79], v[152:155], v[44:47]
    ds_read_b64_tr_b16 a[104:105], v110 offset:53248
    v_mul_f32 v52, v20, v14
    v_mfma_f32_16x16x32_bf16 v[36:39], a[76:79], v[144:147], v[36:39]
    ds_read_b64_tr_b16 a[106:107], v110 offset:55296
    s_waitcnt lgkmcnt(6)
    v_mfma_f32_16x16x32_bf16 v[32:35], a[80:83], v[160:163], v[32:35]
    ds_read_b64_tr_b16 a[108:109], v111 offset:53248
    ds_read_b64_tr_b16 a[110:111], v111 offset:55296
    v_mfma_f32_16x16x32_bf16 v[40:43], a[80:83], v[168:171], v[40:43]
    v_mul_f32 v53, v21, v14
    v_cvt_pk_bf16_f32 v66, v52, v53
    v_mfma_f32_16x16x32_bf16 v[44:47], a[84:87], v[168:171], v[44:47]
    ds_read_b64_tr_b16 a[112:113], v110 offset:57344
    ds_read_b64_tr_b16 a[114:115], v110 offset:59392
    v_mfma_f32_16x16x32_bf16 v[36:39], a[84:87], v[160:163], v[36:39]
    v_mul_f32 v54, v22, v14
    v_mul_f32 v55, v23, v14
    v_mfma_f32_16x16x32_bf16 v[32:35], a[88:91], v[176:179], v[32:35]
    ds_read_b64_tr_b16 a[116:117], v111 offset:57344
    ds_read_b64_tr_b16 a[118:119], v111 offset:59392
    v_mfma_f32_16x16x32_bf16 v[40:43], a[88:91], v[184:187], v[40:43]
    v_cvt_pk_bf16_f32 v67, v54, v55
    v_mul_f32 v56, v24, v15
    v_mfma_f32_16x16x32_bf16 v[44:47], a[92:95], v[184:187], v[44:47]
    ds_read_b64_tr_b16 a[120:121], v110 offset:61440
    v_mul_f32 v57, v25, v15
    v_mfma_f32_16x16x32_bf16 v[36:39], a[92:95], v[176:179], v[36:39]
    ds_read_b64_tr_b16 a[122:123], v110 offset:63488
    s_barrier
    s_waitcnt lgkmcnt(6)
    v_mfma_f32_16x16x32_bf16 v[32:35], a[96:99], v[192:195], v[32:35]
    ds_read_b64_tr_b16 a[124:125], v111 offset:61440
    ds_read_b64_tr_b16 a[126:127], v111 offset:63488
    v_mfma_f32_16x16x32_bf16 v[40:43], a[96:99], v[200:203], v[40:43]
    buffer_store_dwordx4 v[64:67], v124, s[56:59], s63 offen offset:0 sc1
    v_mfma_f32_16x16x32_bf16 v[44:47], a[100:103], v[200:203], v[44:47]
    ds_read_b64_tr_b16 a[64:65], v112 offset:0
    ds_read_b64_tr_b16 a[66:67], v112 offset:2048
    v_mfma_f32_16x16x32_bf16 v[36:39], a[100:103], v[192:195], v[36:39]
    v_cvt_pk_bf16_f32 v68, v56, v57
    v_mul_f32 v58, v26, v15
    v_mfma_f32_16x16x32_bf16 v[32:35], a[104:107], v[208:211], v[32:35]
    ds_read_b64_tr_b16 a[68:69], v113 offset:0
    ds_read_b64_tr_b16 a[70:71], v113 offset:2048
    v_mfma_f32_16x16x32_bf16 v[40:43], a[104:107], v[216:219], v[40:43]
    v_mul_f32 v59, v27, v15
    v_cvt_pk_bf16_f32 v69, v58, v59
    v_mfma_f32_16x16x32_bf16 v[44:47], a[108:111], v[216:219], v[44:47]
    ds_read_b64_tr_b16 a[72:73], v112 offset:4096
    v_mul_f32 v60, v28, v15
    v_mfma_f32_16x16x32_bf16 v[36:39], a[108:111], v[208:211], v[36:39]
    ds_read_b64_tr_b16 a[74:75], v112 offset:6144
    s_waitcnt lgkmcnt(6)
    v_mfma_f32_16x16x32_bf16 v[32:35], a[112:115], v[224:227], v[32:35]
    ds_read_b64_tr_b16 a[76:77], v113 offset:4096
    ds_read_b64_tr_b16 a[78:79], v113 offset:6144
    v_mfma_f32_16x16x32_bf16 v[40:43], a[112:115], v[232:235], v[40:43]
    v_mul_f32 v61, v29, v15
    v_cvt_pk_bf16_f32 v70, v60, v61
    v_mfma_f32_16x16x32_bf16 v[44:47], a[116:119], v[232:235], v[44:47]
    ds_read_b64_tr_b16 a[80:81], v112 offset:8192
    ds_read_b64_tr_b16 a[82:83], v112 offset:10240
    v_mfma_f32_16x16x32_bf16 v[36:39], a[116:119], v[224:227], v[36:39]
    v_mul_f32 v62, v30, v15
    v_mul_f32 v63, v31, v15
    v_mfma_f32_16x16x32_bf16 v[32:35], a[120:123], v[240:243], v[32:35]
    ds_read_b64_tr_b16 a[84:85], v113 offset:8192
    ds_read_b64_tr_b16 a[86:87], v113 offset:10240
    v_mfma_f32_16x16x32_bf16 v[40:43], a[120:123], v[248:251], v[40:43]
    v_cvt_pk_bf16_f32 v71, v62, v63
    v_mfma_f32_16x16x32_bf16 v[44:47], a[124:127], v[248:251], v[44:47]
    ds_read_b64_tr_b16 a[88:89], v112 offset:12288
    buffer_store_dwordx4 v[68:71], v124, s[56:59], s63 offen offset:1024 sc1
    v_mfma_f32_16x16x32_bf16 v[36:39], a[124:127], v[240:243], v[36:39]
    ds_read_b64_tr_b16 a[90:91], v112 offset:14336
    v_mul_f32 v48, v32, v14
    s_waitcnt lgkmcnt(6)
    v_mfma_f32_16x16x32_bf16 v[16:19], a[64:67], v[128:131], 0
    ds_read_b64_tr_b16 a[92:93], v113 offset:12288
    ds_read_b64_tr_b16 a[94:95], v113 offset:14336
    v_mul_f32 v49, v33, v14
    v_mfma_f32_16x16x32_bf16 v[24:27], a[64:67], v[136:139], 0
    v_cvt_pk_bf16_f32 v72, v48, v49
    v_mul_f32 v50, v34, v14
    v_mfma_f32_16x16x32_bf16 v[28:31], a[68:71], v[136:139], 0
    ds_read_b64_tr_b16 a[96:97], v112 offset:16384
    ds_read_b64_tr_b16 a[98:99], v112 offset:18432
    v_mfma_f32_16x16x32_bf16 v[20:23], a[68:71], v[128:131], 0
    s_barrier
    v_mul_f32 v51, v35, v14
    v_mfma_f32_16x16x32_bf16 v[16:19], a[72:75], v[144:147], v[16:19]
    ds_read_b64_tr_b16 a[100:101], v113 offset:16384
    ds_read_b64_tr_b16 a[102:103], v113 offset:18432
    v_mfma_f32_16x16x32_bf16 v[24:27], a[72:75], v[152:155], v[24:27]
    v_cvt_pk_bf16_f32 v73, v50, v51
    v_mul_f32 v52, v36, v14
    v_mfma_f32_16x16x32_bf16 v[28:31], a[76:79], v[152:155], v[28:31]
    ds_read_b64_tr_b16 a[104:105], v112 offset:20480
    v_mul_f32 v53, v37, v14
    v_mfma_f32_16x16x32_bf16 v[20:23], a[76:79], v[144:147], v[20:23]
    ds_read_b64_tr_b16 a[106:107], v112 offset:22528
    s_waitcnt lgkmcnt(6)
    v_mfma_f32_16x16x32_bf16 v[16:19], a[80:83], v[160:163], v[16:19]
    ds_read_b64_tr_b16 a[108:109], v113 offset:20480
    ds_read_b64_tr_b16 a[110:111], v113 offset:22528
    v_mfma_f32_16x16x32_bf16 v[24:27], a[80:83], v[168:171], v[24:27]
    v_cvt_pk_bf16_f32 v74, v52, v53
    v_mul_f32 v54, v38, v14
    v_mfma_f32_16x16x32_bf16 v[28:31], a[84:87], v[168:171], v[28:31]
    ds_read_b64_tr_b16 a[112:113], v112 offset:24576
    ds_read_b64_tr_b16 a[114:115], v112 offset:26624
    v_mfma_f32_16x16x32_bf16 v[20:23], a[84:87], v[160:163], v[20:23]
    v_mul_f32 v55, v39, v14
    v_cvt_pk_bf16_f32 v75, v54, v55
    v_mfma_f32_16x16x32_bf16 v[16:19], a[88:91], v[176:179], v[16:19]
    ds_read_b64_tr_b16 a[116:117], v113 offset:24576
    ds_read_b64_tr_b16 a[118:119], v113 offset:26624
    v_mfma_f32_16x16x32_bf16 v[24:27], a[88:91], v[184:187], v[24:27]
    buffer_store_dwordx4 v[72:75], v124, s[56:59], s63 offen offset:2048 sc1
    v_mfma_f32_16x16x32_bf16 v[28:31], a[92:95], v[184:187], v[28:31]
    ds_read_b64_tr_b16 a[120:121], v112 offset:28672
    v_mul_f32 v56, v40, v15
    v_mfma_f32_16x16x32_bf16 v[20:23], a[92:95], v[176:179], v[20:23]
    ds_read_b64_tr_b16 a[122:123], v112 offset:30720
    s_waitcnt lgkmcnt(6)
    v_mfma_f32_16x16x32_bf16 v[16:19], a[96:99], v[192:195], v[16:19]
    ds_read_b64_tr_b16 a[124:125], v113 offset:28672
    ds_read_b64_tr_b16 a[126:127], v113 offset:30720
    v_mfma_f32_16x16x32_bf16 v[24:27], a[96:99], v[200:203], v[24:27]
    v_mul_f32 v57, v41, v15
    v_cvt_pk_bf16_f32 v76, v56, v57
    v_mfma_f32_16x16x32_bf16 v[28:31], a[100:103], v[200:203], v[28:31]
    ds_read_b64_tr_b16 a[64:65], v114 offset:0
    ds_read_b64_tr_b16 a[66:67], v114 offset:2048
    v_mfma_f32_16x16x32_bf16 v[20:23], a[100:103], v[192:195], v[20:23]
    v_mul_f32 v58, v42, v15
    v_mul_f32 v59, v43, v15
    v_mfma_f32_16x16x32_bf16 v[16:19], a[104:107], v[208:211], v[16:19]
    ds_read_b64_tr_b16 a[68:69], v115 offset:0
    ds_read_b64_tr_b16 a[70:71], v115 offset:2048
    v_mfma_f32_16x16x32_bf16 v[24:27], a[104:107], v[216:219], v[24:27]
    v_cvt_pk_bf16_f32 v77, v58, v59
    v_mul_f32 v60, v44, v15
    v_mfma_f32_16x16x32_bf16 v[28:31], a[108:111], v[216:219], v[28:31]
    ds_read_b64_tr_b16 a[72:73], v114 offset:4096
    v_mul_f32 v61, v45, v15
    v_mfma_f32_16x16x32_bf16 v[20:23], a[108:111], v[208:211], v[20:23]
    ds_read_b64_tr_b16 a[74:75], v114 offset:6144
    s_waitcnt lgkmcnt(6)
    v_mfma_f32_16x16x32_bf16 v[16:19], a[112:115], v[224:227], v[16:19]
    ds_read_b64_tr_b16 a[76:77], v115 offset:4096
    ds_read_b64_tr_b16 a[78:79], v115 offset:6144
    v_mfma_f32_16x16x32_bf16 v[24:27], a[112:115], v[232:235], v[24:27]
    v_cvt_pk_bf16_f32 v78, v60, v61
    v_mul_f32 v62, v46, v15
    v_mfma_f32_16x16x32_bf16 v[28:31], a[116:119], v[232:235], v[28:31]
    ds_read_b64_tr_b16 a[80:81], v114 offset:8192
    ds_read_b64_tr_b16 a[82:83], v114 offset:10240
    v_mfma_f32_16x16x32_bf16 v[20:23], a[116:119], v[224:227], v[20:23]
    v_mul_f32 v63, v47, v15
    v_cvt_pk_bf16_f32 v79, v62, v63
    v_mfma_f32_16x16x32_bf16 v[16:19], a[120:123], v[240:243], v[16:19]
    ds_read_b64_tr_b16 a[84:85], v115 offset:8192
    ds_read_b64_tr_b16 a[86:87], v115 offset:10240
    v_mfma_f32_16x16x32_bf16 v[24:27], a[120:123], v[248:251], v[24:27]
    buffer_store_dwordx4 v[76:79], v124, s[56:59], s63 offen offset:3072 sc1
    v_mfma_f32_16x16x32_bf16 v[28:31], a[124:127], v[248:251], v[28:31]
    ds_read_b64_tr_b16 a[88:89], v114 offset:12288
    s_add_u32 s63, s63, 4096
    v_mfma_f32_16x16x32_bf16 v[20:23], a[124:127], v[240:243], v[20:23]
    ds_read_b64_tr_b16 a[90:91], v114 offset:14336
    s_waitcnt lgkmcnt(6)
    v_mfma_f32_16x16x32_bf16 v[32:35], a[64:67], v[128:131], 0
    ds_read_b64_tr_b16 a[92:93], v115 offset:12288
    ds_read_b64_tr_b16 a[94:95], v115 offset:14336
    v_mfma_f32_16x16x32_bf16 v[40:43], a[64:67], v[136:139], 0
    v_mul_f32 v48, v16, v14
    v_mul_f32 v49, v17, v14
    v_mfma_f32_16x16x32_bf16 v[44:47], a[68:71], v[136:139], 0
    ds_read_b64_tr_b16 a[96:97], v114 offset:16384
    ds_read_b64_tr_b16 a[98:99], v114 offset:18432
    v_mfma_f32_16x16x32_bf16 v[36:39], a[68:71], v[128:131], 0
    v_cvt_pk_bf16_f32 v64, v48, v49
    v_mul_f32 v50, v18, v14
    v_mfma_f32_16x16x32_bf16 v[32:35], a[72:75], v[144:147], v[32:35]
    ds_read_b64_tr_b16 a[100:101], v115 offset:16384
    ds_read_b64_tr_b16 a[102:103], v115 offset:18432
    v_mfma_f32_16x16x32_bf16 v[40:43], a[72:75], v[152:155], v[40:43]
    v_mul_f32 v51, v19, v14
    v_cvt_pk_bf16_f32 v65, v50, v51
    v_mfma_f32_16x16x32_bf16 v[44:47], a[76:79], v[152:155], v[44:47]
    ds_read_b64_tr_b16 a[104:105], v114 offset:20480
    v_mul_f32 v52, v20, v14
    v_mfma_f32_16x16x32_bf16 v[36:39], a[76:79], v[144:147], v[36:39]
    ds_read_b64_tr_b16 a[106:107], v114 offset:22528
    s_waitcnt lgkmcnt(6)
    v_mfma_f32_16x16x32_bf16 v[32:35], a[80:83], v[160:163], v[32:35]
    ds_read_b64_tr_b16 a[108:109], v115 offset:20480
    ds_read_b64_tr_b16 a[110:111], v115 offset:22528
    v_mfma_f32_16x16x32_bf16 v[40:43], a[80:83], v[168:171], v[40:43]
    v_mul_f32 v53, v21, v14
    v_cvt_pk_bf16_f32 v66, v52, v53
    v_mfma_f32_16x16x32_bf16 v[44:47], a[84:87], v[168:171], v[44:47]
    ds_read_b64_tr_b16 a[112:113], v114 offset:24576
    ds_read_b64_tr_b16 a[114:115], v114 offset:26624
    v_mfma_f32_16x16x32_bf16 v[36:39], a[84:87], v[160:163], v[36:39]
    v_mul_f32 v54, v22, v14
    v_mul_f32 v55, v23, v14
    v_mfma_f32_16x16x32_bf16 v[32:35], a[88:91], v[176:179], v[32:35]
    ds_read_b64_tr_b16 a[116:117], v115 offset:24576
    ds_read_b64_tr_b16 a[118:119], v115 offset:26624
    v_mfma_f32_16x16x32_bf16 v[40:43], a[88:91], v[184:187], v[40:43]
    v_cvt_pk_bf16_f32 v67, v54, v55
    v_mul_f32 v56, v24, v15
    v_mfma_f32_16x16x32_bf16 v[44:47], a[92:95], v[184:187], v[44:47]
    ds_read_b64_tr_b16 a[120:121], v114 offset:28672
    v_mul_f32 v57, v25, v15
    v_mfma_f32_16x16x32_bf16 v[36:39], a[92:95], v[176:179], v[36:39]
    ds_read_b64_tr_b16 a[122:123], v114 offset:30720
    s_waitcnt lgkmcnt(6)
    v_mfma_f32_16x16x32_bf16 v[32:35], a[96:99], v[192:195], v[32:35]
    ds_read_b64_tr_b16 a[124:125], v115 offset:28672
    ds_read_b64_tr_b16 a[126:127], v115 offset:30720
    v_mfma_f32_16x16x32_bf16 v[40:43], a[96:99], v[200:203], v[40:43]
    buffer_store_dwordx4 v[64:67], v124, s[56:59], s63 offen offset:0 sc1
    v_mfma_f32_16x16x32_bf16 v[44:47], a[100:103], v[200:203], v[44:47]
    ds_read_b64_tr_b16 a[64:65], v104 offset:0
    ds_read_b64_tr_b16 a[66:67], v104 offset:2048
    v_mfma_f32_16x16x32_bf16 v[36:39], a[100:103], v[192:195], v[36:39]
    v_cvt_pk_bf16_f32 v68, v56, v57
    v_mul_f32 v58, v26, v15
    v_mfma_f32_16x16x32_bf16 v[32:35], a[104:107], v[208:211], v[32:35]
    ds_read_b64_tr_b16 a[68:69], v105 offset:0
    ds_read_b64_tr_b16 a[70:71], v105 offset:2048
    v_mfma_f32_16x16x32_bf16 v[40:43], a[104:107], v[216:219], v[40:43]
    v_mul_f32 v59, v27, v15
    v_cvt_pk_bf16_f32 v69, v58, v59
    v_mfma_f32_16x16x32_bf16 v[44:47], a[108:111], v[216:219], v[44:47]
    ds_read_b64_tr_b16 a[72:73], v104 offset:4096
    v_mul_f32 v60, v28, v15
    v_mfma_f32_16x16x32_bf16 v[36:39], a[108:111], v[208:211], v[36:39]
    ds_read_b64_tr_b16 a[74:75], v104 offset:6144
    s_waitcnt lgkmcnt(6)
    v_mfma_f32_16x16x32_bf16 v[32:35], a[112:115], v[224:227], v[32:35]
    ds_read_b64_tr_b16 a[76:77], v105 offset:4096
    ds_read_b64_tr_b16 a[78:79], v105 offset:6144
    v_mfma_f32_16x16x32_bf16 v[40:43], a[112:115], v[232:235], v[40:43]
    v_mul_f32 v61, v29, v15
    v_cvt_pk_bf16_f32 v70, v60, v61
    v_mfma_f32_16x16x32_bf16 v[44:47], a[116:119], v[232:235], v[44:47]
    ds_read_b64_tr_b16 a[80:81], v104 offset:8192
    ds_read_b64_tr_b16 a[82:83], v104 offset:10240
    v_mfma_f32_16x16x32_bf16 v[36:39], a[116:119], v[224:227], v[36:39]
    v_mul_f32 v62, v30, v15
    v_mul_f32 v63, v31, v15
    v_mfma_f32_16x16x32_bf16 v[32:35], a[120:123], v[240:243], v[32:35]
    ds_read_b64_tr_b16 a[84:85], v105 offset:8192
    ds_read_b64_tr_b16 a[86:87], v105 offset:10240
    v_mfma_f32_16x16x32_bf16 v[40:43], a[120:123], v[248:251], v[40:43]
    v_cvt_pk_bf16_f32 v71, v62, v63
    v_mfma_f32_16x16x32_bf16 v[44:47], a[124:127], v[248:251], v[44:47]
    ds_read_b64_tr_b16 a[88:89], v104 offset:12288
    buffer_store_dwordx4 v[68:71], v124, s[56:59], s63 offen offset:1024 sc1
    v_mfma_f32_16x16x32_bf16 v[36:39], a[124:127], v[240:243], v[36:39]
    ds_read_b64_tr_b16 a[90:91], v104 offset:14336
    v_mul_f32 v48, v32, v14
    s_waitcnt lgkmcnt(6)
    v_mfma_f32_16x16x32_bf16 v[16:19], a[64:67], v[128:131], 0
    ds_read_b64_tr_b16 a[92:93], v105 offset:12288
    ds_read_b64_tr_b16 a[94:95], v105 offset:14336
    v_mul_f32 v49, v33, v14
    v_mfma_f32_16x16x32_bf16 v[24:27], a[64:67], v[136:139], 0
    v_cvt_pk_bf16_f32 v72, v48, v49
    v_mul_f32 v50, v34, v14
    v_mfma_f32_16x16x32_bf16 v[28:31], a[68:71], v[136:139], 0
    ds_read_b64_tr_b16 a[96:97], v104 offset:16384
    ds_read_b64_tr_b16 a[98:99], v104 offset:18432
    v_mfma_f32_16x16x32_bf16 v[20:23], a[68:71], v[128:131], 0
    s_barrier
    v_mul_f32 v51, v35, v14
    v_mfma_f32_16x16x32_bf16 v[16:19], a[72:75], v[144:147], v[16:19]
    ds_read_b64_tr_b16 a[100:101], v105 offset:16384
    ds_read_b64_tr_b16 a[102:103], v105 offset:18432
    v_mfma_f32_16x16x32_bf16 v[24:27], a[72:75], v[152:155], v[24:27]
    v_cvt_pk_bf16_f32 v73, v50, v51
    v_mul_f32 v52, v36, v14
    v_mfma_f32_16x16x32_bf16 v[28:31], a[76:79], v[152:155], v[28:31]
    ds_read_b64_tr_b16 a[104:105], v104 offset:20480
    v_mul_f32 v53, v37, v14
    v_mfma_f32_16x16x32_bf16 v[20:23], a[76:79], v[144:147], v[20:23]
    ds_read_b64_tr_b16 a[106:107], v104 offset:22528
    s_waitcnt lgkmcnt(6)
    v_mfma_f32_16x16x32_bf16 v[16:19], a[80:83], v[160:163], v[16:19]
    ds_read_b64_tr_b16 a[108:109], v105 offset:20480
    ds_read_b64_tr_b16 a[110:111], v105 offset:22528
    v_mfma_f32_16x16x32_bf16 v[24:27], a[80:83], v[168:171], v[24:27]
    v_cvt_pk_bf16_f32 v74, v52, v53
    v_mul_f32 v54, v38, v14
    v_mfma_f32_16x16x32_bf16 v[28:31], a[84:87], v[168:171], v[28:31]
    ds_read_b64_tr_b16 a[112:113], v104 offset:24576
    ds_read_b64_tr_b16 a[114:115], v104 offset:26624
    v_mfma_f32_16x16x32_bf16 v[20:23], a[84:87], v[160:163], v[20:23]
    v_mul_f32 v55, v39, v14
    v_cvt_pk_bf16_f32 v75, v54, v55
    v_mfma_f32_16x16x32_bf16 v[16:19], a[88:91], v[176:179], v[16:19]
    ds_read_b64_tr_b16 a[116:117], v105 offset:24576
    ds_read_b64_tr_b16 a[118:119], v105 offset:26624
    v_mfma_f32_16x16x32_bf16 v[24:27], a[88:91], v[184:187], v[24:27]
    buffer_store_dwordx4 v[72:75], v124, s[56:59], s63 offen offset:2048 sc1
    v_mfma_f32_16x16x32_bf16 v[28:31], a[92:95], v[184:187], v[28:31]
    ds_read_b64_tr_b16 a[120:121], v104 offset:28672
    v_mul_f32 v56, v40, v15
    v_mfma_f32_16x16x32_bf16 v[20:23], a[92:95], v[176:179], v[20:23]
    ds_read_b64_tr_b16 a[122:123], v104 offset:30720
    s_waitcnt lgkmcnt(6)
    v_mfma_f32_16x16x32_bf16 v[16:19], a[96:99], v[192:195], v[16:19]
    ds_read_b64_tr_b16 a[124:125], v105 offset:28672
    ds_read_b64_tr_b16 a[126:127], v105 offset:30720
    v_mfma_f32_16x16x32_bf16 v[24:27], a[96:99], v[200:203], v[24:27]
    v_mul_f32 v57, v41, v15
    v_cvt_pk_bf16_f32 v76, v56, v57
    v_mfma_f32_16x16x32_bf16 v[28:31], a[100:103], v[200:203], v[28:31]
    ds_read_b64_tr_b16 a[64:65], v106 offset:0
    ds_read_b64_tr_b16 a[66:67], v106 offset:2048
    v_mfma_f32_16x16x32_bf16 v[20:23], a[100:103], v[192:195], v[20:23]
    v_mul_f32 v58, v42, v15
    v_mul_f32 v59, v43, v15
    v_mfma_f32_16x16x32_bf16 v[16:19], a[104:107], v[208:211], v[16:19]
    ds_read_b64_tr_b16 a[68:69], v107 offset:0
    ds_read_b64_tr_b16 a[70:71], v107 offset:2048
    v_mfma_f32_16x16x32_bf16 v[24:27], a[104:107], v[216:219], v[24:27]
    v_cvt_pk_bf16_f32 v77, v58, v59
    v_mul_f32 v60, v44, v15
    v_mfma_f32_16x16x32_bf16 v[28:31], a[108:111], v[216:219], v[28:31]
    ds_read_b64_tr_b16 a[72:73], v106 offset:4096
    v_mul_f32 v61, v45, v15
    v_mfma_f32_16x16x32_bf16 v[20:23], a[108:111], v[208:211], v[20:23]
    ds_read_b64_tr_b16 a[74:75], v106 offset:6144
    s_waitcnt lgkmcnt(6)
    v_mfma_f32_16x16x32_bf16 v[16:19], a[112:115], v[224:227], v[16:19]
    ds_read_b64_tr_b16 a[76:77], v107 offset:4096
    ds_read_b64_tr_b16 a[78:79], v107 offset:6144
    v_mfma_f32_16x16x32_bf16 v[24:27], a[112:115], v[232:235], v[24:27]
    v_cvt_pk_bf16_f32 v78, v60, v61
    v_mul_f32 v62, v46, v15
    v_mfma_f32_16x16x32_bf16 v[28:31], a[116:119], v[232:235], v[28:31]
    ds_read_b64_tr_b16 a[80:81], v106 offset:8192
    ds_read_b64_tr_b16 a[82:83], v106 offset:10240
    v_mfma_f32_16x16x32_bf16 v[20:23], a[116:119], v[224:227], v[20:23]
    v_mul_f32 v63, v47, v15
    v_cvt_pk_bf16_f32 v79, v62, v63
    v_mfma_f32_16x16x32_bf16 v[16:19], a[120:123], v[240:243], v[16:19]
    ds_read_b64_tr_b16 a[84:85], v107 offset:8192
    ds_read_b64_tr_b16 a[86:87], v107 offset:10240
    v_mfma_f32_16x16x32_bf16 v[24:27], a[120:123], v[248:251], v[24:27]
    buffer_store_dwordx4 v[76:79], v124, s[56:59], s63 offen offset:3072 sc1
    v_mfma_f32_16x16x32_bf16 v[28:31], a[124:127], v[248:251], v[28:31]
    ds_read_b64_tr_b16 a[88:89], v106 offset:12288
    s_add_u32 s63, s63, 4096
    v_mfma_f32_16x16x32_bf16 v[20:23], a[124:127], v[240:243], v[20:23]
    ds_read_b64_tr_b16 a[90:91], v106 offset:14336
    s_waitcnt lgkmcnt(6)
    v_mfma_f32_16x16x32_bf16 v[32:35], a[64:67], v[128:131], 0
    ds_read_b64_tr_b16 a[92:93], v107 offset:12288
    ds_read_b64_tr_b16 a[94:95], v107 offset:14336
    v_mfma_f32_16x16x32_bf16 v[40:43], a[64:67], v[136:139], 0
    v_mul_f32 v48, v16, v14
    v_mul_f32 v49, v17, v14
    v_mfma_f32_16x16x32_bf16 v[44:47], a[68:71], v[136:139], 0
    ds_read_b64_tr_b16 a[96:97], v106 offset:16384
    ds_read_b64_tr_b16 a[98:99], v106 offset:18432
    v_mfma_f32_16x16x32_bf16 v[36:39], a[68:71], v[128:131], 0
    v_cvt_pk_bf16_f32 v64, v48, v49
    v_mul_f32 v50, v18, v14
    v_mfma_f32_16x16x32_bf16 v[32:35], a[72:75], v[144:147], v[32:35]
    ds_read_b64_tr_b16 a[100:101], v107 offset:16384
    ds_read_b64_tr_b16 a[102:103], v107 offset:18432
    v_mfma_f32_16x16x32_bf16 v[40:43], a[72:75], v[152:155], v[40:43]
    v_mul_f32 v51, v19, v14
    v_cvt_pk_bf16_f32 v65, v50, v51
    v_mfma_f32_16x16x32_bf16 v[44:47], a[76:79], v[152:155], v[44:47]
    ds_read_b64_tr_b16 a[104:105], v106 offset:20480
    v_mul_f32 v52, v20, v14
    v_mfma_f32_16x16x32_bf16 v[36:39], a[76:79], v[144:147], v[36:39]
    ds_read_b64_tr_b16 a[106:107], v106 offset:22528
    s_waitcnt lgkmcnt(6)
    v_mfma_f32_16x16x32_bf16 v[32:35], a[80:83], v[160:163], v[32:35]
    ds_read_b64_tr_b16 a[108:109], v107 offset:20480
    ds_read_b64_tr_b16 a[110:111], v107 offset:22528
    v_mfma_f32_16x16x32_bf16 v[40:43], a[80:83], v[168:171], v[40:43]
    v_mul_f32 v53, v21, v14
    v_cvt_pk_bf16_f32 v66, v52, v53
    v_mfma_f32_16x16x32_bf16 v[44:47], a[84:87], v[168:171], v[44:47]
    ds_read_b64_tr_b16 a[112:113], v106 offset:24576
    ds_read_b64_tr_b16 a[114:115], v106 offset:26624
    v_mfma_f32_16x16x32_bf16 v[36:39], a[84:87], v[160:163], v[36:39]
    v_mul_f32 v54, v22, v14
    v_mul_f32 v55, v23, v14
    v_mfma_f32_16x16x32_bf16 v[32:35], a[88:91], v[176:179], v[32:35]
    ds_read_b64_tr_b16 a[116:117], v107 offset:24576
    ds_read_b64_tr_b16 a[118:119], v107 offset:26624
    v_mfma_f32_16x16x32_bf16 v[40:43], a[88:91], v[184:187], v[40:43]
    v_cvt_pk_bf16_f32 v67, v54, v55
    v_mul_f32 v56, v24, v15
    v_mfma_f32_16x16x32_bf16 v[44:47], a[92:95], v[184:187], v[44:47]
    ds_read_b64_tr_b16 a[120:121], v106 offset:28672
    v_mul_f32 v57, v25, v15
    v_mfma_f32_16x16x32_bf16 v[36:39], a[92:95], v[176:179], v[36:39]
    ds_read_b64_tr_b16 a[122:123], v106 offset:30720
    s_waitcnt lgkmcnt(6)
    v_mfma_f32_16x16x32_bf16 v[32:35], a[96:99], v[192:195], v[32:35]
    ds_read_b64_tr_b16 a[124:125], v107 offset:28672
    ds_read_b64_tr_b16 a[126:127], v107 offset:30720
    v_mfma_f32_16x16x32_bf16 v[40:43], a[96:99], v[200:203], v[40:43]
    buffer_store_dwordx4 v[64:67], v124, s[56:59], s63 offen offset:0 sc1
    v_mfma_f32_16x16x32_bf16 v[44:47], a[100:103], v[200:203], v[44:47]
    ds_read_b64_tr_b16 a[64:65], v104 offset:32768
    ds_read_b64_tr_b16 a[66:67], v104 offset:34816
    v_mfma_f32_16x16x32_bf16 v[36:39], a[100:103], v[192:195], v[36:39]
    v_cvt_pk_bf16_f32 v68, v56, v57
    v_mul_f32 v58, v26, v15
    v_mfma_f32_16x16x32_bf16 v[32:35], a[104:107], v[208:211], v[32:35]
    ds_read_b64_tr_b16 a[68:69], v105 offset:32768
    ds_read_b64_tr_b16 a[70:71], v105 offset:34816
    v_mfma_f32_16x16x32_bf16 v[40:43], a[104:107], v[216:219], v[40:43]
    v_mul_f32 v59, v27, v15
    v_cvt_pk_bf16_f32 v69, v58, v59
    v_mfma_f32_16x16x32_bf16 v[44:47], a[108:111], v[216:219], v[44:47]
    ds_read_b64_tr_b16 a[72:73], v104 offset:36864
    v_mul_f32 v60, v28, v15
    v_mfma_f32_16x16x32_bf16 v[36:39], a[108:111], v[208:211], v[36:39]
    ds_read_b64_tr_b16 a[74:75], v104 offset:38912
    s_waitcnt lgkmcnt(6)
    v_mfma_f32_16x16x32_bf16 v[32:35], a[112:115], v[224:227], v[32:35]
    ds_read_b64_tr_b16 a[76:77], v105 offset:36864
    ds_read_b64_tr_b16 a[78:79], v105 offset:38912
    v_mfma_f32_16x16x32_bf16 v[40:43], a[112:115], v[232:235], v[40:43]
    v_mul_f32 v61, v29, v15
    v_cvt_pk_bf16_f32 v70, v60, v61
    v_mfma_f32_16x16x32_bf16 v[44:47], a[116:119], v[232:235], v[44:47]
    ds_read_b64_tr_b16 a[80:81], v104 offset:40960
    ds_read_b64_tr_b16 a[82:83], v104 offset:43008
    v_mfma_f32_16x16x32_bf16 v[36:39], a[116:119], v[224:227], v[36:39]
    v_mul_f32 v62, v30, v15
    v_mul_f32 v63, v31, v15
    v_mfma_f32_16x16x32_bf16 v[32:35], a[120:123], v[240:243], v[32:35]
    ds_read_b64_tr_b16 a[84:85], v105 offset:40960
    ds_read_b64_tr_b16 a[86:87], v105 offset:43008
    v_mfma_f32_16x16x32_bf16 v[40:43], a[120:123], v[248:251], v[40:43]
    v_cvt_pk_bf16_f32 v71, v62, v63
    v_mfma_f32_16x16x32_bf16 v[44:47], a[124:127], v[248:251], v[44:47]
    ds_read_b64_tr_b16 a[88:89], v104 offset:45056
    buffer_store_dwordx4 v[68:71], v124, s[56:59], s63 offen offset:1024 sc1
    v_mfma_f32_16x16x32_bf16 v[36:39], a[124:127], v[240:243], v[36:39]
    ds_read_b64_tr_b16 a[90:91], v104 offset:47104
    v_mul_f32 v48, v32, v14
    s_waitcnt lgkmcnt(6)
    v_mfma_f32_16x16x32_bf16 v[16:19], a[64:67], v[128:131], 0
    ds_read_b64_tr_b16 a[92:93], v105 offset:45056
    ds_read_b64_tr_b16 a[94:95], v105 offset:47104
    v_mul_f32 v49, v33, v14
    v_mfma_f32_16x16x32_bf16 v[24:27], a[64:67], v[136:139], 0
    v_cvt_pk_bf16_f32 v72, v48, v49
    v_mul_f32 v50, v34, v14
    v_mfma_f32_16x16x32_bf16 v[28:31], a[68:71], v[136:139], 0
    ds_read_b64_tr_b16 a[96:97], v104 offset:49152
    ds_read_b64_tr_b16 a[98:99], v104 offset:51200
    v_mfma_f32_16x16x32_bf16 v[20:23], a[68:71], v[128:131], 0
    s_barrier
    v_mul_f32 v51, v35, v14
    v_mfma_f32_16x16x32_bf16 v[16:19], a[72:75], v[144:147], v[16:19]
    ds_read_b64_tr_b16 a[100:101], v105 offset:49152
    ds_read_b64_tr_b16 a[102:103], v105 offset:51200
    v_mfma_f32_16x16x32_bf16 v[24:27], a[72:75], v[152:155], v[24:27]
    v_cvt_pk_bf16_f32 v73, v50, v51
    v_mul_f32 v52, v36, v14
    v_mfma_f32_16x16x32_bf16 v[28:31], a[76:79], v[152:155], v[28:31]
    ds_read_b64_tr_b16 a[104:105], v104 offset:53248
    v_mul_f32 v53, v37, v14
    v_mfma_f32_16x16x32_bf16 v[20:23], a[76:79], v[144:147], v[20:23]
    ds_read_b64_tr_b16 a[106:107], v104 offset:55296
    s_waitcnt lgkmcnt(6)
    v_mfma_f32_16x16x32_bf16 v[16:19], a[80:83], v[160:163], v[16:19]
    ds_read_b64_tr_b16 a[108:109], v105 offset:53248
    ds_read_b64_tr_b16 a[110:111], v105 offset:55296
    v_mfma_f32_16x16x32_bf16 v[24:27], a[80:83], v[168:171], v[24:27]
    v_cvt_pk_bf16_f32 v74, v52, v53
    v_mul_f32 v54, v38, v14
    v_mfma_f32_16x16x32_bf16 v[28:31], a[84:87], v[168:171], v[28:31]
    ds_read_b64_tr_b16 a[112:113], v104 offset:57344
    ds_read_b64_tr_b16 a[114:115], v104 offset:59392
    v_mfma_f32_16x16x32_bf16 v[20:23], a[84:87], v[160:163], v[20:23]
    v_mul_f32 v55, v39, v14
    v_cvt_pk_bf16_f32 v75, v54, v55
    v_mfma_f32_16x16x32_bf16 v[16:19], a[88:91], v[176:179], v[16:19]
    ds_read_b64_tr_b16 a[116:117], v105 offset:57344
    ds_read_b64_tr_b16 a[118:119], v105 offset:59392
    v_mfma_f32_16x16x32_bf16 v[24:27], a[88:91], v[184:187], v[24:27]
    buffer_store_dwordx4 v[72:75], v124, s[56:59], s63 offen offset:2048 sc1
    v_mfma_f32_16x16x32_bf16 v[28:31], a[92:95], v[184:187], v[28:31]
    ds_read_b64_tr_b16 a[120:121], v104 offset:61440
    v_mul_f32 v56, v40, v15
    v_mfma_f32_16x16x32_bf16 v[20:23], a[92:95], v[176:179], v[20:23]
    ds_read_b64_tr_b16 a[122:123], v104 offset:63488
    s_waitcnt lgkmcnt(6)
    v_mfma_f32_16x16x32_bf16 v[16:19], a[96:99], v[192:195], v[16:19]
    ds_read_b64_tr_b16 a[124:125], v105 offset:61440
    ds_read_b64_tr_b16 a[126:127], v105 offset:63488
    v_mfma_f32_16x16x32_bf16 v[24:27], a[96:99], v[200:203], v[24:27]
    v_mul_f32 v57, v41, v15
    v_cvt_pk_bf16_f32 v76, v56, v57
    v_mfma_f32_16x16x32_bf16 v[28:31], a[100:103], v[200:203], v[28:31]
    ds_read_b64_tr_b16 a[64:65], v106 offset:32768
    ds_read_b64_tr_b16 a[66:67], v106 offset:34816
    v_mfma_f32_16x16x32_bf16 v[20:23], a[100:103], v[192:195], v[20:23]
    v_mul_f32 v58, v42, v15
    v_mul_f32 v59, v43, v15
    v_mfma_f32_16x16x32_bf16 v[16:19], a[104:107], v[208:211], v[16:19]
    ds_read_b64_tr_b16 a[68:69], v107 offset:32768
    ds_read_b64_tr_b16 a[70:71], v107 offset:34816
    v_mfma_f32_16x16x32_bf16 v[24:27], a[104:107], v[216:219], v[24:27]
    v_cvt_pk_bf16_f32 v77, v58, v59
    v_mul_f32 v60, v44, v15
    v_mfma_f32_16x16x32_bf16 v[28:31], a[108:111], v[216:219], v[28:31]
    ds_read_b64_tr_b16 a[72:73], v106 offset:36864
    v_mul_f32 v61, v45, v15
    v_mfma_f32_16x16x32_bf16 v[20:23], a[108:111], v[208:211], v[20:23]
    ds_read_b64_tr_b16 a[74:75], v106 offset:38912
    s_waitcnt lgkmcnt(6)
    v_mfma_f32_16x16x32_bf16 v[16:19], a[112:115], v[224:227], v[16:19]
    ds_read_b64_tr_b16 a[76:77], v107 offset:36864
    ds_read_b64_tr_b16 a[78:79], v107 offset:38912
    v_mfma_f32_16x16x32_bf16 v[24:27], a[112:115], v[232:235], v[24:27]
    v_cvt_pk_bf16_f32 v78, v60, v61
    v_mul_f32 v62, v46, v15
    v_mfma_f32_16x16x32_bf16 v[28:31], a[116:119], v[232:235], v[28:31]
    ds_read_b64_tr_b16 a[80:81], v106 offset:40960
    ds_read_b64_tr_b16 a[82:83], v106 offset:43008
    v_mfma_f32_16x16x32_bf16 v[20:23], a[116:119], v[224:227], v[20:23]
    v_mul_f32 v63, v47, v15
    v_cvt_pk_bf16_f32 v79, v62, v63
    v_mfma_f32_16x16x32_bf16 v[16:19], a[120:123], v[240:243], v[16:19]
    ds_read_b64_tr_b16 a[84:85], v107 offset:40960
    ds_read_b64_tr_b16 a[86:87], v107 offset:43008
    v_mfma_f32_16x16x32_bf16 v[24:27], a[120:123], v[248:251], v[24:27]
    buffer_store_dwordx4 v[76:79], v124, s[56:59], s63 offen offset:3072 sc1
    v_mfma_f32_16x16x32_bf16 v[28:31], a[124:127], v[248:251], v[28:31]
    ds_read_b64_tr_b16 a[88:89], v106 offset:45056
    s_add_u32 s63, s63, 4096
    v_mfma_f32_16x16x32_bf16 v[20:23], a[124:127], v[240:243], v[20:23]
    ds_read_b64_tr_b16 a[90:91], v106 offset:47104
    s_waitcnt lgkmcnt(6)
    v_mfma_f32_16x16x32_bf16 v[32:35], a[64:67], v[128:131], 0
    ds_read_b64_tr_b16 a[92:93], v107 offset:45056
    ds_read_b64_tr_b16 a[94:95], v107 offset:47104
    v_mfma_f32_16x16x32_bf16 v[40:43], a[64:67], v[136:139], 0
    v_mul_f32 v48, v16, v14
    v_mul_f32 v49, v17, v14
    v_mfma_f32_16x16x32_bf16 v[44:47], a[68:71], v[136:139], 0
    ds_read_b64_tr_b16 a[96:97], v106 offset:49152
    ds_read_b64_tr_b16 a[98:99], v106 offset:51200
    v_mfma_f32_16x16x32_bf16 v[36:39], a[68:71], v[128:131], 0
    v_cvt_pk_bf16_f32 v64, v48, v49
    v_mul_f32 v50, v18, v14
    v_mfma_f32_16x16x32_bf16 v[32:35], a[72:75], v[144:147], v[32:35]
    ds_read_b64_tr_b16 a[100:101], v107 offset:49152
    ds_read_b64_tr_b16 a[102:103], v107 offset:51200
    v_mfma_f32_16x16x32_bf16 v[40:43], a[72:75], v[152:155], v[40:43]
    v_mul_f32 v51, v19, v14
    v_cvt_pk_bf16_f32 v65, v50, v51
    v_mfma_f32_16x16x32_bf16 v[44:47], a[76:79], v[152:155], v[44:47]
    ds_read_b64_tr_b16 a[104:105], v106 offset:53248
    v_mul_f32 v52, v20, v14
    v_mfma_f32_16x16x32_bf16 v[36:39], a[76:79], v[144:147], v[36:39]
    ds_read_b64_tr_b16 a[106:107], v106 offset:55296
    s_waitcnt lgkmcnt(6)
    v_mfma_f32_16x16x32_bf16 v[32:35], a[80:83], v[160:163], v[32:35]
    ds_read_b64_tr_b16 a[108:109], v107 offset:53248
    ds_read_b64_tr_b16 a[110:111], v107 offset:55296
    v_mfma_f32_16x16x32_bf16 v[40:43], a[80:83], v[168:171], v[40:43]
    v_mul_f32 v53, v21, v14
    v_cvt_pk_bf16_f32 v66, v52, v53
    v_mfma_f32_16x16x32_bf16 v[44:47], a[84:87], v[168:171], v[44:47]
    ds_read_b64_tr_b16 a[112:113], v106 offset:57344
    ds_read_b64_tr_b16 a[114:115], v106 offset:59392
    v_mfma_f32_16x16x32_bf16 v[36:39], a[84:87], v[160:163], v[36:39]
    v_mul_f32 v54, v22, v14
    v_mul_f32 v55, v23, v14
    v_mfma_f32_16x16x32_bf16 v[32:35], a[88:91], v[176:179], v[32:35]
    ds_read_b64_tr_b16 a[116:117], v107 offset:57344
    ds_read_b64_tr_b16 a[118:119], v107 offset:59392
    v_mfma_f32_16x16x32_bf16 v[40:43], a[88:91], v[184:187], v[40:43]
    v_cvt_pk_bf16_f32 v67, v54, v55
    v_mul_f32 v56, v24, v15
    v_mfma_f32_16x16x32_bf16 v[44:47], a[92:95], v[184:187], v[44:47]
    ds_read_b64_tr_b16 a[120:121], v106 offset:61440
    v_mul_f32 v57, v25, v15
    v_mfma_f32_16x16x32_bf16 v[36:39], a[92:95], v[176:179], v[36:39]
    ds_read_b64_tr_b16 a[122:123], v106 offset:63488
    s_waitcnt lgkmcnt(6)
    v_mfma_f32_16x16x32_bf16 v[32:35], a[96:99], v[192:195], v[32:35]
    ds_read_b64_tr_b16 a[124:125], v107 offset:61440
    ds_read_b64_tr_b16 a[126:127], v107 offset:63488
    v_mfma_f32_16x16x32_bf16 v[40:43], a[96:99], v[200:203], v[40:43]
    buffer_store_dwordx4 v[64:67], v124, s[56:59], s63 offen offset:0 sc1
    v_mfma_f32_16x16x32_bf16 v[44:47], a[100:103], v[200:203], v[44:47]
    ds_read_b64_tr_b16 a[64:65], v108 offset:16384
    ds_read_b64_tr_b16 a[66:67], v108 offset:18432
    v_mfma_f32_16x16x32_bf16 v[36:39], a[100:103], v[192:195], v[36:39]
    v_cvt_pk_bf16_f32 v68, v56, v57
    v_mul_f32 v58, v26, v15
    v_mfma_f32_16x16x32_bf16 v[32:35], a[104:107], v[208:211], v[32:35]
    ds_read_b64_tr_b16 a[68:69], v109 offset:16384
    ds_read_b64_tr_b16 a[70:71], v109 offset:18432
    v_mfma_f32_16x16x32_bf16 v[40:43], a[104:107], v[216:219], v[40:43]
    v_mul_f32 v59, v27, v15
    v_cvt_pk_bf16_f32 v69, v58, v59
    v_mfma_f32_16x16x32_bf16 v[44:47], a[108:111], v[216:219], v[44:47]
    ds_read_b64_tr_b16 a[72:73], v108 offset:20480
    v_mul_f32 v60, v28, v15
    v_mfma_f32_16x16x32_bf16 v[36:39], a[108:111], v[208:211], v[36:39]
    ds_read_b64_tr_b16 a[74:75], v108 offset:22528
    s_waitcnt lgkmcnt(6)
    v_mfma_f32_16x16x32_bf16 v[32:35], a[112:115], v[224:227], v[32:35]
    ds_read_b64_tr_b16 a[76:77], v109 offset:20480
    ds_read_b64_tr_b16 a[78:79], v109 offset:22528
    v_mfma_f32_16x16x32_bf16 v[40:43], a[112:115], v[232:235], v[40:43]
    v_mul_f32 v61, v29, v15
    v_cvt_pk_bf16_f32 v70, v60, v61
    v_mfma_f32_16x16x32_bf16 v[44:47], a[116:119], v[232:235], v[44:47]
    ds_read_b64_tr_b16 a[80:81], v108 offset:24576
    ds_read_b64_tr_b16 a[82:83], v108 offset:26624
    v_mfma_f32_16x16x32_bf16 v[36:39], a[116:119], v[224:227], v[36:39]
    v_mul_f32 v62, v30, v15
    v_mul_f32 v63, v31, v15
    v_mfma_f32_16x16x32_bf16 v[32:35], a[120:123], v[240:243], v[32:35]
    ds_read_b64_tr_b16 a[84:85], v109 offset:24576
    ds_read_b64_tr_b16 a[86:87], v109 offset:26624
    v_mfma_f32_16x16x32_bf16 v[40:43], a[120:123], v[248:251], v[40:43]
    v_cvt_pk_bf16_f32 v71, v62, v63
    v_mfma_f32_16x16x32_bf16 v[44:47], a[124:127], v[248:251], v[44:47]
    ds_read_b64_tr_b16 a[88:89], v108 offset:28672
    buffer_store_dwordx4 v[68:71], v124, s[56:59], s63 offen offset:1024 sc1
    v_mfma_f32_16x16x32_bf16 v[36:39], a[124:127], v[240:243], v[36:39]
    ds_read_b64_tr_b16 a[90:91], v108 offset:30720
    v_mov_b32 v13, 3
    v_mul_f32 v48, v32, v14
    s_waitcnt lgkmcnt(6)
    v_mfma_f32_16x16x32_bf16 v[16:19], a[64:67], v[128:131], 0
    ds_read_b64_tr_b16 a[92:93], v109 offset:28672
    ds_read_b64_tr_b16 a[94:95], v109 offset:30720
    v_mul_f32 v49, v33, v14
    v_mfma_f32_16x16x32_bf16 v[24:27], a[64:67], v[136:139], 0
    v_cvt_pk_bf16_f32 v72, v48, v49
    v_mul_f32 v50, v34, v14
    v_mul_f32 v51, v35, v14
    v_mfma_f32_16x16x32_bf16 v[28:31], a[68:71], v[136:139], 0
    ds_read_b64_tr_b16 a[96:97], v108 offset:0
    ds_read_b64_tr_b16 a[98:99], v108 offset:2048
    v_mfma_f32_16x16x32_bf16 v[20:23], a[68:71], v[128:131], 0
    s_barrier
    s_waitcnt vmcnt(2)
    buffer_store_dword v13, v127, s[12:15], 0 offen sc1
    v_mfma_f32_16x16x32_bf16 v[16:19], a[72:75], v[144:147], v[16:19]
    ds_read_b64_tr_b16 a[100:101], v109 offset:0
    ds_read_b64_tr_b16 a[102:103], v109 offset:2048
    v_mfma_f32_16x16x32_bf16 v[24:27], a[72:75], v[152:155], v[24:27]
    v_cvt_pk_bf16_f32 v73, v50, v51
    v_mul_f32 v52, v36, v14
    v_mfma_f32_16x16x32_bf16 v[28:31], a[76:79], v[152:155], v[28:31]
    ds_read_b64_tr_b16 a[104:105], v108 offset:4096
    v_mul_f32 v53, v37, v14
    v_mfma_f32_16x16x32_bf16 v[20:23], a[76:79], v[144:147], v[20:23]
    ds_read_b64_tr_b16 a[106:107], v108 offset:6144
    s_waitcnt lgkmcnt(6)
    v_mfma_f32_16x16x32_bf16 v[16:19], a[80:83], v[160:163], v[16:19]
    ds_read_b64_tr_b16 a[108:109], v109 offset:4096
    ds_read_b64_tr_b16 a[110:111], v109 offset:6144
    v_mfma_f32_16x16x32_bf16 v[24:27], a[80:83], v[168:171], v[24:27]
    v_cvt_pk_bf16_f32 v74, v52, v53
    v_mul_f32 v54, v38, v14
    v_mfma_f32_16x16x32_bf16 v[28:31], a[84:87], v[168:171], v[28:31]
    ds_read_b64_tr_b16 a[112:113], v108 offset:8192
    ds_read_b64_tr_b16 a[114:115], v108 offset:10240
    v_mfma_f32_16x16x32_bf16 v[20:23], a[84:87], v[160:163], v[20:23]
    v_mul_f32 v55, v39, v14
    v_cvt_pk_bf16_f32 v75, v54, v55
    v_mfma_f32_16x16x32_bf16 v[16:19], a[88:91], v[176:179], v[16:19]
    ds_read_b64_tr_b16 a[116:117], v109 offset:8192
    ds_read_b64_tr_b16 a[118:119], v109 offset:10240
    v_mfma_f32_16x16x32_bf16 v[24:27], a[88:91], v[184:187], v[24:27]
    buffer_store_dwordx4 v[72:75], v124, s[56:59], s63 offen offset:2048 sc1
    v_mfma_f32_16x16x32_bf16 v[28:31], a[92:95], v[184:187], v[28:31]
    ds_read_b64_tr_b16 a[120:121], v108 offset:12288
    v_mul_f32 v56, v40, v15
    v_mfma_f32_16x16x32_bf16 v[20:23], a[92:95], v[176:179], v[20:23]
    ds_read_b64_tr_b16 a[122:123], v108 offset:14336
    s_waitcnt lgkmcnt(6)
    v_mfma_f32_16x16x32_bf16 v[16:19], a[96:99], v[192:195], v[16:19]
    ds_read_b64_tr_b16 a[124:125], v109 offset:12288
    ds_read_b64_tr_b16 a[126:127], v109 offset:14336
    v_mfma_f32_16x16x32_bf16 v[24:27], a[96:99], v[200:203], v[24:27]
    v_mul_f32 v57, v41, v15
    v_cvt_pk_bf16_f32 v76, v56, v57
    v_mfma_f32_16x16x32_bf16 v[28:31], a[100:103], v[200:203], v[28:31]
    ds_read_b64_tr_b16 a[64:65], v110 offset:16384
    ds_read_b64_tr_b16 a[66:67], v110 offset:18432
    v_mfma_f32_16x16x32_bf16 v[20:23], a[100:103], v[192:195], v[20:23]
    v_mul_f32 v58, v42, v15
    v_mul_f32 v59, v43, v15
    v_mfma_f32_16x16x32_bf16 v[16:19], a[104:107], v[208:211], v[16:19]
    ds_read_b64_tr_b16 a[68:69], v111 offset:16384
    ds_read_b64_tr_b16 a[70:71], v111 offset:18432
    v_mfma_f32_16x16x32_bf16 v[24:27], a[104:107], v[216:219], v[24:27]
    v_cvt_pk_bf16_f32 v77, v58, v59
    v_mul_f32 v60, v44, v15
    v_mfma_f32_16x16x32_bf16 v[28:31], a[108:111], v[216:219], v[28:31]
    ds_read_b64_tr_b16 a[72:73], v110 offset:20480
    v_mul_f32 v61, v45, v15
    v_mfma_f32_16x16x32_bf16 v[20:23], a[108:111], v[208:211], v[20:23]
    ds_read_b64_tr_b16 a[74:75], v110 offset:22528
    s_waitcnt lgkmcnt(6)
    v_mfma_f32_16x16x32_bf16 v[16:19], a[112:115], v[224:227], v[16:19]
    ds_read_b64_tr_b16 a[76:77], v111 offset:20480
    ds_read_b64_tr_b16 a[78:79], v111 offset:22528
    v_mfma_f32_16x16x32_bf16 v[24:27], a[112:115], v[232:235], v[24:27]
    v_cvt_pk_bf16_f32 v78, v60, v61
    v_mul_f32 v62, v46, v15
    v_mfma_f32_16x16x32_bf16 v[28:31], a[116:119], v[232:235], v[28:31]
    ds_read_b64_tr_b16 a[80:81], v110 offset:24576
    ds_read_b64_tr_b16 a[82:83], v110 offset:26624
    v_mfma_f32_16x16x32_bf16 v[20:23], a[116:119], v[224:227], v[20:23]
    v_mul_f32 v63, v47, v15
    v_cvt_pk_bf16_f32 v79, v62, v63
    v_mfma_f32_16x16x32_bf16 v[16:19], a[120:123], v[240:243], v[16:19]
    ds_read_b64_tr_b16 a[84:85], v111 offset:24576
    ds_read_b64_tr_b16 a[86:87], v111 offset:26624
    v_mfma_f32_16x16x32_bf16 v[24:27], a[120:123], v[248:251], v[24:27]
    buffer_store_dwordx4 v[76:79], v124, s[56:59], s63 offen offset:3072 sc1
    v_mfma_f32_16x16x32_bf16 v[28:31], a[124:127], v[248:251], v[28:31]
    ds_read_b64_tr_b16 a[88:89], v110 offset:28672
    s_add_u32 s63, s63, 4096
    v_mfma_f32_16x16x32_bf16 v[20:23], a[124:127], v[240:243], v[20:23]
    ds_read_b64_tr_b16 a[90:91], v110 offset:30720
    s_waitcnt lgkmcnt(6)
    v_mfma_f32_16x16x32_bf16 v[32:35], a[64:67], v[128:131], 0
    ds_read_b64_tr_b16 a[92:93], v111 offset:28672
    ds_read_b64_tr_b16 a[94:95], v111 offset:30720
    v_mfma_f32_16x16x32_bf16 v[40:43], a[64:67], v[136:139], 0
    v_mul_f32 v48, v16, v14
    v_mul_f32 v49, v17, v14
    v_mfma_f32_16x16x32_bf16 v[44:47], a[68:71], v[136:139], 0
    ds_read_b64_tr_b16 a[96:97], v110 offset:0
    ds_read_b64_tr_b16 a[98:99], v110 offset:2048
    v_mfma_f32_16x16x32_bf16 v[36:39], a[68:71], v[128:131], 0
    v_cvt_pk_bf16_f32 v64, v48, v49
    v_mul_f32 v50, v18, v14
    v_mfma_f32_16x16x32_bf16 v[32:35], a[72:75], v[144:147], v[32:35]
    ds_read_b64_tr_b16 a[100:101], v111 offset:0
    ds_read_b64_tr_b16 a[102:103], v111 offset:2048
    v_mfma_f32_16x16x32_bf16 v[40:43], a[72:75], v[152:155], v[40:43]
    v_mul_f32 v51, v19, v14
    v_cvt_pk_bf16_f32 v65, v50, v51
    v_mfma_f32_16x16x32_bf16 v[44:47], a[76:79], v[152:155], v[44:47]
    ds_read_b64_tr_b16 a[104:105], v110 offset:4096
    v_mul_f32 v52, v20, v14
    v_mfma_f32_16x16x32_bf16 v[36:39], a[76:79], v[144:147], v[36:39]
    ds_read_b64_tr_b16 a[106:107], v110 offset:6144
    s_waitcnt lgkmcnt(6)
    v_mfma_f32_16x16x32_bf16 v[32:35], a[80:83], v[160:163], v[32:35]
    ds_read_b64_tr_b16 a[108:109], v111 offset:4096
    ds_read_b64_tr_b16 a[110:111], v111 offset:6144
    v_mfma_f32_16x16x32_bf16 v[40:43], a[80:83], v[168:171], v[40:43]
    v_mul_f32 v53, v21, v14
    v_cvt_pk_bf16_f32 v66, v52, v53
    v_mfma_f32_16x16x32_bf16 v[44:47], a[84:87], v[168:171], v[44:47]
    ds_read_b64_tr_b16 a[112:113], v110 offset:8192
    ds_read_b64_tr_b16 a[114:115], v110 offset:10240
    v_mfma_f32_16x16x32_bf16 v[36:39], a[84:87], v[160:163], v[36:39]
    v_mul_f32 v54, v22, v14
    v_mul_f32 v55, v23, v14
    v_mfma_f32_16x16x32_bf16 v[32:35], a[88:91], v[176:179], v[32:35]
    ds_read_b64_tr_b16 a[116:117], v111 offset:8192
    ds_read_b64_tr_b16 a[118:119], v111 offset:10240
    v_mfma_f32_16x16x32_bf16 v[40:43], a[88:91], v[184:187], v[40:43]
    v_cvt_pk_bf16_f32 v67, v54, v55
    v_mul_f32 v56, v24, v15
    v_mfma_f32_16x16x32_bf16 v[44:47], a[92:95], v[184:187], v[44:47]
    ds_read_b64_tr_b16 a[120:121], v110 offset:12288
    v_mul_f32 v57, v25, v15
    v_mfma_f32_16x16x32_bf16 v[36:39], a[92:95], v[176:179], v[36:39]
    ds_read_b64_tr_b16 a[122:123], v110 offset:14336
    s_waitcnt lgkmcnt(6)
    v_mfma_f32_16x16x32_bf16 v[32:35], a[96:99], v[192:195], v[32:35]
    ds_read_b64_tr_b16 a[124:125], v111 offset:12288
    ds_read_b64_tr_b16 a[126:127], v111 offset:14336
    v_mfma_f32_16x16x32_bf16 v[40:43], a[96:99], v[200:203], v[40:43]
    buffer_store_dwordx4 v[64:67], v124, s[56:59], s63 offen offset:0 sc1
    v_mfma_f32_16x16x32_bf16 v[44:47], a[100:103], v[200:203], v[44:47]
    ds_read_b64_tr_b16 a[64:65], v108 offset:32768
    ds_read_b64_tr_b16 a[66:67], v108 offset:34816
    v_mfma_f32_16x16x32_bf16 v[36:39], a[100:103], v[192:195], v[36:39]
    v_cvt_pk_bf16_f32 v68, v56, v57
    v_mul_f32 v58, v26, v15
    v_mfma_f32_16x16x32_bf16 v[32:35], a[104:107], v[208:211], v[32:35]
    ds_read_b64_tr_b16 a[68:69], v109 offset:32768
    ds_read_b64_tr_b16 a[70:71], v109 offset:34816
    v_mfma_f32_16x16x32_bf16 v[40:43], a[104:107], v[216:219], v[40:43]
    v_mul_f32 v59, v27, v15
    v_cvt_pk_bf16_f32 v69, v58, v59
    v_mfma_f32_16x16x32_bf16 v[44:47], a[108:111], v[216:219], v[44:47]
    ds_read_b64_tr_b16 a[72:73], v108 offset:36864
    v_mul_f32 v60, v28, v15
    v_mfma_f32_16x16x32_bf16 v[36:39], a[108:111], v[208:211], v[36:39]
    ds_read_b64_tr_b16 a[74:75], v108 offset:38912
    s_waitcnt lgkmcnt(6)
    v_mfma_f32_16x16x32_bf16 v[32:35], a[112:115], v[224:227], v[32:35]
    ds_read_b64_tr_b16 a[76:77], v109 offset:36864
    ds_read_b64_tr_b16 a[78:79], v109 offset:38912
    v_mfma_f32_16x16x32_bf16 v[40:43], a[112:115], v[232:235], v[40:43]
    v_mul_f32 v61, v29, v15
    v_cvt_pk_bf16_f32 v70, v60, v61
    v_mfma_f32_16x16x32_bf16 v[44:47], a[116:119], v[232:235], v[44:47]
    ds_read_b64_tr_b16 a[80:81], v108 offset:40960
    ds_read_b64_tr_b16 a[82:83], v108 offset:43008
    v_mfma_f32_16x16x32_bf16 v[36:39], a[116:119], v[224:227], v[36:39]
    v_mul_f32 v62, v30, v15
    v_mul_f32 v63, v31, v15
    v_mfma_f32_16x16x32_bf16 v[32:35], a[120:123], v[240:243], v[32:35]
    ds_read_b64_tr_b16 a[84:85], v109 offset:40960
    ds_read_b64_tr_b16 a[86:87], v109 offset:43008
    v_mfma_f32_16x16x32_bf16 v[40:43], a[120:123], v[248:251], v[40:43]
    v_cvt_pk_bf16_f32 v71, v62, v63
    v_mfma_f32_16x16x32_bf16 v[44:47], a[124:127], v[248:251], v[44:47]
    ds_read_b64_tr_b16 a[88:89], v108 offset:45056
    buffer_store_dwordx4 v[68:71], v124, s[56:59], s63 offen offset:1024 sc1
    v_mfma_f32_16x16x32_bf16 v[36:39], a[124:127], v[240:243], v[36:39]
    ds_read_b64_tr_b16 a[90:91], v108 offset:47104
    v_mul_f32 v48, v32, v14
    s_waitcnt lgkmcnt(6)
    v_mfma_f32_16x16x32_bf16 v[16:19], a[64:67], v[128:131], 0
    ds_read_b64_tr_b16 a[92:93], v109 offset:45056
    ds_read_b64_tr_b16 a[94:95], v109 offset:47104
    v_mfma_f32_16x16x32_bf16 v[24:27], a[64:67], v[136:139], 0
    v_mul_f32 v49, v33, v14
    v_cvt_pk_bf16_f32 v72, v48, v49
    v_mfma_f32_16x16x32_bf16 v[28:31], a[68:71], v[136:139], 0
    ds_read_b64_tr_b16 a[96:97], v108 offset:49152
    ds_read_b64_tr_b16 a[98:99], v108 offset:51200
    v_mfma_f32_16x16x32_bf16 v[20:23], a[68:71], v[128:131], 0
    v_mul_f32 v50, v34, v14
    v_mul_f32 v51, v35, v14
    v_mfma_f32_16x16x32_bf16 v[16:19], a[72:75], v[144:147], v[16:19]
    ds_read_b64_tr_b16 a[100:101], v109 offset:49152
    ds_read_b64_tr_b16 a[102:103], v109 offset:51200
    v_mfma_f32_16x16x32_bf16 v[24:27], a[72:75], v[152:155], v[24:27]
    v_cvt_pk_bf16_f32 v73, v50, v51
    v_mul_f32 v52, v36, v14
    v_mfma_f32_16x16x32_bf16 v[28:31], a[76:79], v[152:155], v[28:31]
    ds_read_b64_tr_b16 a[104:105], v108 offset:53248
    v_mul_f32 v53, v37, v14
    v_mfma_f32_16x16x32_bf16 v[20:23], a[76:79], v[144:147], v[20:23]
    ds_read_b64_tr_b16 a[106:107], v108 offset:55296
    s_waitcnt lgkmcnt(6)
    v_mfma_f32_16x16x32_bf16 v[16:19], a[80:83], v[160:163], v[16:19]
    ds_read_b64_tr_b16 a[108:109], v109 offset:53248
    ds_read_b64_tr_b16 a[110:111], v109 offset:55296
    v_mfma_f32_16x16x32_bf16 v[24:27], a[80:83], v[168:171], v[24:27]
    v_cvt_pk_bf16_f32 v74, v52, v53
    v_mul_f32 v54, v38, v14
    v_mfma_f32_16x16x32_bf16 v[28:31], a[84:87], v[168:171], v[28:31]
    ds_read_b64_tr_b16 a[112:113], v108 offset:57344
    ds_read_b64_tr_b16 a[114:115], v108 offset:59392
    v_mfma_f32_16x16x32_bf16 v[20:23], a[84:87], v[160:163], v[20:23]
    v_mul_f32 v55, v39, v14
    v_cvt_pk_bf16_f32 v75, v54, v55
    v_mfma_f32_16x16x32_bf16 v[16:19], a[88:91], v[176:179], v[16:19]
    ds_read_b64_tr_b16 a[116:117], v109 offset:57344
    ds_read_b64_tr_b16 a[118:119], v109 offset:59392
    v_mfma_f32_16x16x32_bf16 v[24:27], a[88:91], v[184:187], v[24:27]
    buffer_store_dwordx4 v[72:75], v124, s[56:59], s63 offen offset:2048 sc1
    v_mfma_f32_16x16x32_bf16 v[28:31], a[92:95], v[184:187], v[28:31]
    ds_read_b64_tr_b16 a[120:121], v108 offset:61440
    v_mul_f32 v56, v40, v15
    v_mfma_f32_16x16x32_bf16 v[20:23], a[92:95], v[176:179], v[20:23]
    ds_read_b64_tr_b16 a[122:123], v108 offset:63488
    s_waitcnt lgkmcnt(6)
    v_mfma_f32_16x16x32_bf16 v[16:19], a[96:99], v[192:195], v[16:19]
    ds_read_b64_tr_b16 a[124:125], v109 offset:61440
    ds_read_b64_tr_b16 a[126:127], v109 offset:63488
    v_mfma_f32_16x16x32_bf16 v[24:27], a[96:99], v[200:203], v[24:27]
    v_mul_f32 v57, v41, v15
    v_cvt_pk_bf16_f32 v76, v56, v57
    v_mfma_f32_16x16x32_bf16 v[28:31], a[100:103], v[200:203], v[28:31]
    ds_read_b64_tr_b16 a[64:65], v110 offset:32768
    ds_read_b64_tr_b16 a[66:67], v110 offset:34816
    v_mfma_f32_16x16x32_bf16 v[20:23], a[100:103], v[192:195], v[20:23]
    v_mul_f32 v58, v42, v15
    v_mul_f32 v59, v43, v15
    v_mfma_f32_16x16x32_bf16 v[16:19], a[104:107], v[208:211], v[16:19]
    ds_read_b64_tr_b16 a[68:69], v111 offset:32768
    ds_read_b64_tr_b16 a[70:71], v111 offset:34816
    v_mfma_f32_16x16x32_bf16 v[24:27], a[104:107], v[216:219], v[24:27]
    v_cvt_pk_bf16_f32 v77, v58, v59
    v_mul_f32 v60, v44, v15
    v_mfma_f32_16x16x32_bf16 v[28:31], a[108:111], v[216:219], v[28:31]
    ds_read_b64_tr_b16 a[72:73], v110 offset:36864
    v_mul_f32 v61, v45, v15
    v_mfma_f32_16x16x32_bf16 v[20:23], a[108:111], v[208:211], v[20:23]
    ds_read_b64_tr_b16 a[74:75], v110 offset:38912
    s_waitcnt lgkmcnt(6)
    v_mfma_f32_16x16x32_bf16 v[16:19], a[112:115], v[224:227], v[16:19]
    ds_read_b64_tr_b16 a[76:77], v111 offset:36864
    ds_read_b64_tr_b16 a[78:79], v111 offset:38912
    v_mfma_f32_16x16x32_bf16 v[24:27], a[112:115], v[232:235], v[24:27]
    v_cvt_pk_bf16_f32 v78, v60, v61
    v_mul_f32 v62, v46, v15
    v_mfma_f32_16x16x32_bf16 v[28:31], a[116:119], v[232:235], v[28:31]
    ds_read_b64_tr_b16 a[80:81], v110 offset:40960
    ds_read_b64_tr_b16 a[82:83], v110 offset:43008
    v_mfma_f32_16x16x32_bf16 v[20:23], a[116:119], v[224:227], v[20:23]
    v_mul_f32 v63, v47, v15
    v_cvt_pk_bf16_f32 v79, v62, v63
    v_mfma_f32_16x16x32_bf16 v[16:19], a[120:123], v[240:243], v[16:19]
    ds_read_b64_tr_b16 a[84:85], v111 offset:40960
    ds_read_b64_tr_b16 a[86:87], v111 offset:43008
    v_mfma_f32_16x16x32_bf16 v[24:27], a[120:123], v[248:251], v[24:27]
    buffer_store_dwordx4 v[76:79], v124, s[56:59], s63 offen offset:3072 sc1
    v_mfma_f32_16x16x32_bf16 v[28:31], a[124:127], v[248:251], v[28:31]
    ds_read_b64_tr_b16 a[88:89], v110 offset:45056
    s_add_u32 s63, s63, 4096
    v_mfma_f32_16x16x32_bf16 v[20:23], a[124:127], v[240:243], v[20:23]
    ds_read_b64_tr_b16 a[90:91], v110 offset:47104
    s_waitcnt lgkmcnt(6)
    v_mfma_f32_16x16x32_bf16 v[32:35], a[64:67], v[128:131], 0
    ds_read_b64_tr_b16 a[92:93], v111 offset:45056
    ds_read_b64_tr_b16 a[94:95], v111 offset:47104
    v_mfma_f32_16x16x32_bf16 v[40:43], a[64:67], v[136:139], 0
    v_mul_f32 v48, v16, v14
    v_mul_f32 v49, v17, v14
    v_mfma_f32_16x16x32_bf16 v[44:47], a[68:71], v[136:139], 0
    ds_read_b64_tr_b16 a[96:97], v110 offset:49152
    ds_read_b64_tr_b16 a[98:99], v110 offset:51200
    v_mfma_f32_16x16x32_bf16 v[36:39], a[68:71], v[128:131], 0
    v_cvt_pk_bf16_f32 v64, v48, v49
    v_mul_f32 v50, v18, v14
    v_mfma_f32_16x16x32_bf16 v[32:35], a[72:75], v[144:147], v[32:35]
    ds_read_b64_tr_b16 a[100:101], v111 offset:49152
    ds_read_b64_tr_b16 a[102:103], v111 offset:51200
    v_mfma_f32_16x16x32_bf16 v[40:43], a[72:75], v[152:155], v[40:43]
    v_mul_f32 v51, v19, v14
    v_cvt_pk_bf16_f32 v65, v50, v51
    v_mfma_f32_16x16x32_bf16 v[44:47], a[76:79], v[152:155], v[44:47]
    ds_read_b64_tr_b16 a[104:105], v110 offset:53248
    v_mul_f32 v52, v20, v14
    v_mfma_f32_16x16x32_bf16 v[36:39], a[76:79], v[144:147], v[36:39]
    ds_read_b64_tr_b16 a[106:107], v110 offset:55296
    s_waitcnt lgkmcnt(6)
    v_mfma_f32_16x16x32_bf16 v[32:35], a[80:83], v[160:163], v[32:35]
    ds_read_b64_tr_b16 a[108:109], v111 offset:53248
    ds_read_b64_tr_b16 a[110:111], v111 offset:55296
    v_mfma_f32_16x16x32_bf16 v[40:43], a[80:83], v[168:171], v[40:43]
    v_mul_f32 v53, v21, v14
    v_cvt_pk_bf16_f32 v66, v52, v53
    v_mfma_f32_16x16x32_bf16 v[44:47], a[84:87], v[168:171], v[44:47]
    ds_read_b64_tr_b16 a[112:113], v110 offset:57344
    ds_read_b64_tr_b16 a[114:115], v110 offset:59392
    v_mfma_f32_16x16x32_bf16 v[36:39], a[84:87], v[160:163], v[36:39]
    v_mul_f32 v54, v22, v14
    v_mul_f32 v55, v23, v14
    v_mfma_f32_16x16x32_bf16 v[32:35], a[88:91], v[176:179], v[32:35]
    ds_read_b64_tr_b16 a[116:117], v111 offset:57344
    ds_read_b64_tr_b16 a[118:119], v111 offset:59392
    v_mfma_f32_16x16x32_bf16 v[40:43], a[88:91], v[184:187], v[40:43]
    v_cvt_pk_bf16_f32 v67, v54, v55
    v_mul_f32 v56, v24, v15
    v_mfma_f32_16x16x32_bf16 v[44:47], a[92:95], v[184:187], v[44:47]
    ds_read_b64_tr_b16 a[120:121], v110 offset:61440
    v_mul_f32 v57, v25, v15
    v_mfma_f32_16x16x32_bf16 v[36:39], a[92:95], v[176:179], v[36:39]
    ds_read_b64_tr_b16 a[122:123], v110 offset:63488
    s_waitcnt lgkmcnt(6)
    v_mfma_f32_16x16x32_bf16 v[32:35], a[96:99], v[192:195], v[32:35]
    ds_read_b64_tr_b16 a[124:125], v111 offset:61440
    ds_read_b64_tr_b16 a[126:127], v111 offset:63488
    v_mfma_f32_16x16x32_bf16 v[40:43], a[96:99], v[200:203], v[40:43]
    buffer_store_dwordx4 v[64:67], v124, s[56:59], s63 offen offset:0 sc1
    v_mfma_f32_16x16x32_bf16 v[44:47], a[100:103], v[200:203], v[44:47]
    ds_read_b64_tr_b16 a[64:65], v112 offset:0
    ds_read_b64_tr_b16 a[66:67], v112 offset:2048
    v_mfma_f32_16x16x32_bf16 v[36:39], a[100:103], v[192:195], v[36:39]
    v_cvt_pk_bf16_f32 v68, v56, v57
    v_mul_f32 v58, v26, v15
    v_mfma_f32_16x16x32_bf16 v[32:35], a[104:107], v[208:211], v[32:35]
    ds_read_b64_tr_b16 a[68:69], v113 offset:0
    ds_read_b64_tr_b16 a[70:71], v113 offset:2048
    v_mfma_f32_16x16x32_bf16 v[40:43], a[104:107], v[216:219], v[40:43]
    v_mul_f32 v59, v27, v15
    v_cvt_pk_bf16_f32 v69, v58, v59
    v_mfma_f32_16x16x32_bf16 v[44:47], a[108:111], v[216:219], v[44:47]
    ds_read_b64_tr_b16 a[72:73], v112 offset:4096
    v_mul_f32 v60, v28, v15
    v_mfma_f32_16x16x32_bf16 v[36:39], a[108:111], v[208:211], v[36:39]
    ds_read_b64_tr_b16 a[74:75], v112 offset:6144
    s_waitcnt lgkmcnt(6)
    v_mfma_f32_16x16x32_bf16 v[32:35], a[112:115], v[224:227], v[32:35]
    ds_read_b64_tr_b16 a[76:77], v113 offset:4096
    ds_read_b64_tr_b16 a[78:79], v113 offset:6144
    v_mfma_f32_16x16x32_bf16 v[40:43], a[112:115], v[232:235], v[40:43]
    v_mul_f32 v61, v29, v15
    v_cvt_pk_bf16_f32 v70, v60, v61
    v_mfma_f32_16x16x32_bf16 v[44:47], a[116:119], v[232:235], v[44:47]
    ds_read_b64_tr_b16 a[80:81], v112 offset:8192
    ds_read_b64_tr_b16 a[82:83], v112 offset:10240
    v_mfma_f32_16x16x32_bf16 v[36:39], a[116:119], v[224:227], v[36:39]
    v_mul_f32 v62, v30, v15
    v_mul_f32 v63, v31, v15
    v_mfma_f32_16x16x32_bf16 v[32:35], a[120:123], v[240:243], v[32:35]
    ds_read_b64_tr_b16 a[84:85], v113 offset:8192
    ds_read_b64_tr_b16 a[86:87], v113 offset:10240
    v_mfma_f32_16x16x32_bf16 v[40:43], a[120:123], v[248:251], v[40:43]
    v_cvt_pk_bf16_f32 v71, v62, v63
    v_mfma_f32_16x16x32_bf16 v[44:47], a[124:127], v[248:251], v[44:47]
    ds_read_b64_tr_b16 a[88:89], v112 offset:12288
    buffer_store_dwordx4 v[68:71], v124, s[56:59], s63 offen offset:1024 sc1
    v_mfma_f32_16x16x32_bf16 v[36:39], a[124:127], v[240:243], v[36:39]
    ds_read_b64_tr_b16 a[90:91], v112 offset:14336
    v_mul_f32 v48, v32, v14
    s_waitcnt lgkmcnt(6)
    v_mfma_f32_16x16x32_bf16 v[16:19], a[64:67], v[128:131], 0
    ds_read_b64_tr_b16 a[92:93], v113 offset:12288
    ds_read_b64_tr_b16 a[94:95], v113 offset:14336
    v_mfma_f32_16x16x32_bf16 v[24:27], a[64:67], v[136:139], 0
    v_mul_f32 v49, v33, v14
    v_cvt_pk_bf16_f32 v72, v48, v49
    v_mfma_f32_16x16x32_bf16 v[28:31], a[68:71], v[136:139], 0
    ds_read_b64_tr_b16 a[96:97], v112 offset:16384
    ds_read_b64_tr_b16 a[98:99], v112 offset:18432
    v_mfma_f32_16x16x32_bf16 v[20:23], a[68:71], v[128:131], 0
    v_mul_f32 v50, v34, v14
    v_mul_f32 v51, v35, v14
    v_mfma_f32_16x16x32_bf16 v[16:19], a[72:75], v[144:147], v[16:19]
    ds_read_b64_tr_b16 a[100:101], v113 offset:16384
    ds_read_b64_tr_b16 a[102:103], v113 offset:18432
    v_mfma_f32_16x16x32_bf16 v[24:27], a[72:75], v[152:155], v[24:27]
    v_cvt_pk_bf16_f32 v73, v50, v51
    v_mul_f32 v52, v36, v14
    v_mfma_f32_16x16x32_bf16 v[28:31], a[76:79], v[152:155], v[28:31]
    ds_read_b64_tr_b16 a[104:105], v112 offset:20480
    v_mul_f32 v53, v37, v14
    v_mfma_f32_16x16x32_bf16 v[20:23], a[76:79], v[144:147], v[20:23]
    ds_read_b64_tr_b16 a[106:107], v112 offset:22528
    s_waitcnt lgkmcnt(6)
    v_mfma_f32_16x16x32_bf16 v[16:19], a[80:83], v[160:163], v[16:19]
    ds_read_b64_tr_b16 a[108:109], v113 offset:20480
    ds_read_b64_tr_b16 a[110:111], v113 offset:22528
    v_mfma_f32_16x16x32_bf16 v[24:27], a[80:83], v[168:171], v[24:27]
    v_cvt_pk_bf16_f32 v74, v52, v53
    v_mul_f32 v54, v38, v14
    v_mfma_f32_16x16x32_bf16 v[28:31], a[84:87], v[168:171], v[28:31]
    ds_read_b64_tr_b16 a[112:113], v112 offset:24576
    ds_read_b64_tr_b16 a[114:115], v112 offset:26624
    v_mfma_f32_16x16x32_bf16 v[20:23], a[84:87], v[160:163], v[20:23]
    v_mul_f32 v55, v39, v14
    v_cvt_pk_bf16_f32 v75, v54, v55
    v_mfma_f32_16x16x32_bf16 v[16:19], a[88:91], v[176:179], v[16:19]
    ds_read_b64_tr_b16 a[116:117], v113 offset:24576
    ds_read_b64_tr_b16 a[118:119], v113 offset:26624
    v_mfma_f32_16x16x32_bf16 v[24:27], a[88:91], v[184:187], v[24:27]
    buffer_store_dwordx4 v[72:75], v124, s[56:59], s63 offen offset:2048 sc1
    v_mfma_f32_16x16x32_bf16 v[28:31], a[92:95], v[184:187], v[28:31]
    ds_read_b64_tr_b16 a[120:121], v112 offset:28672
    v_mul_f32 v56, v40, v15
    v_mfma_f32_16x16x32_bf16 v[20:23], a[92:95], v[176:179], v[20:23]
    ds_read_b64_tr_b16 a[122:123], v112 offset:30720
    s_waitcnt lgkmcnt(6)
    v_mfma_f32_16x16x32_bf16 v[16:19], a[96:99], v[192:195], v[16:19]
    ds_read_b64_tr_b16 a[124:125], v113 offset:28672
    ds_read_b64_tr_b16 a[126:127], v113 offset:30720
    v_mfma_f32_16x16x32_bf16 v[24:27], a[96:99], v[200:203], v[24:27]
    v_mul_f32 v57, v41, v15
    v_cvt_pk_bf16_f32 v76, v56, v57
    v_mfma_f32_16x16x32_bf16 v[28:31], a[100:103], v[200:203], v[28:31]
    ds_read_b64_tr_b16 a[64:65], v114 offset:0
    ds_read_b64_tr_b16 a[66:67], v114 offset:2048
    v_mfma_f32_16x16x32_bf16 v[20:23], a[100:103], v[192:195], v[20:23]
    v_mul_f32 v58, v42, v15
    v_mul_f32 v59, v43, v15
    v_mfma_f32_16x16x32_bf16 v[16:19], a[104:107], v[208:211], v[16:19]
    ds_read_b64_tr_b16 a[68:69], v115 offset:0
    ds_read_b64_tr_b16 a[70:71], v115 offset:2048
    v_mfma_f32_16x16x32_bf16 v[24:27], a[104:107], v[216:219], v[24:27]
    v_cvt_pk_bf16_f32 v77, v58, v59
    v_mul_f32 v60, v44, v15
    v_mfma_f32_16x16x32_bf16 v[28:31], a[108:111], v[216:219], v[28:31]
    ds_read_b64_tr_b16 a[72:73], v114 offset:4096
    v_mul_f32 v61, v45, v15
    v_mfma_f32_16x16x32_bf16 v[20:23], a[108:111], v[208:211], v[20:23]
    ds_read_b64_tr_b16 a[74:75], v114 offset:6144
    s_waitcnt lgkmcnt(6)
    v_mfma_f32_16x16x32_bf16 v[16:19], a[112:115], v[224:227], v[16:19]
    ds_read_b64_tr_b16 a[76:77], v115 offset:4096
    ds_read_b64_tr_b16 a[78:79], v115 offset:6144
    v_mfma_f32_16x16x32_bf16 v[24:27], a[112:115], v[232:235], v[24:27]
    v_cvt_pk_bf16_f32 v78, v60, v61
    v_mul_f32 v62, v46, v15
    v_mfma_f32_16x16x32_bf16 v[28:31], a[116:119], v[232:235], v[28:31]
    ds_read_b64_tr_b16 a[80:81], v114 offset:8192
    ds_read_b64_tr_b16 a[82:83], v114 offset:10240
    v_mfma_f32_16x16x32_bf16 v[20:23], a[116:119], v[224:227], v[20:23]
    v_mul_f32 v63, v47, v15
    v_cvt_pk_bf16_f32 v79, v62, v63
    v_mfma_f32_16x16x32_bf16 v[16:19], a[120:123], v[240:243], v[16:19]
    ds_read_b64_tr_b16 a[84:85], v115 offset:8192
    ds_read_b64_tr_b16 a[86:87], v115 offset:10240
    v_mfma_f32_16x16x32_bf16 v[24:27], a[120:123], v[248:251], v[24:27]
    buffer_store_dwordx4 v[76:79], v124, s[56:59], s63 offen offset:3072 sc1
    v_mfma_f32_16x16x32_bf16 v[28:31], a[124:127], v[248:251], v[28:31]
    ds_read_b64_tr_b16 a[88:89], v114 offset:12288
    s_add_u32 s63, s63, 4096
    v_mfma_f32_16x16x32_bf16 v[20:23], a[124:127], v[240:243], v[20:23]
    ds_read_b64_tr_b16 a[90:91], v114 offset:14336
    s_waitcnt lgkmcnt(6)
    v_mfma_f32_16x16x32_bf16 v[32:35], a[64:67], v[128:131], 0
    ds_read_b64_tr_b16 a[92:93], v115 offset:12288
    ds_read_b64_tr_b16 a[94:95], v115 offset:14336
    v_mfma_f32_16x16x32_bf16 v[40:43], a[64:67], v[136:139], 0
    v_mul_f32 v48, v16, v14
    v_mul_f32 v49, v17, v14
    v_mfma_f32_16x16x32_bf16 v[44:47], a[68:71], v[136:139], 0
    ds_read_b64_tr_b16 a[96:97], v114 offset:16384
    ds_read_b64_tr_b16 a[98:99], v114 offset:18432
    v_mfma_f32_16x16x32_bf16 v[36:39], a[68:71], v[128:131], 0
    v_cvt_pk_bf16_f32 v64, v48, v49
    v_mul_f32 v50, v18, v14
    v_mfma_f32_16x16x32_bf16 v[32:35], a[72:75], v[144:147], v[32:35]
    ds_read_b64_tr_b16 a[100:101], v115 offset:16384
    ds_read_b64_tr_b16 a[102:103], v115 offset:18432
    v_mfma_f32_16x16x32_bf16 v[40:43], a[72:75], v[152:155], v[40:43]
    v_mul_f32 v51, v19, v14
    v_cvt_pk_bf16_f32 v65, v50, v51
    v_mfma_f32_16x16x32_bf16 v[44:47], a[76:79], v[152:155], v[44:47]
    ds_read_b64_tr_b16 a[104:105], v114 offset:20480
    v_mul_f32 v52, v20, v14
    v_mfma_f32_16x16x32_bf16 v[36:39], a[76:79], v[144:147], v[36:39]
    ds_read_b64_tr_b16 a[106:107], v114 offset:22528
    s_waitcnt lgkmcnt(6)
    v_mfma_f32_16x16x32_bf16 v[32:35], a[80:83], v[160:163], v[32:35]
    ds_read_b64_tr_b16 a[108:109], v115 offset:20480
    ds_read_b64_tr_b16 a[110:111], v115 offset:22528
    v_mfma_f32_16x16x32_bf16 v[40:43], a[80:83], v[168:171], v[40:43]
    v_mul_f32 v53, v21, v14
    v_cvt_pk_bf16_f32 v66, v52, v53
    v_mfma_f32_16x16x32_bf16 v[44:47], a[84:87], v[168:171], v[44:47]
    ds_read_b64_tr_b16 a[112:113], v114 offset:24576
    ds_read_b64_tr_b16 a[114:115], v114 offset:26624
    v_mfma_f32_16x16x32_bf16 v[36:39], a[84:87], v[160:163], v[36:39]
    v_mul_f32 v54, v22, v14
    v_mul_f32 v55, v23, v14
    v_mfma_f32_16x16x32_bf16 v[32:35], a[88:91], v[176:179], v[32:35]
    ds_read_b64_tr_b16 a[116:117], v115 offset:24576
    ds_read_b64_tr_b16 a[118:119], v115 offset:26624
    v_mfma_f32_16x16x32_bf16 v[40:43], a[88:91], v[184:187], v[40:43]
    v_cvt_pk_bf16_f32 v67, v54, v55
    v_mul_f32 v56, v24, v15
    v_mfma_f32_16x16x32_bf16 v[44:47], a[92:95], v[184:187], v[44:47]
    ds_read_b64_tr_b16 a[120:121], v114 offset:28672
    v_mul_f32 v57, v25, v15
    v_mfma_f32_16x16x32_bf16 v[36:39], a[92:95], v[176:179], v[36:39]
    ds_read_b64_tr_b16 a[122:123], v114 offset:30720
    s_waitcnt lgkmcnt(6)
    v_mfma_f32_16x16x32_bf16 v[32:35], a[96:99], v[192:195], v[32:35]
    ds_read_b64_tr_b16 a[124:125], v115 offset:28672
    ds_read_b64_tr_b16 a[126:127], v115 offset:30720
    v_mfma_f32_16x16x32_bf16 v[40:43], a[96:99], v[200:203], v[40:43]
    buffer_store_dwordx4 v[64:67], v124, s[56:59], s63 offen offset:0 sc1
    v_mfma_f32_16x16x32_bf16 v[44:47], a[100:103], v[200:203], v[44:47]
    v_cvt_pk_bf16_f32 v68, v56, v57
    v_mul_f32 v58, v26, v15
    v_mfma_f32_16x16x32_bf16 v[36:39], a[100:103], v[192:195], v[36:39]
    v_mul_f32 v59, v27, v15
    v_cvt_pk_bf16_f32 v69, v58, v59
    v_mfma_f32_16x16x32_bf16 v[32:35], a[104:107], v[208:211], v[32:35]
    v_mul_f32 v60, v28, v15
    v_mul_f32 v61, v29, v15
    v_mfma_f32_16x16x32_bf16 v[40:43], a[104:107], v[216:219], v[40:43]
    v_cvt_pk_bf16_f32 v70, v60, v61
    v_mul_f32 v62, v30, v15
    v_mfma_f32_16x16x32_bf16 v[44:47], a[108:111], v[216:219], v[44:47]
    v_mul_f32 v63, v31, v15
    v_cvt_pk_bf16_f32 v71, v62, v63
    v_mfma_f32_16x16x32_bf16 v[36:39], a[108:111], v[208:211], v[36:39]
    s_waitcnt lgkmcnt(0)
    v_mfma_f32_16x16x32_bf16 v[32:35], a[112:115], v[224:227], v[32:35]
    buffer_store_dwordx4 v[68:71], v124, s[56:59], s63 offen offset:1024 sc1
    v_mfma_f32_16x16x32_bf16 v[40:43], a[112:115], v[232:235], v[40:43]
    v_mfma_f32_16x16x32_bf16 v[44:47], a[116:119], v[232:235], v[44:47]
    v_mfma_f32_16x16x32_bf16 v[36:39], a[116:119], v[224:227], v[36:39]
    v_mfma_f32_16x16x32_bf16 v[32:35], a[120:123], v[240:243], v[32:35]
    v_mfma_f32_16x16x32_bf16 v[40:43], a[120:123], v[248:251], v[40:43]
    buffer_load_dword v9, v12, s[12:15], s18 offen sc1
    v_mfma_f32_16x16x32_bf16 v[44:47], a[124:127], v[248:251], v[44:47]
    v_mfma_f32_16x16x32_bf16 v[36:39], a[124:127], v[240:243], v[36:39]
    s_nop 3
    v_mul_f32 v48, v32, v14
    v_mul_f32 v49, v33, v14
    v_cvt_pk_bf16_f32 v72, v48, v49
    v_mul_f32 v50, v34, v14
    v_mul_f32 v51, v35, v14
    v_cvt_pk_bf16_f32 v73, v50, v51
    v_mul_f32 v52, v36, v14
    v_mul_f32 v53, v37, v14
    v_cvt_pk_bf16_f32 v74, v52, v53
    v_mul_f32 v54, v38, v14
    v_mul_f32 v55, v39, v14
    v_cvt_pk_bf16_f32 v75, v54, v55
    buffer_store_dwordx4 v[72:75], v124, s[56:59], s63 offen offset:2048 sc1
    v_mul_f32 v56, v40, v15
    v_mul_f32 v57, v41, v15
    v_cvt_pk_bf16_f32 v76, v56, v57
    v_mul_f32 v58, v42, v15
    v_mul_f32 v59, v43, v15
    v_cvt_pk_bf16_f32 v77, v58, v59
    v_mul_f32 v60, v44, v15
    v_mul_f32 v61, v45, v15
    v_cvt_pk_bf16_f32 v78, v60, v61
    v_mul_f32 v62, v46, v15
    v_mul_f32 v63, v47, v15
    v_cvt_pk_bf16_f32 v79, v62, v63
    buffer_store_dwordx4 v[76:79], v124, s[56:59], s63 offen offset:3072 sc1
    s_add_u32 s63, s63, 4096
    v_mov_b32 v13, 7
    s_mov_b32 s24, 0
    s_waitcnt vmcnt(0)
    buffer_store_dword v13, v127, s[12:15], 0 offen sc1
    v_cmp_lt_u32 vcc, s19, v9
    s_nop 0
    s_or_b32 s27, vcc_lo, s20
    s_and_b32 s27, s27, 0xffff
    s_xor_b32 s26, s27, 0xffff
    s_ff1_i32_b32 s3, s27
    s_bitset0_b32 s27, s3
    s_mul_i32 s3, s3, 86016
    s_add_u32 s23, s3, s16
    buffer_load_dwordx4 v[128:131], v0, s[84:87], s23 offen sc1
    s_cmp_eq_u32 s27, 0
    s_cbranch_scc1 L_rf1_w
L_rb1_w:
    s_ff1_i32_b32 s3, s27
    s_bitset0_b32 s27, s3
    s_mul_i32 s3, s3, 86016
    s_add_u32 s23, s3, s16
    buffer_load_dwordx4 v[132:135], v0, s[84:87], s23 offen sc1
    s_cmp_eq_u32 s27, 0
    s_cbranch_scc1 L_rf2_w
L_rb2_w:
    s_ff1_i32_b32 s3, s27
    s_bitset0_b32 s27, s3
    s_mul_i32 s3, s3, 86016
    s_add_u32 s23, s3, s16
    buffer_load_dwordx4 v[136:139], v0, s[84:87], s23 offen sc1
    s_cmp_eq_u32 s27, 0
    s_cbranch_scc1 L_rf3_w
L_rb3_w:
    s_ff1_i32_b32 s3, s27
    s_bitset0_b32 s27, s3
    s_mul_i32 s3, s3, 86016
    s_add_u32 s23, s3, s16
    buffer_load_dwordx4 v[140:143], v0, s[84:87], s23 offen sc1
    s_cmp_eq_u32 s27, 0
    s_cbranch_scc1 L_rf4_w
L_rb4_w:
    s_ff1_i32_b32 s3, s27
    s_bitset0_b32 s27, s3
    s_mul_i32 s3, s3, 86016
    s_add_u32 s23, s3, s16
    buffer_load_dwordx4 v[144:147], v0, s[84:87], s23 offen sc1
    s_cmp_eq_u32 s27, 0
    s_cbranch_scc1 L_rf5_w
L_rb5_w:
    s_ff1_i32_b32 s3, s27
    s_bitset0_b32 s27, s3
    s_mul_i32 s3, s3, 86016
    s_add_u32 s23, s3, s16
    buffer_load_dwordx4 v[148:151], v0, s[84:87], s23 offen sc1
    s_cmp_eq_u32 s27, 0
    s_cbranch_scc1 L_rf6_w
L_rb6_w:
    s_ff1_i32_b32 s3, s27
    s_bitset0_b32 s27, s3
    s_mul_i32 s3, s3, 86016
    s_add_u32 s23, s3, s16
    buffer_load_dwordx4 v[152:155], v0, s[84:87], s23 offen sc1
    s_cmp_eq_u32 s27, 0
    s_cbranch_scc1 L_rf7_w
L_rb7_w:
    s_ff1_i32_b32 s3, s27
    s_bitset0_b32 s27, s3
    s_mul_i32 s3, s3, 86016
    s_add_u32 s23, s3, s16
    buffer_load_dwordx4 v[156:159], v0, s[84:87], s23 offen sc1
    s_cmp_eq_u32 s27, 0
    s_cbranch_scc1 L_rf8_w
L_rb8_w:
    s_ff1_i32_b32 s3, s27
    s_bitset0_b32 s27, s3
    s_mul_i32 s3, s3, 86016
    s_add_u32 s23, s3, s16
    buffer_load_dwordx4 v[160:163], v0, s[84:87], s23 offen sc1
    s_cmp_eq_u32 s27, 0
    s_cbranch_scc1 L_rf9_w
L_rb9_w:
    s_ff1_i32_b32 s3, s27
    s_bitset0_b32 s27, s3
    s_mul_i32 s3, s3, 86016
    s_add_u32 s23, s3, s16
    buffer_load_dwordx4 v[164:167], v0, s[84:87], s23 offen sc1
    s_cmp_eq_u32 s27, 0
    s_cbranch_scc1 L_rf10_w
L_rb10_w:
    s_ff1_i32_b32 s3, s27
    s_bitset0_b32 s27, s3
    s_mul_i32 s3, s3, 86016
    s_add_u32 s23, s3, s16
    buffer_load_dwordx4 v[168:171], v0, s[84:87], s23 offen sc1
    s_cmp_eq_u32 s27, 0
    s_cbranch_scc1 L_rf11_w
L_rb11_w:
    s_ff1_i32_b32 s3, s27
    s_bitset0_b32 s27, s3
    s_mul_i32 s3, s3, 86016
    s_add_u32 s23, s3, s16
    buffer_load_dwordx4 v[172:175], v0, s[84:87], s23 offen sc1
    s_cmp_eq_u32 s27, 0
    s_cbranch_scc1 L_rf12_w
L_rb12_w:
    s_ff1_i32_b32 s3, s27
    s_bitset0_b32 s27, s3
    s_mul_i32 s3, s3, 86016
    s_add_u32 s23, s3, s16
    buffer_load_dwordx4 v[176:179], v0, s[84:87], s23 offen sc1
    s_cmp_eq_u32 s27, 0
    s_cbranch_scc1 L_rf13_w
L_rb13_w:
    s_ff1_i32_b32 s3, s27
    s_bitset0_b32 s27, s3
    s_mul_i32 s3, s3, 86016
    s_add_u32 s23, s3, s16
    buffer_load_dwordx4 v[180:183], v0, s[84:87], s23 offen sc1
    s_cmp_eq_u32 s27, 0
    s_cbranch_scc1 L_rf14_w
L_rb14_w:
    s_ff1_i32_b32 s3, s27
    s_bitset0_b32 s27, s3
    s_mul_i32 s3, s3, 86016
    s_add_u32 s23, s3, s16
    buffer_load_dwordx4 v[184:187], v0, s[84:87], s23 offen sc1
    s_cmp_eq_u32 s27, 0
    s_cbranch_scc1 L_rf15_w
L_rb15_w:
    s_ff1_i32_b32 s3, s27
    s_bitset0_b32 s27, s3
    s_mul_i32 s3, s3, 86016
    s_add_u32 s23, s3, s16
    buffer_load_dwordx4 v[188:191], v0, s[84:87], s23 offen sc1
    s_waitcnt vmcnt(15)
    v_lshlrev_b32 v48, 16, v128
    v_and_b32 v49, 0xffff0000, v128
    v_lshlrev_b32 v50, 16, v129
    v_and_b32 v51, 0xffff0000, v129
    v_lshlrev_b32 v52, 16, v130
    v_and_b32 v53, 0xffff0000, v130
    v_lshlrev_b32 v54, 16, v131
    v_and_b32 v55, 0xffff0000, v131
    s_waitcnt vmcnt(14)
    v_lshlrev_b32 v4, 16, v132
    v_and_b32 v5, 0xffff0000, v132
    v_pk_add_f32 v[48:49], v[48:49], v[4:5]
    v_lshlrev_b32 v6, 16, v133
    v_and_b32 v7, 0xffff0000, v133
    v_pk_add_f32 v[50:51], v[50:51], v[6:7]
    v_lshlrev_b32 v4, 16, v134
    v_and_b32 v5, 0xffff0000, v134
    v_pk_add_f32 v[52:53], v[52:53], v[4:5]
    v_lshlrev_b32 v6, 16, v135
    v_and_b32 v7, 0xffff0000, v135
    v_pk_add_f32 v[54:55], v[54:55], v[6:7]
    s_waitcnt vmcnt(13)
    v_lshlrev_b32 v4, 16, v136
    v_and_b32 v5, 0xffff0000, v136
    v_pk_add_f32 v[48:49], v[48:49], v[4:5]
    v_lshlrev_b32 v6, 16, v137
    v_and_b32 v7, 0xffff0000, v137
    v_pk_add_f32 v[50:51], v[50:51], v[6:7]
    v_lshlrev_b32 v4, 16, v138
    v_and_b32 v5, 0xffff0000, v138
    v_pk_add_f32 v[52:53], v[52:53], v[4:5]
    v_lshlrev_b32 v6, 16, v139
    v_and_b32 v7, 0xffff0000, v139
    v_pk_add_f32 v[54:55], v[54:55], v[6:7]
    s_waitcnt vmcnt(12)
    v_lshlrev_b32 v4, 16, v140
    v_and_b32 v5, 0xffff0000, v140
    v_pk_add_f32 v[48:49], v[48:49], v[4:5]
    v_lshlrev_b32 v6, 16, v141
    v_and_b32 v7, 0xffff0000, v141
    v_pk_add_f32 v[50:51], v[50:51], v[6:7]
    v_lshlrev_b32 v4, 16, v142
    v_and_b32 v5, 0xffff0000, v142
    v_pk_add_f32 v[52:53], v[52:53], v[4:5]
    v_lshlrev_b32 v6, 16, v143
    v_and_b32 v7, 0xffff0000, v143
    v_pk_add_f32 v[54:55], v[54:55], v[6:7]
    s_waitcnt vmcnt(11)
    v_lshlrev_b32 v4, 16, v144
    v_and_b32 v5, 0xffff0000, v144
    v_pk_add_f32 v[48:49], v[48:49], v[4:5]
    v_lshlrev_b32 v6, 16, v145
    v_and_b32 v7, 0xffff0000, v145
    v_pk_add_f32 v[50:51], v[50:51], v[6:7]
    v_lshlrev_b32 v4, 16, v146
    v_and_b32 v5, 0xffff0000, v146
    v_pk_add_f32 v[52:53], v[52:53], v[4:5]
    v_lshlrev_b32 v6, 16, v147
    v_and_b32 v7, 0xffff0000, v147
    v_pk_add_f32 v[54:55], v[54:55], v[6:7]
    s_waitcnt vmcnt(10)
    v_lshlrev_b32 v4, 16, v148
    v_and_b32 v5, 0xffff0000, v148
    v_pk_add_f32 v[48:49], v[48:49], v[4:5]
    v_lshlrev_b32 v6, 16, v149
    v_and_b32 v7, 0xffff0000, v149
    v_pk_add_f32 v[50:51], v[50:51], v[6:7]
    v_lshlrev_b32 v4, 16, v150
    v_and_b32 v5, 0xffff0000, v150
    v_pk_add_f32 v[52:53], v[52:53], v[4:5]
    v_lshlrev_b32 v6, 16, v151
    v_and_b32 v7, 0xffff0000, v151
    v_pk_add_f32 v[54:55], v[54:55], v[6:7]
    s_waitcnt vmcnt(9)
    v_lshlrev_b32 v4, 16, v152
    v_and_b32 v5, 0xffff0000, v152
    v_pk_add_f32 v[48:49], v[48:49], v[4:5]
    v_lshlrev_b32 v6, 16, v153
    v_and_b32 v7, 0xffff0000, v153
    v_pk_add_f32 v[50:51], v[50:51], v[6:7]
    v_lshlrev_b32 v4, 16, v154
    v_and_b32 v5, 0xffff0000, v154
    v_pk_add_f32 v[52:53], v[52:53], v[4:5]
    v_lshlrev_b32 v6, 16, v155
    v_and_b32 v7, 0xffff0000, v155
    v_pk_add_f32 v[54:55], v[54:55], v[6:7]
    s_waitcnt vmcnt(8)
    v_lshlrev_b32 v4, 16, v156
    v_and_b32 v5, 0xffff0000, v156
    v_pk_add_f32 v[48:49], v[48:49], v[4:5]
    v_lshlrev_b32 v6, 16, v157
    v_and_b32 v7, 0xffff0000, v157
    v_pk_add_f32 v[50:51], v[50:51], v[6:7]
    v_lshlrev_b32 v4, 16, v158
    v_and_b32 v5, 0xffff0000, v158
    v_pk_add_f32 v[52:53], v[52:53], v[4:5]
    v_lshlrev_b32 v6, 16, v159
    v_and_b32 v7, 0xffff0000, v159
    v_pk_add_f32 v[54:55], v[54:55], v[6:7]
    s_waitcnt vmcnt(7)
    v_lshlrev_b32 v4, 16, v160
    v_and_b32 v5, 0xffff0000, v160
    v_pk_add_f32 v[48:49], v[48:49], v[4:5]
    v_lshlrev_b32 v6, 16, v161
    v_and_b32 v7, 0xffff0000, v161
    v_pk_add_f32 v[50:51], v[50:51], v[6:7]
    v_lshlrev_b32 v4, 16, v162
    v_and_b32 v5, 0xffff0000, v162
    v_pk_add_f32 v[52:53], v[52:53], v[4:5]
    v_lshlrev_b32 v6, 16, v163
    v_and_b32 v7, 0xffff0000, v163
    v_pk_add_f32 v[54:55], v[54:55], v[6:7]
    s_waitcnt vmcnt(6)
    v_lshlrev_b32 v4, 16, v164
    v_and_b32 v5, 0xffff0000, v164
    v_pk_add_f32 v[48:49], v[48:49], v[4:5]
    v_lshlrev_b32 v6, 16, v165
    v_and_b32 v7, 0xffff0000, v165
    v_pk_add_f32 v[50:51], v[50:51], v[6:7]
    v_lshlrev_b32 v4, 16, v166
    v_and_b32 v5, 0xffff0000, v166
    v_pk_add_f32 v[52:53], v[52:53], v[4:5]
    v_lshlrev_b32 v6, 16, v167
    v_and_b32 v7, 0xffff0000, v167
    v_pk_add_f32 v[54:55], v[54:55], v[6:7]
    s_waitcnt vmcnt(5)
    v_lshlrev_b32 v4, 16, v168
    v_and_b32 v5, 0xffff0000, v168
    v_pk_add_f32 v[48:49], v[48:49], v[4:5]
    v_lshlrev_b32 v6, 16, v169
    v_and_b32 v7, 0xffff0000, v169
    v_pk_add_f32 v[50:51], v[50:51], v[6:7]
    v_lshlrev_b32 v4, 16, v170
    v_and_b32 v5, 0xffff0000, v170
    v_pk_add_f32 v[52:53], v[52:53], v[4:5]
    v_lshlrev_b32 v6, 16, v171
    v_and_b32 v7, 0xffff0000, v171
    v_pk_add_f32 v[54:55], v[54:55], v[6:7]
    s_waitcnt vmcnt(4)
    v_lshlrev_b32 v4, 16, v172
    v_and_b32 v5, 0xffff0000, v172
    v_pk_add_f32 v[48:49], v[48:49], v[4:5]
    v_lshlrev_b32 v6, 16, v173
    v_and_b32 v7, 0xffff0000, v173
    v_pk_add_f32 v[50:51], v[50:51], v[6:7]
    v_lshlrev_b32 v4, 16, v174
    v_and_b32 v5, 0xffff0000, v174
    v_pk_add_f32 v[52:53], v[52:53], v[4:5]
    v_lshlrev_b32 v6, 16, v175
    v_and_b32 v7, 0xffff0000, v175
    v_pk_add_f32 v[54:55], v[54:55], v[6:7]
    s_waitcnt vmcnt(3)
    v_lshlrev_b32 v4, 16, v176
    v_and_b32 v5, 0xffff0000, v176
    v_pk_add_f32 v[48:49], v[48:49], v[4:5]
    v_lshlrev_b32 v6, 16, v177
    v_and_b32 v7, 0xffff0000, v177
    v_pk_add_f32 v[50:51], v[50:51], v[6:7]
    v_lshlrev_b32 v4, 16, v178
    v_and_b32 v5, 0xffff0000, v178
    v_pk_add_f32 v[52:53], v[52:53], v[4:5]
    v_lshlrev_b32 v6, 16, v179
    v_and_b32 v7, 0xffff0000, v179
    v_pk_add_f32 v[54:55], v[54:55], v[6:7]
    s_waitcnt vmcnt(2)
    v_lshlrev_b32 v4, 16, v180
    v_and_b32 v5, 0xffff0000, v180
    v_pk_add_f32 v[48:49], v[48:49], v[4:5]
    v_lshlrev_b32 v6, 16, v181
    v_and_b32 v7, 0xffff0000, v181
    v_pk_add_f32 v[50:51], v[50:51], v[6:7]
    v_lshlrev_b32 v4, 16, v182
    v_and_b32 v5, 0xffff0000, v182
    v_pk_add_f32 v[52:53], v[52:53], v[4:5]
    v_lshlrev_b32 v6, 16, v183
    v_and_b32 v7, 0xffff0000, v183
    v_pk_add_f32 v[54:55], v[54:55], v[6:7]
    s_waitcnt vmcnt(1)
    v_lshlrev_b32 v4, 16, v184
    v_and_b32 v5, 0xffff0000, v184
    v_pk_add_f32 v[48:49], v[48:49], v[4:5]
    v_lshlrev_b32 v6, 16, v185
    v_and_b32 v7, 0xffff0000, v185
    v_pk_add_f32 v[50:51], v[50:51], v[6:7]
    v_lshlrev_b32 v4, 16, v186
    v_and_b32 v5, 0xffff0000, v186
    v_pk_add_f32 v[52:53], v[52:53], v[4:5]
    v_lshlrev_b32 v6, 16, v187
    v_and_b32 v7, 0xffff0000, v187
    v_pk_add_f32 v[54:55], v[54:55], v[6:7]
    s_waitcnt vmcnt(0)
    v_lshlrev_b32 v4, 16, v188
    v_and_b32 v5, 0xffff0000, v188
    v_pk_add_f32 v[48:49], v[48:49], v[4:5]
    v_lshlrev_b32 v6, 16, v189
    v_and_b32 v7, 0xffff0000, v189
    v_pk_add_f32 v[50:51], v[50:51], v[6:7]
    v_lshlrev_b32 v4, 16, v190
    v_and_b32 v5, 0xffff0000, v190
    v_pk_add_f32 v[52:53], v[52:53], v[4:5]
    v_lshlrev_b32 v6, 16, v191
    v_and_b32 v7, 0xffff0000, v191
    v_pk_add_f32 v[54:55], v[54:55], v[6:7]
    v_cvt_pk_bf16_f32 v48, v48, v49
    v_cvt_pk_bf16_f32 v49, v50, v51
    v_cvt_pk_bf16_f32 v50, v52, v53
    v_cvt_pk_bf16_f32 v51, v54, v55
    s_nop 0
    v_permlane32_swap_b32 v48, v50
    v_permlane32_swap_b32 v49, v51
    buffer_store_dwordx4 v[48:51], v11, s[72:75], s17 offen
L_wfin:
L_end:
    s_endpgm
L_rf1_w:
    s_call_b64 s[64:65], L_refill_w
    s_branch L_rb1_w
L_rf2_w:
    s_call_b64 s[64:65], L_refill_w
    s_branch L_rb2_w
L_rf3_w:
    s_call_b64 s[64:65], L_refill_w
    s_branch L_rb3_w
L_rf4_w:
    s_call_b64 s[64:65], L_refill_w
    s_branch L_rb4_w
L_rf5_w:
    s_call_b64 s[64:65], L_refill_w
    s_branch L_rb5_w
L_rf6_w:
    s_call_b64 s[64:65], L_refill_w
    s_branch L_rb6_w
L_rf7_w:
    s_call_b64 s[64:65], L_refill_w
    s_branch L_rb7_w
L_rf8_w:
    s_call_b64 s[64:65], L_refill_w
    s_branch L_rb8_w
L_rf9_w:
    s_call_b64 s[64:65], L_refill_w
    s_branch L_rb9_w
L_rf10_w:
    s_call_b64 s[64:65], L_refill_w
    s_branch L_rb10_w
L_rf11_w:
    s_call_b64 s[64:65], L_refill_w
    s_branch L_rb11_w
L_rf12_w:
    s_call_b64 s[64:65], L_refill_w
    s_branch L_rb12_w
L_rf13_w:
    s_call_b64 s[64:65], L_refill_w
    s_branch L_rb13_w
L_rf14_w:
    s_call_b64 s[64:65], L_refill_w
    s_branch L_rb14_w
L_rf15_w:
    s_call_b64 s[64:65], L_refill_w
    s_branch L_rb15_w
L_refill_w:
    s_mov_b32 exec_lo, s26
    s_mov_b32 exec_hi, 0
    s_branch L_go_w
L_slp_w:
L_go_w:
    buffer_load_dword v9, v12, s[12:15], s18 offen sc1
    s_mov_b32 s27, s26
    s_add_u32 s24, s24, 1
    s_cmp_gt_u32 s24, 0x40000
    s_waitcnt vmcnt(0)
    s_cbranch_scc1 L_got_w
    v_cmp_lt_u32 vcc, s19, v9
    s_nop 0
    s_and_b32 s27, vcc_lo, s26
    s_cbranch_scc0 L_slp_w
L_got_w:
    s_andn2_b32 s26, s26, s27
    s_mov_b64 exec, -1
    s_setpc_b64 s[64:65]
L_announce:
    v_mov_b32 v15, 1
    s_waitcnt vmcnt(0)
    buffer_store_dword v15, v124, s[4:7], 0 offen sc1
    s_branch L_announced
L_tr_L1:
    s_call_b64 s[64:65], L_rare1
    s_branch L_bk_L1
L_tr_L2:
    s_call_b64 s[64:65], L_rare0
    s_branch L_bk_L2
L_tr_L3:
    s_call_b64 s[64:65], L_rare1
    s_branch L_bk_L3
L_tr_L4:
    s_call_b64 s[64:65], L_rare0
    s_branch L_bk_L4
L_tr_L5:
    s_call_b64 s[64:65], L_rare1
    s_branch L_bk_L5
L_tr_L0:
    s_call_b64 s[64:65], L_rare0
    s_branch L_bk_L0
L_tr_P30:
    s_call_b64 s[64:65], L_rare0
    s_branch L_bk_P30
L_tr_P31:
    s_call_b64 s[64:65], L_rare1
    s_branch L_bk_P31
L_rare0:
    s_nop 7
    v_max3_f32 v1, v16, v17, v18
    v_max3_f32 v2, v24, v25, v26
    v_max3_f32 v1, v1, v19, v20
    v_max3_f32 v2, v2, v27, v28
    v_max3_f32 v1, v1, v21, v22
    v_max3_f32 v2, v2, v29, v30
    v_max_f32 v1, v1, v23
    v_max_f32 v2, v2, v31
    v_mov_b32 v3, v1
    v_mov_b32 v4, v2
    s_nop 0
    v_permlane16_swap_b32 v1, v3
    v_permlane16_swap_b32 v2, v4
    v_max_f32 v1, v1, v3
    v_max_f32 v2, v2, v4
    v_mov_b32 v3, v1
    v_mov_b32 v4, v2
    s_nop 0
    v_permlane32_swap_b32 v1, v3
    v_permlane32_swap_b32 v2, v4
    v_max_f32 v1, v1, v3
    v_max_f32 v2, v2, v4
    v_max_f32 v1, 0, v1
    v_exp_f32 v3, -v1
    v_sub_f32 v96, v96, v1
    v_sub_f32 v97, v97, v1
    v_sub_f32 v98, v98, v1
    v_sub_f32 v99, v99, v1
    v_sub_f32 v16, v16, v1
    v_sub_f32 v17, v17, v1
    v_sub_f32 v18, v18, v1
    v_sub_f32 v19, v19, v1
    v_sub_f32 v20, v20, v1
    v_sub_f32 v21, v21, v1
    v_sub_f32 v22, v22, v1
    v_sub_f32 v23, v23, v1
    v_sub_f32 v32, v32, v1
    v_sub_f32 v33, v33, v1
    v_sub_f32 v34, v34, v1
    v_sub_f32 v35, v35, v1
    v_sub_f32 v36, v36, v1
    v_sub_f32 v37, v37, v1
    v_sub_f32 v38, v38, v1
    v_sub_f32 v39, v39, v1
    v_mul_f32 v6, v6, v3
    v_mul_f32 v7, v7, v3
    v_mul_f32 v8, v8, v3
    v_mul_f32 v9, v9, v3
    v_max_f32 v2, 0, v2
    v_exp_f32 v4, -v2
    v_sub_f32 v100, v100, v2
    v_sub_f32 v101, v101, v2
    v_sub_f32 v102, v102, v2
    v_sub_f32 v103, v103, v2
    v_sub_f32 v24, v24, v2
    v_sub_f32 v25, v25, v2
    v_sub_f32 v26, v26, v2
    v_sub_f32 v27, v27, v2
    v_sub_f32 v28, v28, v2
    v_sub_f32 v29, v29, v2
    v_sub_f32 v30, v30, v2
    v_sub_f32 v31, v31, v2
    v_sub_f32 v40, v40, v2
    v_sub_f32 v41, v41, v2
    v_sub_f32 v42, v42, v2
    v_sub_f32 v43, v43, v2
    v_sub_f32 v44, v44, v2
    v_sub_f32 v45, v45, v2
    v_sub_f32 v46, v46, v2
    v_sub_f32 v47, v47, v2
    v_mul_f32 v84, v84, v4
    v_mul_f32 v85, v85, v4
    v_mul_f32 v86, v86, v4
    v_mul_f32 v87, v87, v4
    v_mul_f32 v128, v128, v3
    v_mul_f32 v129, v129, v3
    v_mul_f32 v130, v130, v3
    v_mul_f32 v131, v131, v3
    v_mul_f32 v132, v132, v3
    v_mul_f32 v133, v133, v3
    v_mul_f32 v134, v134, v3
    v_mul_f32 v135, v135, v3
    v_mul_f32 v136, v136, v4
    v_mul_f32 v137, v137, v4
    v_mul_f32 v138, v138, v4
    v_mul_f32 v139, v139, v4
    v_mul_f32 v140, v140, v4
    v_mul_f32 v141, v141, v4
    v_mul_f32 v142, v142, v4
    v_mul_f32 v143, v143, v4
    v_mul_f32 v144, v144, v3
    v_mul_f32 v145, v145, v3
    v_mul_f32 v146, v146, v3
    v_mul_f32 v147, v147, v3
    v_mul_f32 v148, v148, v3
    v_mul_f32 v149, v149, v3
    v_mul_f32 v150, v150, v3
    v_mul_f32 v151, v151, v3
    v_mul_f32 v152, v152, v4
    v_mul_f32 v153, v153, v4
    v_mul_f32 v154, v154, v4
    v_mul_f32 v155, v155, v4
    v_mul_f32 v156, v156, v4
    v_mul_f32 v157, v157, v4
    v_mul_f32 v158, v158, v4
    v_mul_f32 v159, v159, v4
    v_mul_f32 v160, v160, v3
    v_mul_f32 v161, v161, v3
    v_mul_f32 v162, v162, v3
    v_mul_f32 v163, v163, v3
    v_mul_f32 v164, v164, v3
    v_mul_f32 v165, v165, v3
    v_mul_f32 v166, v166, v3
    v_mul_f32 v167, v167, v3
    v_mul_f32 v168, v168, v4
    v_mul_f32 v169, v169, v4
    v_mul_f32 v170, v170, v4
    v_mul_f32 v171, v171, v4
    v_mul_f32 v172, v172, v4
    v_mul_f32 v173, v173, v4
    v_mul_f32 v174, v174, v4
    v_mul_f32 v175, v175, v4
    v_mul_f32 v176, v176, v3
    v_mul_f32 v177, v177, v3
    v_mul_f32 v178, v178, v3
    v_mul_f32 v179, v179, v3
    v_mul_f32 v180, v180, v3
    v_mul_f32 v181, v181, v3
    v_mul_f32 v182, v182, v3
    v_mul_f32 v183, v183, v3
    v_mul_f32 v184, v184, v4
    v_mul_f32 v185, v185, v4
    v_mul_f32 v186, v186, v4
    v_mul_f32 v187, v187, v4
    v_mul_f32 v188, v188, v4
    v_mul_f32 v189, v189, v4
    v_mul_f32 v190, v190, v4
    v_mul_f32 v191, v191, v4
    v_mul_f32 v192, v192, v3
    v_mul_f32 v193, v193, v3
    v_mul_f32 v194, v194, v3
    v_mul_f32 v195, v195, v3
    v_mul_f32 v196, v196, v3
    v_mul_f32 v197, v197, v3
    v_mul_f32 v198, v198, v3
    v_mul_f32 v199, v199, v3
    v_mul_f32 v200, v200, v4
    v_mul_f32 v201, v201, v4
    v_mul_f32 v202, v202, v4
    v_mul_f32 v203, v203, v4
    v_mul_f32 v204, v204, v4
    v_mul_f32 v205, v205, v4
    v_mul_f32 v206, v206, v4
    v_mul_f32 v207, v207, v4
    v_mul_f32 v208, v208, v3
    v_mul_f32 v209, v209, v3
    v_mul_f32 v210, v210, v3
    v_mul_f32 v211, v211, v3
    v_mul_f32 v212, v212, v3
    v_mul_f32 v213, v213, v3
    v_mul_f32 v214, v214, v3
    v_mul_f32 v215, v215, v3
    v_mul_f32 v216, v216, v4
    v_mul_f32 v217, v217, v4
    v_mul_f32 v218, v218, v4
    v_mul_f32 v219, v219, v4
    v_mul_f32 v220, v220, v4
    v_mul_f32 v221, v221, v4
    v_mul_f32 v222, v222, v4
    v_mul_f32 v223, v223, v4
    v_mul_f32 v224, v224, v3
    v_mul_f32 v225, v225, v3
    v_mul_f32 v226, v226, v3
    v_mul_f32 v227, v227, v3
    v_mul_f32 v228, v228, v3
    v_mul_f32 v229, v229, v3
    v_mul_f32 v230, v230, v3
    v_mul_f32 v231, v231, v3
    v_mul_f32 v232, v232, v4
    v_mul_f32 v233, v233, v4
    v_mul_f32 v234, v234, v4
    v_mul_f32 v235, v235, v4
    v_mul_f32 v236, v236, v4
    v_mul_f32 v237, v237, v4
    v_mul_f32 v238, v238, v4
    v_mul_f32 v239, v239, v4
    v_mul_f32 v240, v240, v3
    v_mul_f32 v241, v241, v3
    v_mul_f32 v242, v242, v3
    v_mul_f32 v243, v243, v3
    v_mul_f32 v244, v244, v3
    v_mul_f32 v245, v245, v3
    v_mul_f32 v246, v246, v3
    v_mul_f32 v247, v247, v3
    v_mul_f32 v248, v248, v4
    v_mul_f32 v249, v249, v4
    v_mul_f32 v250, v250, v4
    v_mul_f32 v251, v251, v4
    v_mul_f32 v252, v252, v4
    v_mul_f32 v253, v253, v4
    v_mul_f32 v254, v254, v4
    v_mul_f32 v255, v255, v4
    v_exp_f32 v48, v16
    v_exp_f32 v49, v17
    v_exp_f32 v50, v18
    v_cvt_pk_bf16_f32 v64, v48, v49
    v_exp_f32 v51, v19
    v_exp_f32 v52, v20
    v_cvt_pk_bf16_f32 v65, v50, v51
    v_exp_f32 v53, v21
    v_exp_f32 v54, v22
    v_cvt_pk_bf16_f32 v66, v52, v53
    v_exp_f32 v55, v23
    v_exp_f32 v56, v24
    v_cvt_pk_bf16_f32 v67, v54, v55
    s_nop 1
    v_mfma_f32_16x16x32_bf16 v[116:119], a[240:243], v[64:67], v[6:9]
    v_exp_f32 v57, v25
    v_exp_f32 v58, v26
    v_cvt_pk_bf16_f32 v68, v56, v57
    v_exp_f32 v59, v27
    v_exp_f32 v60, v28
    v_cvt_pk_bf16_f32 v69, v58, v59
    v_exp_f32 v61, v29
    v_exp_f32 v62, v30
    v_cvt_pk_bf16_f32 v70, v60, v61
    v_exp_f32 v63, v31
    s_nop 0
    v_cvt_pk_bf16_f32 v71, v62, v63
    s_nop 1
    v_mfma_f32_16x16x32_bf16 v[120:123], a[240:243], v[68:71], v[84:87]
    s_nop 7
    s_setpc_b64 s[64:65]
L_rare1:
    s_nop 7
    v_max3_f32 v1, v32, v33, v34
    v_max3_f32 v2, v40, v41, v42
    v_max3_f32 v1, v1, v35, v36
    v_max3_f32 v2, v2, v43, v44
    v_max3_f32 v1, v1, v37, v38
    v_max3_f32 v2, v2, v45, v46
    v_max_f32 v1, v1, v39
    v_max_f32 v2, v2, v47
    v_mov_b32 v3, v1
    v_mov_b32 v4, v2
    s_nop 0
    v_permlane16_swap_b32 v1, v3
    v_permlane16_swap_b32 v2, v4
    v_max_f32 v1, v1, v3
    v_max_f32 v2, v2, v4
    v_mov_b32 v3, v1
    v_mov_b32 v4, v2
    s_nop 0
    v_permlane32_swap_b32 v1, v3
    v_permlane32_swap_b32 v2, v4
    v_max_f32 v1, v1, v3
    v_max_f32 v2, v2, v4
    v_max_f32 v1, 0, v1
    v_exp_f32 v3, -v1
    v_sub_f32 v96, v96, v1
    v_sub_f32 v97, v97, v1
    v_sub_f32 v98, v98, v1
    v_sub_f32 v99, v99, v1
    v_sub_f32 v16, v16, v1
    v_sub_f32 v17, v17, v1
    v_sub_f32 v18, v18, v1
    v_sub_f32 v19, v19, v1
    v_sub_f32 v20, v20, v1
    v_sub_f32 v21, v21, v1
    v_sub_f32 v22, v22, v1
    v_sub_f32 v23, v23, v1
    v_sub_f32 v32, v32, v1
    v_sub_f32 v33, v33, v1
    v_sub_f32 v34, v34, v1
    v_sub_f32 v35, v35, v1
    v_sub_f32 v36, v36, v1
    v_sub_f32 v37, v37, v1
    v_sub_f32 v38, v38, v1
    v_sub_f32 v39, v39, v1
    v_mul_f32 v116, v116, v3
    v_mul_f32 v117, v117, v3
    v_mul_f32 v118, v118, v3
    v_mul_f32 v119, v119, v3
    v_max_f32 v2, 0, v2
    v_exp_f32 v4, -v2
    v_sub_f32 v100, v100, v2
    v_sub_f32 v101, v101, v2
    v_sub_f32 v102, v102, v2
    v_sub_f32 v103, v103, v2
    v_sub_f32 v24, v24, v2
    v_sub_f32 v25, v25, v2
    v_sub_f32 v26, v26, v2
    v_sub_f32 v27, v27, v2
    v_sub_f32 v28, v28, v2
    v_sub_f32 v29, v29, v2
    v_sub_f32 v30, v30, v2
    v_sub_f32 v31, v31, v2
    v_sub_f32 v40, v40, v2
    v_sub_f32 v41, v41, v2
    v_sub_f32 v42, v42, v2
    v_sub_f32 v43, v43, v2
    v_sub_f32 v44, v44, v2
    v_sub_f32 v45, v45, v2
    v_sub_f32 v46, v46, v2
    v_sub_f32 v47, v47, v2
    v_mul_f32 v120, v120, v4
    v_mul_f32 v121, v121, v4
    v_mul_f32 v122, v122, v4
    v_mul_f32 v123, v123, v4
    v_mul_f32 v128, v128, v3
    v_mul_f32 v129, v129, v3
    v_mul_f32 v130, v130, v3
    v_mul_f32 v131, v131, v3
    v_mul_f32 v132, v132, v3
    v_mul_f32 v133, v133, v3
    v_mul_f32 v134, v134, v3
    v_mul_f32 v135, v135, v3
    v_mul_f32 v136, v136, v4
    v_mul_f32 v137, v137, v4
    v_mul_f32 v138, v138, v4
    v_mul_f32 v139, v139, v4
    v_mul_f32 v140, v140, v4
    v_mul_f32 v141, v141, v4
    v_mul_f32 v142, v142, v4
    v_mul_f32 v143, v143, v4
    v_mul_f32 v144, v144, v3
    v_mul_f32 v145, v145, v3
    v_mul_f32 v146, v146, v3
    v_mul_f32 v147, v147, v3
    v_mul_f32 v148, v148, v3
    v_mul_f32 v149, v149, v3
    v_mul_f32 v150, v150, v3
    v_mul_f32 v151, v151, v3
    v_mul_f32 v152, v152, v4
    v_mul_f32 v153, v153, v4
    v_mul_f32 v154, v154, v4
    v_mul_f32 v155, v155, v4
    v_mul_f32 v156, v156, v4
    v_mul_f32 v157, v157, v4
    v_mul_f32 v158, v158, v4
    v_mul_f32 v159, v159, v4
    v_mul_f32 v160, v160, v3
    v_mul_f32 v161, v161, v3
    v_mul_f32 v162, v162, v3
    v_mul_f32 v163, v163, v3
    v_mul_f32 v164, v164, v3
    v_mul_f32 v165, v165, v3
    v_mul_f32 v166, v166, v3
    v_mul_f32 v167, v167, v3
    v_mul_f32 v168, v168, v4
    v_mul_f32 v169, v169, v4
    v_mul_f32 v170, v170, v4
    v_mul_f32 v171, v171, v4
    v_mul_f32 v172, v172, v4
    v_mul_f32 v173, v173, v4
    v_mul_f32 v174, v174, v4
    v_mul_f32 v175, v175, v4
    v_mul_f32 v176, v176, v3
    v_mul_f32 v177, v177, v3
    v_mul_f32 v178, v178, v3
    v_mul_f32 v179, v179, v3
    v_mul_f32 v180, v180, v3
    v_mul_f32 v181, v181, v3
    v_mul_f32 v182, v182, v3
    v_mul_f32 v183, v183, v3
    v_mul_f32 v184, v184, v4
    v_mul_f32 v185, v185, v4
    v_mul_f32 v186, v186, v4
    v_mul_f32 v187, v187, v4
    v_mul_f32 v188, v188, v4
    v_mul_f32 v189, v189, v4
    v_mul_f32 v190, v190, v4
    v_mul_f32 v191, v191, v4
    v_mul_f32 v192, v192, v3
    v_mul_f32 v193, v193, v3
    v_mul_f32 v194, v194, v3
    v_mul_f32 v195, v195, v3
    v_mul_f32 v196, v196, v3
    v_mul_f32 v197, v197, v3
    v_mul_f32 v198, v198, v3
    v_mul_f32 v199, v199, v3
    v_mul_f32 v200, v200, v4
    v_mul_f32 v201, v201, v4
    v_mul_f32 v202, v202, v4
    v_mul_f32 v203, v203, v4
    v_mul_f32 v204, v204, v4
    v_mul_f32 v205, v205, v4
    v_mul_f32 v206, v206, v4
    v_mul_f32 v207, v207, v4
    v_mul_f32 v208, v208, v3
    v_mul_f32 v209, v209, v3
    v_mul_f32 v210, v210, v3
    v_mul_f32 v211, v211, v3
    v_mul_f32 v212, v212, v3
    v_mul_f32 v213, v213, v3
    v_mul_f32 v214, v214, v3
    v_mul_f32 v215, v215, v3
    v_mul_f32 v216, v216, v4
    v_mul_f32 v217, v217, v4
    v_mul_f32 v218, v218, v4
    v_mul_f32 v219, v219, v4
    v_mul_f32 v220, v220, v4
    v_mul_f32 v221, v221, v4
    v_mul_f32 v222, v222, v4
    v_mul_f32 v223, v223, v4
    v_mul_f32 v224, v224, v3
    v_mul_f32 v225, v225, v3
    v_mul_f32 v226, v226, v3
    v_mul_f32 v227, v227, v3
    v_mul_f32 v228, v228, v3
    v_mul_f32 v229, v229, v3
    v_mul_f32 v230, v230, v3
    v_mul_f32 v231, v231, v3
    v_mul_f32 v232, v232, v4
    v_mul_f32 v233, v233, v4
    v_mul_f32 v234, v234, v4
    v_mul_f32 v235, v235, v4
    v_mul_f32 v236, v236, v4
    v_mul_f32 v237, v237, v4
    v_mul_f32 v238, v238, v4
    v_mul_f32 v239, v239, v4
    v_mul_f32 v240, v240, v3
    v_mul_f32 v241, v241, v3
    v_mul_f32 v242, v242, v3
    v_mul_f32 v243, v243, v3
    v_mul_f32 v244, v244, v3
    v_mul_f32 v245, v245, v3
    v_mul_f32 v246, v246, v3
    v_mul_f32 v247, v247, v3
    v_mul_f32 v248, v248, v4
    v_mul_f32 v249, v249, v4
    v_mul_f32 v250, v250, v4
    v_mul_f32 v251, v251, v4
    v_mul_f32 v252, v252, v4
    v_mul_f32 v253, v253, v4
    v_mul_f32 v254, v254, v4
    v_mul_f32 v255, v255, v4
    v_exp_f32 v48, v32
    v_exp_f32 v49, v33
    v_exp_f32 v50, v34
    v_cvt_pk_bf16_f32 v72, v48, v49
    v_exp_f32 v51, v35
    v_exp_f32 v52, v36
    v_cvt_pk_bf16_f32 v73, v50, v51
    v_exp_f32 v53, v37
    v_exp_f32 v54, v38
    v_cvt_pk_bf16_f32 v74, v52, v53
    v_exp_f32 v55, v39
    v_exp_f32 v56, v40
    v_cvt_pk_bf16_f32 v75, v54, v55
    s_nop 1
    v_mfma_f32_16x16x32_bf16 v[6:9], a[240:243], v[72:75], v[116:119]
    v_exp_f32 v57, v41
    v_exp_f32 v58, v42
    v_cvt_pk_bf16_f32 v76, v56, v57
    v_exp_f32 v59, v43
    v_exp_f32 v60, v44
    v_cvt_pk_bf16_f32 v77, v58, v59
    v_exp_f32 v61, v45
    v_exp_f32 v62, v46
    v_cvt_pk_bf16_f32 v78, v60, v61
    v_exp_f32 v63, v47
    s_nop 0
    v_cvt_pk_bf16_f32 v79, v62, v63
    s_nop 1
    v_mfma_f32_16x16x32_bf16 v[84:87], a[240:243], v[76:79], v[120:123]
    s_nop 7
    s_setpc_b64 s[64:65]
L_codeend:
.section .rodata,"a"
.p2align 6
.amdhsa_kernel concat_heads__gqa_block_cached__mha_block_cached__near_ridge_kernel
      .amdhsa_next_free_vgpr 512
      .amdhsa_next_free_sgpr 102
      .amdhsa_accum_offset 256
      .amdhsa_group_segment_fixed_size 0
      .amdhsa_kernarg_size 104
      .amdhsa_user_sgpr_count 2
      .amdhsa_user_sgpr_kernarg_segment_ptr 1
      .amdhsa_system_sgpr_workgroup_id_x 1
.end_amdhsa_kernel
```
